```python
import torch

def _softmax(x, axis=-1):
    return torch.softmax(x, dim=axis)
def _gelu(x):
    return torch.nn.functional.gelu(x, approximate="tanh")
def _silu(x):
    return torch.nn.functional.silu(x)
def _sigmoid(x):
    return torch.sigmoid(x)
def _layernorm(x, axis=-1, eps=1e-5):
    m = x.mean(dim=axis, keepdim=True)
    v = x.var(dim=axis, keepdim=True, unbiased=False)
    return (x - m) / torch.sqrt(v + eps)
def _scatter_add(tgt, idx, src, axis=0):
    return tgt.clone().index_add_(axis, idx, src)
def _segment_sum(src, seg, n):
    out = torch.zeros((n,) + src.shape[1:], dtype=src.dtype)
    return out.index_add_(0, seg, src)
def _pad(x, pw):
    flat = tuple(v for pair in reversed(pw) for v in pair)
    return torch.nn.functional.pad(x, flat)

kernel_name = 'sequential_preLN__ssm_conv_s4d__glu_gated_bilinear__prompt'

def setup_inputs():

    _w = (lambda a: (lambda t: t.to(torch.bfloat16) if t.is_floating_point() else t)(torch.as_tensor(a)))
    def _A_setup():
        Bsz, L, D, N = 1, 2048, 576, 128
        return {
            "u": _w((lambda *s: torch.randn(*s, dtype=torch.bfloat16) * 0.05)(Bsz, L, D)),
            "log_A_real": _w((lambda *s: torch.randn(*s, dtype=torch.bfloat16) * 6.4)(D, N) * 0.5),
            "A_imag": _w((lambda *s: torch.randn(*s, dtype=torch.bfloat16) * 0.05)(D, N) * 3.14),
            "C_real": _w((lambda *s: torch.randn(*s, dtype=torch.bfloat16) * 0.05)(D, N) / N ** 0.5),
            "C_imag": _w((lambda *s: torch.randn(*s, dtype=torch.bfloat16) * 0.05)(D, N) / N ** 0.5),
            "log_dt": _w((lambda *s: torch.randn(*s, dtype=torch.bfloat16) * 0.05)(D) * 0.5 - 4.0),
            "D_skip": _w((lambda *s: torch.randn(*s, dtype=torch.bfloat16) * 0.05)(D)),
        }
    _A_in = _A_setup()

    def _B_setup():
        B, S, D, F = 1, 2048, 576, 4608
        return {
            "x": _w((lambda *s: torch.randn(*s, dtype=torch.bfloat16) * 0.05)(B, S, D)),
            "w_gate": _w((lambda *s: torch.randn(*s, dtype=torch.bfloat16) * 0.4)(D, F) * (D ** -0.5)),
            "w_up": _w((lambda *s: torch.randn(*s, dtype=torch.bfloat16) * 0.4)(D, F) * (D ** -0.5)),
            "w_down": _w((lambda *s: torch.randn(*s, dtype=torch.bfloat16) * 0.4)(F, D) * (F ** -0.5)),
        }
    _B_in = _B_setup()

    return {
        "A_u": _A_in["u"],
        "A_log_A_real": _A_in["log_A_real"],
        "A_A_imag": _A_in["A_imag"],
        "A_C_real": _A_in["C_real"],
        "A_C_imag": _A_in["C_imag"],
        "A_log_dt": _A_in["log_dt"],
        "A_D_skip": _A_in["D_skip"],
        "B_x": _B_in["x"],
        "B_w_gate": _B_in["w_gate"],
        "B_w_up": _B_in["w_up"],
        "B_w_down": _B_in["w_down"],
    }

def reference(A_u, A_log_A_real, A_A_imag, A_C_real, A_C_imag, A_log_dt, A_D_skip, B_x, B_w_gate, B_w_up, B_w_down):
    def _A_ref(u, log_A_real, A_imag, C_real, C_imag, log_dt, D_skip):
        L = u.shape[1]
        dt = torch.exp(log_dt)
        A = -torch.exp(log_A_real) + 1j * A_imag
        C = (C_real + 1j * C_imag) * dt[:, None]
        pos = (lambda x, dt: x.to(dt))(torch.arange(L), log_dt.dtype)
        P = torch.exp((A * dt[:, None])[:, :, None] * pos[None, None, :])
        K = 2.0 * torch.einsum("dn,dnl->dl", C, P).real
        L2 = 2 * L
        u_t = (lambda x, *d: x.permute(*d))(u, 0, 2, 1)
        Kf = (lambda x, *a, **k: torch.fft.rfft(x.float(), *a, **k))(K, L2)
        Uf = (lambda x, *a, **k: torch.fft.rfft(x.float(), *a, **k))(u_t, L2)
        y = (lambda x, *a, **k: torch.fft.irfft(x, *a, **k).to(torch.bfloat16))(Uf * Kf[None, :, :], L2)[:, :, :L]
        y = (lambda x, *d: x.permute(*d))(y, 0, 2, 1)
        return y + u * D_skip[None, None, :]

    def _B_ref(x, w_gate, w_up, w_down):
        g = torch.einsum("bsd,df->bsf", x, w_gate)
        u = torch.einsum("bsd,df->bsf", x, w_up)
        h = g * u
        return torch.einsum("bsf,fd->bsd", h, w_down)

    x = A_u
    h = x + _A_ref(_layernorm(x, axis=-1), A_log_A_real, A_A_imag, A_C_real, A_C_imag, A_log_dt, A_D_skip)
    h2 = h + _B_ref(_layernorm(h, axis=-1), B_w_gate, B_w_up, B_w_down)
    return h2
```

```asm
; @launch kernel=k1_kernel grid=(256,1,1) block=(256,1,1) lds=68096
; @launch kernel=k2_kernel grid=(256,1,1) block=(512,1,1) lds=137856
; @launch kernel=k3_kernel grid=(256,1,1) block=(256,1,1) lds=152192
.amdgcn_target "amdgcn-amd-amdhsa--gfx950"
.text
.globl k1_kernel
.p2align 12
.type k1_kernel,@function
k1_kernel:
    s_cmp_ge_u32 s2, 256
    s_cbranch_scc1 k1_kernel_end
    s_load_dwordx4 s[4:7], s[0:1], 0
    s_load_dwordx4 s[8:11], s[0:1], 16
    s_load_dwordx4 s[12:15], s[0:1], 32
    s_load_dwordx4 s[16:19], s[0:1], 64
    s_load_dwordx2 s[20:21], s[0:1], 104
    s_load_dwordx2 s[22:23], s[0:1], 80
    v_and_b32 v1, 63, v0
    v_lshrrev_b32 v2, 6, v0
    s_nop 0
    v_readfirstlane_b32 s3, v2
    s_nop 0
    s_mul_i32 s37, s3, 17024
    s_lshl_b32 s48, s3, 8
    s_add_u32 s48, s48, s2
    s_sub_u32 s48, s48, 256
    s_waitcnt lgkmcnt(0)
    s_mov_b32 s24, s20
    s_and_b32 s25, s21, 0xffff
    s_mov_b32 s26, 268435456
    s_mov_b32 s27, 0x20000
    s_cmp_lg_u32 s3, 0
    s_cbranch_scc1 k1_kernel_nl
    s_mov_b32 s28, s4
    s_and_b32 s29, s5, 0xffff
    s_mov_b32 s30, 2359296
    s_mov_b32 s31, 0x20000
    s_mul_i32 s41, s2, 9216
    v_lshrrev_b32 v3, 3, v1
    v_and_b32 v4, 7, v1
    v_mul_u32_u24 v5, 1152, v3
    v_lshl_add_u32 v5, v4, 4, v5
    buffer_load_dwordx4 v[16:19], v5, s[28:31], s41 offen offset:0 nt
    buffer_load_dwordx4 v[20:23], v5, s[28:31], s41 offen offset:128 nt
    buffer_load_dwordx4 v[24:27], v5, s[28:31], s41 offen offset:256 nt
    buffer_load_dwordx4 v[28:31], v5, s[28:31], s41 offen offset:384 nt
    buffer_load_dwordx4 v[32:35], v5, s[28:31], s41 offen offset:512 nt
    buffer_load_dwordx4 v[36:39], v5, s[28:31], s41 offen offset:640 nt
    buffer_load_dwordx4 v[40:43], v5, s[28:31], s41 offen offset:768 nt
    buffer_load_dwordx4 v[44:47], v5, s[28:31], s41 offen offset:896 nt
    buffer_load_dwordx4 v[48:51], v5, s[28:31], s41 offen offset:1024 nt
    s_branch k1_kernel_ln
k1_kernel_nl:
    s_sub_u32 s36, s2, 64
    s_cmp_ge_u32 s48, 576
    s_cbranch_scc1 k1_kernel_sw
    s_mov_b32 s28, s6
    s_and_b32 s29, s7, 0xffff
    s_mov_b32 s30, 147456
    s_mov_b32 s31, 0x20000
    s_mov_b32 s32, s8
    s_and_b32 s33, s9, 0xffff
    s_mov_b32 s34, 147456
    s_mov_b32 s35, 0x20000
    s_mov_b32 s40, s10
    s_and_b32 s41, s11, 0xffff
    s_mov_b32 s42, 147456
    s_mov_b32 s43, 0x20000
    s_mov_b32 s44, s12
    s_and_b32 s45, s13, 0xffff
    s_mov_b32 s46, 147456
    s_mov_b32 s47, 0x20000
    s_mov_b32 s52, s14
    s_and_b32 s53, s15, 0xffff
    s_mov_b32 s54, 1152
    s_mov_b32 s55, 0x20000
    s_lshl_b32 s49, s48, 8
    s_lshl_b32 s51, s48, 1
    v_lshlrev_b32 v3, 2, v1
    v_mov_b32 v4, 0
    buffer_load_ushort v5, v4, s[52:55], s51 offen
    buffer_load_dword v8, v3, s[28:31], s49 offen nt
    buffer_load_dword v9, v3, s[32:35], s49 offen nt
    buffer_load_dword v10, v3, s[40:43], s49 offen nt
    buffer_load_dword v11, v3, s[44:47], s49 offen nt
    s_mov_b32 s56, 0xffff0000
    s_mov_b32 s57, 0x05040100
    v_lshlrev_b32 v6, 3, v1
    v_add_u32 v6, s37, v6
    v_and_b32 v2, 15, v1
    v_mul_u32_u24 v7, 528, v2
    v_and_b32 v12, 48, v1
    v_add3_u32 v7, v7, v12, s37
    v_lshrrev_b32 v12, 4, v1
    v_lshlrev_b32 v13, 4, v2
    v_add_u32 v13, s37, v13
    v_lshrrev_b32 v14, 1, v12
    v_lshl_add_u32 v120, v14, 8, v13
    v_and_b32 v14, 1, v12
    v_lshl_add_u32 v120, v14, 3, v120
    v_lshl_add_u32 v125, v12, 10, v13
    v_lshl_add_u32 v14, v12, 8, v13
    v_add_u32 v14, 512, v14
    v_lshl_add_u32 v15, v12, 9, v13
    v_cmp_gt_u32 vcc, 32, v1
    s_nop 1
    v_cndmask_b32 v121, v15, v14, vcc
    v_mov_b32 v14, 8
    v_cndmask_b32_e64 v14, v14, 4, vcc
    v_add_u32 v122, v14, v121
    v_mov_b32 v14, 256
    v_cndmask_b32_e64 v14, v14, 8, vcc
    v_add_u32 v123, v14, v121
    v_mov_b32 v14, 264
    v_cndmask_b32_e64 v14, v14, 12, vcc
    v_add_u32 v124, v14, v121
    v_lshlrev_b32 v126, 4, v1
    v_add_u32 v127, s37, v126
    s_mov_b64 exec, 0
    s_branch L_pad_k1_kernel_0
L_ret_k1_kernel_0:
    s_mov_b64 exec, -1
    s_setprio 1
    s_waitcnt vmcnt(3)
    v_lshlrev_b32 v5, 16, v5
    v_lshlrev_b32 v12, 16, v8
    v_and_b32 v13, s56, v8
    v_mul_f32 v5, 0x3fb8aa3b, v5
    v_mul_f32 v12, 0x3fb8aa3b, v12
    v_mul_f32 v13, 0x3fb8aa3b, v13
    v_exp_f32 v5, v5
    v_exp_f32 v12, v12
    v_exp_f32 v13, v13
    s_waitcnt vmcnt(0)
    v_lshlrev_b32 v14, 16, v9
    v_and_b32 v15, s56, v9
    v_lshlrev_b32 v16, 16, v10
    v_and_b32 v17, s56, v10
    v_lshlrev_b32 v18, 16, v11
    v_and_b32 v19, s56, v11
    v_cvt_pk_bf16_f32 v5, v5, v5
    v_cvt_pk_bf16_f32 v13, v12, v13
    v_lshlrev_b32 v4, 16, v5
    v_lshlrev_b32 v5, 16, v5
    v_lshlrev_b32 v12, 16, v13
    v_and_b32 v13, s56, v13
    v_pk_mul_f32 v[16:17], v[16:17], v[4:5]
    v_pk_mul_f32 v[18:19], v[18:19], v[4:5]
    v_pk_mul_f32 v[12:13], v[12:13], v[4:5]
    v_pk_mul_f32 v[14:15], v[14:15], v[4:5]
    v_max3_f32 v8, |v16|, |v17|, |v18|
    v_max_f32_e64 v8, v8, |v19|
    v_mul_f32 v12, 0xbfb8aa3b, v12
    v_mul_f32 v13, 0xbfb8aa3b, v13
    v_mul_f32 v14, 0.15915494, v14
    v_mul_f32 v15, 0.15915494, v15
    v_mul_f32 v92, 0x41000000, v12
    v_max_f32_dpp v8, v8, v8 row_shr:1 row_mask:0xf bank_mask:0xf
    v_mul_f32 v96, 0x43000000, v12
    v_exp_f32 v100, v12
    v_mul_f32 v93, 0x41000000, v13
    v_max_f32_dpp v8, v8, v8 row_shr:2 row_mask:0xf bank_mask:0xf
    v_mul_f32 v97, 0x43000000, v13
    v_exp_f32 v101, v13
    v_mul_f32 v94, 0x41000000, v14
    v_max_f32_dpp v8, v8, v8 row_shr:4 row_mask:0xf bank_mask:0xf
    v_mul_f32 v98, 0x43000000, v14
    v_fract_f32 v102, v14
    v_mul_f32 v95, 0x41000000, v15
    v_max_f32_dpp v8, v8, v8 row_shr:8 row_mask:0xf bank_mask:0xf
    v_mul_f32 v99, 0x43000000, v15
    v_fract_f32 v103, v15
    v_exp_f32 v92, v92
    v_max_f32_dpp v8, v8, v8 row_bcast:15 row_mask:0xa bank_mask:0xf
    v_exp_f32 v96, v96
    v_cos_f32 v20, v102
    v_exp_f32 v93, v93
    v_max_f32_dpp v8, v8, v8 row_bcast:31 row_mask:0xc bank_mask:0xf
    v_exp_f32 v97, v97
    v_cos_f32 v21, v103
    v_fract_f32 v94, v94
    v_readlane_b32 s58, v8, 63
    v_fract_f32 v98, v98
    v_sin_f32 v22, v102
    v_fract_f32 v95, v95
    v_frexp_exp_i32_f32 v8, s58
    v_fract_f32 v99, v99
    v_sin_f32 v23, v103
    v_cos_f32 v48, v94
    v_sub_u32 v9, 7, v8
    v_cos_f32 v52, v98
    v_pk_mul_f32 v[20:21], v[20:21], v[100:101]
    v_cos_f32 v49, v95
    v_add_u32 v10, -17, v8
    v_cos_f32 v53, v99
    v_pk_mul_f32 v[22:23], v[22:23], v[100:101]
    v_sin_f32 v50, v94
    v_ldexp_f32 v16, v16, v9
    v_sin_f32 v54, v98
    v_sin_f32 v51, v95
    v_ldexp_f32 v17, v17, v9
    v_sin_f32 v55, v99
    v_pk_mul_f32 v[48:49], v[48:49], v[92:93]
    v_ldexp_f32 v18, v18, v9
    v_pk_mul_f32 v[52:53], v[52:53], v[96:97]
    v_pk_mul_f32 v[50:51], v[50:51], v[92:93]
    v_ldexp_f32 v19, v19, v9
    v_pk_mul_f32 v[54:55], v[54:55], v[96:97]
    v_ldexp_f32 v10, 1.0, v10
    s_lshl_b32 s51, s48, 2
    s_add_u32 s51, s51, 13697024
    v_mov_b32 v9, 0
    s_mov_b64 exec, 1
    buffer_store_dword v10, v9, s[24:27], s51 offen sc1
    s_mov_b64 exec, -1
    v_cvt_pk_f16_f32 v96, v16, v17
    v_mov_b32 v104, 0x3c003c00
    v_pk_mul_f32 v[108:109], v[54:55], v[54:55]
    v_cvt_pk_f16_f32 v97, -v18, -v19
    v_mov_b32 v105, 0
    v_pk_mul_f32 v[110:111], v[54:55], v[52:53]
    ds_write_b64 v6, v[96:97] offset:0
    ds_write_b64 v6, v[104:105] offset:8448
    v_pk_fma_f32 v[56:57], v[52:53], v[52:53], v[108:109] neg_lo:[0,0,1] neg_hi:[0,0,1]
    v_pk_mul_f32 v[92:93], v[18:19], v[50:51]
    v_cvt_pk_f16_f32 v106, v52, v53
    v_pk_fma_f32 v[58:59], v[52:53], v[54:55], v[110:111]
    v_pk_mul_f32 v[94:95], v[18:19], v[48:49]
    v_cvt_pk_f16_f32 v107, v54, v55
    v_pk_mul_f32 v[108:109], v[58:59], v[54:55]
    v_pk_fma_f32 v[88:89], v[16:17], v[48:49], v[92:93] neg_lo:[0,0,1] neg_hi:[0,0,1]
    ds_write_b64 v6, v[106:107] offset:12672
    v_pk_mul_f32 v[110:111], v[58:59], v[52:53]
    v_pk_fma_f32 v[90:91], v[16:17], v[50:51], v[94:95]
    v_cvt_pk_f16_f32 v104, v20, v21
    v_pk_fma_f32 v[60:61], v[56:57], v[52:53], v[108:109] neg_lo:[0,0,1] neg_hi:[0,0,1]
    v_cvt_pk_f16_f32 v98, v88, v89
    v_cvt_pk_f16_f32 v105, v22, v23
    v_pk_fma_f32 v[62:63], v[56:57], v[54:55], v[110:111]
    v_cvt_pk_f16_f32 v99, -v90, -v91
    ds_write_b64 v6, v[104:105] offset:8976
    v_pk_mul_f32 v[108:109], v[62:63], v[54:55]
    ds_write_b64 v6, v[98:99] offset:528
    v_pk_mul_f32 v[100:101], v[54:55], v[22:23]
    v_pk_mul_f32 v[110:111], v[62:63], v[52:53]
    v_pk_mul_f32 v[92:93], v[90:91], v[50:51]
    v_pk_mul_f32 v[102:103], v[54:55], v[20:21]
    v_pk_fma_f32 v[64:65], v[60:61], v[52:53], v[108:109] neg_lo:[0,0,1] neg_hi:[0,0,1]
    v_pk_mul_f32 v[94:95], v[90:91], v[48:49]
    v_pk_fma_f32 v[80:81], v[52:53], v[20:21], v[100:101] neg_lo:[0,0,1] neg_hi:[0,0,1]
    v_pk_fma_f32 v[66:67], v[60:61], v[54:55], v[110:111]
    v_pk_fma_f32 v[16:17], v[88:89], v[48:49], v[92:93] neg_lo:[0,0,1] neg_hi:[0,0,1]
    v_pk_fma_f32 v[82:83], v[52:53], v[22:23], v[102:103]
    v_pk_mul_f32 v[108:109], v[66:67], v[54:55]
    v_pk_fma_f32 v[18:19], v[88:89], v[50:51], v[94:95]
    v_cvt_pk_f16_f32 v106, v80, v81
    v_pk_mul_f32 v[110:111], v[66:67], v[52:53]
    v_cvt_pk_f16_f32 v96, v16, v17
    v_cvt_pk_f16_f32 v107, v82, v83
    v_pk_fma_f32 v[68:69], v[64:65], v[52:53], v[108:109] neg_lo:[0,0,1] neg_hi:[0,0,1]
    v_cvt_pk_f16_f32 v97, -v18, -v19
    ds_write_b64 v6, v[106:107] offset:13200
    v_pk_fma_f32 v[70:71], v[64:65], v[54:55], v[110:111]
    ds_write_b64 v6, v[96:97] offset:1056
    v_pk_mul_f32 v[100:101], v[22:23], v[22:23]
    v_pk_mul_f32 v[108:109], v[70:71], v[54:55]
    v_pk_mul_f32 v[92:93], v[18:19], v[50:51]
    v_pk_mul_f32 v[102:103], v[22:23], v[20:21]
    v_pk_mul_f32 v[110:111], v[70:71], v[52:53]
    v_pk_mul_f32 v[94:95], v[18:19], v[48:49]
    v_pk_fma_f32 v[24:25], v[20:21], v[20:21], v[100:101] neg_lo:[0,0,1] neg_hi:[0,0,1]
    v_pk_fma_f32 v[72:73], v[68:69], v[52:53], v[108:109] neg_lo:[0,0,1] neg_hi:[0,0,1]
    v_pk_fma_f32 v[88:89], v[16:17], v[48:49], v[92:93] neg_lo:[0,0,1] neg_hi:[0,0,1]
    v_pk_fma_f32 v[26:27], v[20:21], v[22:23], v[102:103]
    v_pk_fma_f32 v[74:75], v[68:69], v[54:55], v[110:111]
    v_pk_fma_f32 v[90:91], v[16:17], v[50:51], v[94:95]
    v_cvt_pk_f16_f32 v104, v24, v25
    v_pk_mul_f32 v[108:109], v[74:75], v[54:55]
    v_cvt_pk_f16_f32 v98, v88, v89
    v_cvt_pk_f16_f32 v105, v26, v27
    v_pk_mul_f32 v[110:111], v[74:75], v[52:53]
    v_cvt_pk_f16_f32 v99, -v90, -v91
    ds_write_b64 v6, v[104:105] offset:9504
    v_pk_fma_f32 v[76:77], v[72:73], v[52:53], v[108:109] neg_lo:[0,0,1] neg_hi:[0,0,1]
    ds_write_b64 v6, v[98:99] offset:1584
    v_pk_mul_f32 v[100:101], v[54:55], v[26:27]
    v_pk_fma_f32 v[78:79], v[72:73], v[54:55], v[110:111]
    v_pk_mul_f32 v[92:93], v[90:91], v[50:51]
    v_pk_mul_f32 v[102:103], v[54:55], v[24:25]
    v_pk_mul_f32 v[94:95], v[90:91], v[48:49]
    v_pk_fma_f32 v[80:81], v[52:53], v[24:25], v[100:101] neg_lo:[0,0,1] neg_hi:[0,0,1]
    v_pk_fma_f32 v[16:17], v[88:89], v[48:49], v[92:93] neg_lo:[0,0,1] neg_hi:[0,0,1]
    v_pk_fma_f32 v[82:83], v[52:53], v[26:27], v[102:103]
    v_pk_fma_f32 v[18:19], v[88:89], v[50:51], v[94:95]
    v_cvt_pk_f16_f32 v106, v80, v81
    v_cvt_pk_f16_f32 v96, v16, v17
    v_cvt_pk_f16_f32 v107, v82, v83
    v_cvt_pk_f16_f32 v97, -v18, -v19
    ds_write_b64 v6, v[106:107] offset:13728
    ds_write_b64 v6, v[96:97] offset:2112
    v_pk_mul_f32 v[100:101], v[26:27], v[22:23]
    v_pk_mul_f32 v[92:93], v[18:19], v[50:51]
    v_pk_mul_f32 v[102:103], v[26:27], v[20:21]
    v_pk_mul_f32 v[94:95], v[18:19], v[48:49]
    v_pk_fma_f32 v[28:29], v[24:25], v[20:21], v[100:101] neg_lo:[0,0,1] neg_hi:[0,0,1]
    v_pk_fma_f32 v[88:89], v[16:17], v[48:49], v[92:93] neg_lo:[0,0,1] neg_hi:[0,0,1]
    v_pk_fma_f32 v[30:31], v[24:25], v[22:23], v[102:103]
    v_pk_fma_f32 v[90:91], v[16:17], v[50:51], v[94:95]
    v_cvt_pk_f16_f32 v104, v28, v29
    v_cvt_pk_f16_f32 v98, v88, v89
    v_cvt_pk_f16_f32 v105, v30, v31
    v_cvt_pk_f16_f32 v99, -v90, -v91
    ds_write_b64 v6, v[104:105] offset:10032
    ds_write_b64 v6, v[98:99] offset:2640
    v_pk_mul_f32 v[100:101], v[54:55], v[30:31]
    v_pk_mul_f32 v[92:93], v[90:91], v[50:51]
    v_pk_mul_f32 v[102:103], v[54:55], v[28:29]
    v_pk_mul_f32 v[94:95], v[90:91], v[48:49]
    v_pk_fma_f32 v[80:81], v[52:53], v[28:29], v[100:101] neg_lo:[0,0,1] neg_hi:[0,0,1]
    v_pk_fma_f32 v[16:17], v[88:89], v[48:49], v[92:93] neg_lo:[0,0,1] neg_hi:[0,0,1]
    v_pk_fma_f32 v[82:83], v[52:53], v[30:31], v[102:103]
    v_pk_fma_f32 v[18:19], v[88:89], v[50:51], v[94:95]
    v_cvt_pk_f16_f32 v106, v80, v81
    v_cvt_pk_f16_f32 v96, v16, v17
    v_cvt_pk_f16_f32 v107, v82, v83
    v_cvt_pk_f16_f32 v97, -v18, -v19
    ds_write_b64 v6, v[106:107] offset:14256
    ds_write_b64 v6, v[96:97] offset:3168
    v_pk_mul_f32 v[100:101], v[30:31], v[22:23]
    v_pk_mul_f32 v[92:93], v[18:19], v[50:51]
    v_pk_mul_f32 v[102:103], v[30:31], v[20:21]
    v_pk_mul_f32 v[94:95], v[18:19], v[48:49]
    v_pk_fma_f32 v[32:33], v[28:29], v[20:21], v[100:101] neg_lo:[0,0,1] neg_hi:[0,0,1]
    v_pk_fma_f32 v[88:89], v[16:17], v[48:49], v[92:93] neg_lo:[0,0,1] neg_hi:[0,0,1]
    v_pk_fma_f32 v[34:35], v[28:29], v[22:23], v[102:103]
    v_pk_fma_f32 v[90:91], v[16:17], v[50:51], v[94:95]
    v_cvt_pk_f16_f32 v104, v32, v33
    v_cvt_pk_f16_f32 v98, v88, v89
    v_cvt_pk_f16_f32 v105, v34, v35
    v_cvt_pk_f16_f32 v99, -v90, -v91
    ds_write_b64 v6, v[104:105] offset:10560
    ds_write_b64 v6, v[98:99] offset:3696
    v_pk_mul_f32 v[100:101], v[54:55], v[34:35]
    v_pk_mul_f32 v[92:93], v[90:91], v[50:51]
    v_pk_mul_f32 v[102:103], v[54:55], v[32:33]
    v_pk_mul_f32 v[94:95], v[90:91], v[48:49]
    v_pk_fma_f32 v[80:81], v[52:53], v[32:33], v[100:101] neg_lo:[0,0,1] neg_hi:[0,0,1]
    v_pk_fma_f32 v[16:17], v[88:89], v[48:49], v[92:93] neg_lo:[0,0,1] neg_hi:[0,0,1]
    v_pk_fma_f32 v[82:83], v[52:53], v[34:35], v[102:103]
    v_pk_fma_f32 v[18:19], v[88:89], v[50:51], v[94:95]
    v_cvt_pk_f16_f32 v106, v80, v81
    v_cvt_pk_f16_f32 v96, v16, v17
    v_cvt_pk_f16_f32 v107, v82, v83
    v_cvt_pk_f16_f32 v97, -v18, -v19
    ds_write_b64 v6, v[106:107] offset:14784
    ds_write_b64 v6, v[96:97] offset:4224
    v_pk_mul_f32 v[100:101], v[34:35], v[22:23]
    v_pk_mul_f32 v[92:93], v[18:19], v[50:51]
    v_pk_mul_f32 v[102:103], v[34:35], v[20:21]
    v_pk_mul_f32 v[94:95], v[18:19], v[48:49]
    v_pk_fma_f32 v[36:37], v[32:33], v[20:21], v[100:101] neg_lo:[0,0,1] neg_hi:[0,0,1]
    v_pk_fma_f32 v[88:89], v[16:17], v[48:49], v[92:93] neg_lo:[0,0,1] neg_hi:[0,0,1]
    v_pk_fma_f32 v[38:39], v[32:33], v[22:23], v[102:103]
    v_pk_fma_f32 v[90:91], v[16:17], v[50:51], v[94:95]
    v_cvt_pk_f16_f32 v104, v36, v37
    v_cvt_pk_f16_f32 v98, v88, v89
    v_cvt_pk_f16_f32 v105, v38, v39
    v_cvt_pk_f16_f32 v99, -v90, -v91
    ds_write_b64 v6, v[104:105] offset:11088
    ds_write_b64 v6, v[98:99] offset:4752
    v_pk_mul_f32 v[100:101], v[54:55], v[38:39]
    v_pk_mul_f32 v[92:93], v[90:91], v[50:51]
    v_pk_mul_f32 v[102:103], v[54:55], v[36:37]
    v_pk_mul_f32 v[94:95], v[90:91], v[48:49]
    v_pk_fma_f32 v[80:81], v[52:53], v[36:37], v[100:101] neg_lo:[0,0,1] neg_hi:[0,0,1]
    v_pk_fma_f32 v[16:17], v[88:89], v[48:49], v[92:93] neg_lo:[0,0,1] neg_hi:[0,0,1]
    v_pk_fma_f32 v[82:83], v[52:53], v[38:39], v[102:103]
    v_pk_fma_f32 v[18:19], v[88:89], v[50:51], v[94:95]
    v_cvt_pk_f16_f32 v106, v80, v81
    v_cvt_pk_f16_f32 v96, v16, v17
    v_cvt_pk_f16_f32 v107, v82, v83
    v_cvt_pk_f16_f32 v97, -v18, -v19
    ds_write_b64 v6, v[106:107] offset:15312
    ds_write_b64 v6, v[96:97] offset:5280
    v_pk_mul_f32 v[100:101], v[38:39], v[22:23]
    v_pk_mul_f32 v[92:93], v[18:19], v[50:51]
    v_pk_mul_f32 v[102:103], v[38:39], v[20:21]
    v_pk_mul_f32 v[94:95], v[18:19], v[48:49]
    v_pk_fma_f32 v[40:41], v[36:37], v[20:21], v[100:101] neg_lo:[0,0,1] neg_hi:[0,0,1]
    v_pk_fma_f32 v[88:89], v[16:17], v[48:49], v[92:93] neg_lo:[0,0,1] neg_hi:[0,0,1]
    v_pk_fma_f32 v[42:43], v[36:37], v[22:23], v[102:103]
    v_pk_fma_f32 v[90:91], v[16:17], v[50:51], v[94:95]
    v_cvt_pk_f16_f32 v104, v40, v41
    v_cvt_pk_f16_f32 v98, v88, v89
    v_cvt_pk_f16_f32 v105, v42, v43
    v_cvt_pk_f16_f32 v99, -v90, -v91
    ds_write_b64 v6, v[104:105] offset:11616
    ds_write_b64 v6, v[98:99] offset:5808
    v_pk_mul_f32 v[100:101], v[54:55], v[42:43]
    v_pk_mul_f32 v[92:93], v[90:91], v[50:51]
    v_pk_mul_f32 v[102:103], v[54:55], v[40:41]
    v_pk_mul_f32 v[94:95], v[90:91], v[48:49]
    v_pk_fma_f32 v[80:81], v[52:53], v[40:41], v[100:101] neg_lo:[0,0,1] neg_hi:[0,0,1]
    v_pk_fma_f32 v[16:17], v[88:89], v[48:49], v[92:93] neg_lo:[0,0,1] neg_hi:[0,0,1]
    v_pk_fma_f32 v[82:83], v[52:53], v[42:43], v[102:103]
    v_pk_fma_f32 v[18:19], v[88:89], v[50:51], v[94:95]
    v_cvt_pk_f16_f32 v106, v80, v81
    v_cvt_pk_f16_f32 v96, v16, v17
    v_cvt_pk_f16_f32 v107, v82, v83
    v_cvt_pk_f16_f32 v97, -v18, -v19
    ds_write_b64 v6, v[106:107] offset:15840
    ds_write_b64 v6, v[96:97] offset:6336
    v_pk_mul_f32 v[100:101], v[42:43], v[22:23]
    v_pk_mul_f32 v[92:93], v[18:19], v[50:51]
    v_pk_mul_f32 v[102:103], v[42:43], v[20:21]
    v_pk_mul_f32 v[94:95], v[18:19], v[48:49]
    v_pk_fma_f32 v[44:45], v[40:41], v[20:21], v[100:101] neg_lo:[0,0,1] neg_hi:[0,0,1]
    v_pk_fma_f32 v[88:89], v[16:17], v[48:49], v[92:93] neg_lo:[0,0,1] neg_hi:[0,0,1]
    v_pk_fma_f32 v[46:47], v[40:41], v[22:23], v[102:103]
    v_pk_fma_f32 v[90:91], v[16:17], v[50:51], v[94:95]
    v_cvt_pk_f16_f32 v104, v44, v45
    v_cvt_pk_f16_f32 v98, v88, v89
    v_cvt_pk_f16_f32 v105, v46, v47
    v_cvt_pk_f16_f32 v99, -v90, -v91
    ds_write_b64 v6, v[104:105] offset:12144
    ds_write_b64 v6, v[98:99] offset:6864
    v_pk_mul_f32 v[100:101], v[54:55], v[46:47]
    v_pk_mul_f32 v[92:93], v[90:91], v[50:51]
    v_pk_mul_f32 v[102:103], v[54:55], v[44:45]
    v_pk_mul_f32 v[94:95], v[90:91], v[48:49]
    v_pk_fma_f32 v[80:81], v[52:53], v[44:45], v[100:101] neg_lo:[0,0,1] neg_hi:[0,0,1]
    v_pk_fma_f32 v[16:17], v[88:89], v[48:49], v[92:93] neg_lo:[0,0,1] neg_hi:[0,0,1]
    v_pk_fma_f32 v[82:83], v[52:53], v[46:47], v[102:103]
    v_pk_fma_f32 v[18:19], v[88:89], v[50:51], v[94:95]
    v_cvt_pk_f16_f32 v106, v80, v81
    v_cvt_pk_f16_f32 v96, v16, v17
    v_cvt_pk_f16_f32 v107, v82, v83
    v_cvt_pk_f16_f32 v97, -v18, -v19
    ds_write_b64 v6, v[106:107] offset:16368
    ds_write_b64 v6, v[96:97] offset:7392
    v_pk_mul_f32 v[92:93], v[18:19], v[50:51]
    v_pk_mul_f32 v[94:95], v[18:19], v[48:49]
    v_pk_fma_f32 v[88:89], v[16:17], v[48:49], v[92:93] neg_lo:[0,0,1] neg_hi:[0,0,1]
    v_pk_fma_f32 v[90:91], v[16:17], v[50:51], v[94:95]
    v_cvt_pk_f16_f32 v98, v88, v89
    v_cvt_pk_f16_f32 v99, -v90, -v91
    ds_write_b64 v6, v[98:99] offset:7920
    ds_read_b128 v[128:131], v7 offset:0
    ds_read_b128 v[132:135], v7 offset:64
    ds_read_b128 v[136:139], v7 offset:128
    ds_read_b128 v[140:143], v7 offset:192
    ds_read_b128 v[144:147], v7 offset:256
    ds_read_b128 v[148:151], v7 offset:320
    ds_read_b128 v[152:155], v7 offset:384
    ds_read_b128 v[156:159], v7 offset:448
    ds_read_b128 v[160:163], v7 offset:8448
    ds_read_b128 v[164:167], v7 offset:8512
    ds_read_b128 v[168:171], v7 offset:8576
    ds_read_b128 v[172:175], v7 offset:8640
    ds_read_b128 v[176:179], v7 offset:8704
    ds_read_b128 v[180:183], v7 offset:8768
    ds_read_b128 v[184:187], v7 offset:8832
    ds_read_b128 v[188:191], v7 offset:8896
    v_cvt_pk_f16_f32 v96, v56, v57
    v_pk_mul_f32 v[100:101], v[78:79], v[54:55]
    v_cvt_pk_f16_f32 v97, v58, v59
    v_pk_mul_f32 v[102:103], v[78:79], v[52:53]
    ds_write_b64 v6, v[96:97] offset:0
    v_pk_fma_f32 v[80:81], v[76:77], v[52:53], v[100:101] neg_lo:[0,0,1] neg_hi:[0,0,1]
    v_pk_mul_f32 v[92:93], v[58:59], v[26:27]
    v_pk_fma_f32 v[82:83], v[76:77], v[54:55], v[102:103]
    v_pk_mul_f32 v[94:95], v[58:59], v[24:25]
    v_cvt_pk_f16_f32 v104, v80, v81
    v_pk_fma_f32 v[16:17], v[56:57], v[24:25], v[92:93] neg_lo:[0,0,1] neg_hi:[0,0,1]
    v_cvt_pk_f16_f32 v105, v82, v83
    v_pk_fma_f32 v[18:19], v[56:57], v[26:27], v[94:95]
    ds_write_b64 v6, v[104:105] offset:8448
    v_cvt_pk_f16_f32 v98, v16, v17
    v_pk_mul_f32 v[100:101], v[82:83], v[54:55]
    v_cvt_pk_f16_f32 v99, v18, v19
    v_pk_mul_f32 v[102:103], v[82:83], v[52:53]
    ds_write_b64 v6, v[98:99] offset:528
    v_pk_fma_f32 v[84:85], v[80:81], v[52:53], v[100:101] neg_lo:[0,0,1] neg_hi:[0,0,1]
    v_pk_mul_f32 v[92:93], v[58:59], v[34:35]
    v_pk_fma_f32 v[86:87], v[80:81], v[54:55], v[102:103]
    v_pk_mul_f32 v[94:95], v[58:59], v[32:33]
    v_cvt_pk_f16_f32 v106, v84, v85
    v_pk_fma_f32 v[88:89], v[56:57], v[32:33], v[92:93] neg_lo:[0,0,1] neg_hi:[0,0,1]
    v_cvt_pk_f16_f32 v107, v86, v87
    v_pk_fma_f32 v[90:91], v[56:57], v[34:35], v[94:95]
    ds_write_b64 v6, v[106:107] offset:8976
    s_waitcnt lgkmcnt(4)
    v_cvt_pk_f16_f32 v96, v88, v89
    v_mfma_f32_16x16x32_f16 v[192:195], v[160:163], v[128:131], 0
    v_pk_mul_f32 v[100:101], v[86:87], v[54:55]
    v_mfma_f32_16x16x32_f16 v[192:195], v[164:167], v[132:135], v[192:195]
    v_cvt_pk_f16_f32 v97, v90, v91
    v_mfma_f32_16x16x32_f16 v[192:195], v[168:171], v[136:139], v[192:195]
    v_pk_mul_f32 v[102:103], v[86:87], v[52:53]
    v_mfma_f32_16x16x32_f16 v[192:195], v[172:175], v[140:143], v[192:195]
    ds_write_b64 v6, v[96:97] offset:1056
    v_pk_fma_f32 v[80:81], v[84:85], v[52:53], v[100:101] neg_lo:[0,0,1] neg_hi:[0,0,1]
    v_mfma_f32_16x16x32_f16 v[192:195], v[176:179], v[144:147], v[192:195]
    v_pk_mul_f32 v[92:93], v[58:59], v[42:43]
    v_pk_fma_f32 v[82:83], v[84:85], v[54:55], v[102:103]
    v_pk_mul_f32 v[94:95], v[58:59], v[40:41]
    v_mfma_f32_16x16x32_f16 v[192:195], v[180:183], v[148:151], v[192:195]
    v_cvt_pk_f16_f32 v104, v80, v81
    v_pk_fma_f32 v[16:17], v[56:57], v[40:41], v[92:93] neg_lo:[0,0,1] neg_hi:[0,0,1]
    v_cvt_pk_f16_f32 v105, v82, v83
    v_mfma_f32_16x16x32_f16 v[192:195], v[184:187], v[152:155], v[192:195]
    v_pk_fma_f32 v[18:19], v[56:57], v[42:43], v[94:95]
    ds_write_b64 v6, v[104:105] offset:9504
    v_cvt_pk_f16_f32 v98, v16, v17
    v_mfma_f32_16x16x32_f16 v[192:195], v[188:191], v[156:159], v[192:195]
    v_pk_mul_f32 v[100:101], v[82:83], v[54:55]
    v_cvt_pk_f16_f32 v99, v18, v19
    v_pk_mul_f32 v[102:103], v[82:83], v[52:53]
    ds_write_b64 v6, v[98:99] offset:1584
    v_pk_fma_f32 v[84:85], v[80:81], v[52:53], v[100:101] neg_lo:[0,0,1] neg_hi:[0,0,1]
    v_cvt_pk_f16_f32 v96, v60, v61
    v_pk_fma_f32 v[86:87], v[80:81], v[54:55], v[102:103]
    v_cvt_pk_f16_f32 v97, v62, v63
    v_cvt_pk_f16_f32 v106, v84, v85
    ds_write_b64 v6, v[96:97] offset:2112
    v_cvt_pk_f16_f32 v107, v86, v87
    v_pk_mul_f32 v[92:93], v[62:63], v[26:27]
    ds_write_b64 v6, v[106:107] offset:10032
    v_pk_mul_f32 v[94:95], v[62:63], v[24:25]
    v_pk_mul_f32 v[100:101], v[86:87], v[54:55]
    v_pk_fma_f32 v[16:17], v[60:61], v[24:25], v[92:93] neg_lo:[0,0,1] neg_hi:[0,0,1]
    v_pk_mul_f32 v[102:103], v[86:87], v[52:53]
    v_pk_fma_f32 v[18:19], v[60:61], v[26:27], v[94:95]
    v_pk_fma_f32 v[80:81], v[84:85], v[52:53], v[100:101] neg_lo:[0,0,1] neg_hi:[0,0,1]
    v_cvt_pk_f16_f32 v98, v16, v17
    v_pk_fma_f32 v[82:83], v[84:85], v[54:55], v[102:103]
    v_cvt_pk_f16_f32 v99, v18, v19
    v_cvt_pk_f16_f32 v104, v80, v81
    ds_write_b64 v6, v[98:99] offset:2640
    v_cvt_pk_f16_f32 v105, v82, v83
    v_pk_mul_f32 v[92:93], v[62:63], v[34:35]
    ds_write_b64 v6, v[104:105] offset:10560
    v_pk_mul_f32 v[94:95], v[62:63], v[32:33]
    v_pk_mul_f32 v[100:101], v[82:83], v[54:55]
    v_pk_fma_f32 v[88:89], v[60:61], v[32:33], v[92:93] neg_lo:[0,0,1] neg_hi:[0,0,1]
    v_pk_mul_f32 v[102:103], v[82:83], v[52:53]
    v_pk_fma_f32 v[90:91], v[60:61], v[34:35], v[94:95]
    v_pk_fma_f32 v[84:85], v[80:81], v[52:53], v[100:101] neg_lo:[0,0,1] neg_hi:[0,0,1]
    v_cvt_pk_f16_f32 v96, v88, v89
    v_pk_fma_f32 v[86:87], v[80:81], v[54:55], v[102:103]
    v_cvt_pk_f16_f32 v97, v90, v91
    v_cvt_pk_f16_f32 v106, v84, v85
    ds_write_b64 v6, v[96:97] offset:3168
    v_cvt_pk_f16_f32 v107, v86, v87
    v_pk_mul_f32 v[92:93], v[62:63], v[42:43]
    ds_write_b64 v6, v[106:107] offset:11088
    v_pk_mul_f32 v[94:95], v[62:63], v[40:41]
    v_pk_mul_f32 v[100:101], v[86:87], v[54:55]
    v_pk_fma_f32 v[16:17], v[60:61], v[40:41], v[92:93] neg_lo:[0,0,1] neg_hi:[0,0,1]
    v_pk_mul_f32 v[102:103], v[86:87], v[52:53]
    v_pk_fma_f32 v[18:19], v[60:61], v[42:43], v[94:95]
    v_pk_fma_f32 v[80:81], v[84:85], v[52:53], v[100:101] neg_lo:[0,0,1] neg_hi:[0,0,1]
    v_cvt_pk_f16_f32 v98, v16, v17
    v_pk_fma_f32 v[82:83], v[84:85], v[54:55], v[102:103]
    v_cvt_pk_f16_f32 v99, v18, v19
    v_cvt_pk_f16_f32 v104, v80, v81
    ds_write_b64 v6, v[98:99] offset:3696
    v_cvt_pk_f16_f32 v105, v82, v83
    v_cvt_pk_f16_f32 v96, v64, v65
    ds_write_b64 v6, v[104:105] offset:11616
    v_cvt_pk_f16_f32 v97, v66, v67
    v_pk_mul_f32 v[100:101], v[82:83], v[54:55]
    ds_write_b64 v6, v[96:97] offset:4224
    v_pk_mul_f32 v[102:103], v[82:83], v[52:53]
L_pad_k1_kernel_0:
    s_cbranch_execz L_ret_k1_kernel_0
    v_pk_mul_f32 v[92:93], v[66:67], v[34:35]
    v_pk_fma_f32 v[84:85], v[80:81], v[52:53], v[100:101] neg_lo:[0,0,1] neg_hi:[0,0,1]
    v_pk_mul_f32 v[94:95], v[66:67], v[32:33]
    v_pk_fma_f32 v[86:87], v[80:81], v[54:55], v[102:103]
    v_pk_fma_f32 v[16:17], v[64:65], v[32:33], v[92:93] neg_lo:[0,0,1] neg_hi:[0,0,1]
    v_cvt_pk_f16_f32 v106, v84, v85
    v_pk_fma_f32 v[18:19], v[64:65], v[34:35], v[94:95]
    v_cvt_pk_f16_f32 v107, v86, v87
    v_cvt_pk_f16_f32 v98, v16, v17
    ds_write_b64 v6, v[106:107] offset:12144
    v_cvt_pk_f16_f32 v99, v18, v19
    v_pk_mul_f32 v[100:101], v[86:87], v[54:55]
    ds_write_b64 v6, v[98:99] offset:4752
    v_pk_mul_f32 v[102:103], v[86:87], v[52:53]
    v_cvt_pk_f16_f32 v96, v68, v69
    v_pk_fma_f32 v[80:81], v[84:85], v[52:53], v[100:101] neg_lo:[0,0,1] neg_hi:[0,0,1]
    v_cvt_pk_f16_f32 v97, v70, v71
    v_pk_fma_f32 v[82:83], v[84:85], v[54:55], v[102:103]
    ds_write_b64 v6, v[96:97] offset:5280
    v_cvt_pk_f16_f32 v104, v80, v81
    v_pk_mul_f32 v[92:93], v[70:71], v[34:35]
    v_cvt_pk_f16_f32 v105, v82, v83
    v_pk_mul_f32 v[94:95], v[70:71], v[32:33]
    ds_write_b64 v6, v[104:105] offset:12672
    v_pk_fma_f32 v[16:17], v[68:69], v[32:33], v[92:93] neg_lo:[0,0,1] neg_hi:[0,0,1]
    v_pk_fma_f32 v[18:19], v[68:69], v[34:35], v[94:95]
    v_cvt_pk_f16_f32 v98, v16, v17
    v_cvt_pk_f16_f32 v99, v18, v19
    ds_write_b64 v6, v[98:99] offset:5808
    v_cvt_pk_f16_f32 v96, v72, v73
    v_cvt_pk_f16_f32 v97, v74, v75
    ds_write_b64 v6, v[96:97] offset:6336
    v_pk_mul_f32 v[92:93], v[74:75], v[34:35]
    v_pk_mul_f32 v[94:95], v[74:75], v[32:33]
    v_pk_fma_f32 v[16:17], v[72:73], v[32:33], v[92:93] neg_lo:[0,0,1] neg_hi:[0,0,1]
    v_pk_fma_f32 v[18:19], v[72:73], v[34:35], v[94:95]
    v_cvt_pk_f16_f32 v98, v16, v17
    v_cvt_pk_f16_f32 v99, v18, v19
    ds_write_b64 v6, v[98:99] offset:6864
    v_cvt_pk_f16_f32 v96, v76, v77
    v_cvt_pk_f16_f32 v97, v78, v79
    ds_write_b64 v6, v[96:97] offset:7392
    v_pk_mul_f32 v[92:93], v[78:79], v[34:35]
    v_pk_mul_f32 v[94:95], v[78:79], v[32:33]
    v_pk_fma_f32 v[16:17], v[76:77], v[32:33], v[92:93] neg_lo:[0,0,1] neg_hi:[0,0,1]
    v_pk_fma_f32 v[18:19], v[76:77], v[34:35], v[94:95]
    v_cvt_pk_f16_f32 v98, v16, v17
    v_cvt_pk_f16_f32 v99, v18, v19
    ds_write_b64 v6, v[98:99] offset:7920
    ds_read_b128 v[160:163], v7 offset:0
    ds_read_b128 v[164:167], v7 offset:64
    ds_read_b128 v[168:171], v7 offset:128
    ds_read_b128 v[172:175], v7 offset:192
    ds_read_b128 v[176:179], v7 offset:256
    ds_read_b128 v[180:183], v7 offset:320
    ds_read_b128 v[184:187], v7 offset:384
    ds_read_b128 v[188:191], v7 offset:448
    ds_read_b128 v[20:23], v7 offset:8448
    ds_read_b128 v[24:27], v7 offset:8512
    ds_read_b128 v[28:31], v7 offset:8576
    ds_read_b128 v[32:35], v7 offset:8640
    ds_read_b128 v[36:39], v7 offset:8704
    ds_read_b128 v[40:43], v7 offset:8768
    ds_read_b128 v[44:47], v7 offset:8832
    ds_read_b128 v[48:51], v7 offset:8896
    s_waitcnt lgkmcnt(15)
    v_mfma_f32_16x16x32_f16 v[196:199], v[160:163], v[128:131], 0
    s_waitcnt lgkmcnt(14)
    v_mfma_f32_16x16x32_f16 v[196:199], v[164:167], v[132:135], v[196:199]
    s_waitcnt lgkmcnt(13)
    v_mfma_f32_16x16x32_f16 v[196:199], v[168:171], v[136:139], v[196:199]
    s_waitcnt lgkmcnt(12)
    v_mfma_f32_16x16x32_f16 v[196:199], v[172:175], v[140:143], v[196:199]
    s_waitcnt lgkmcnt(11)
    v_mfma_f32_16x16x32_f16 v[196:199], v[176:179], v[144:147], v[196:199]
    s_waitcnt lgkmcnt(10)
    v_mfma_f32_16x16x32_f16 v[196:199], v[180:183], v[148:151], v[196:199]
    s_waitcnt lgkmcnt(9)
    v_mfma_f32_16x16x32_f16 v[196:199], v[184:187], v[152:155], v[196:199]
    s_waitcnt lgkmcnt(8)
    v_mfma_f32_16x16x32_f16 v[196:199], v[188:191], v[156:159], v[196:199]
    s_waitcnt lgkmcnt(7)
    v_mfma_f32_16x16x32_f16 v[200:203], v[20:23], v[128:131], 0
    s_waitcnt lgkmcnt(6)
    v_mfma_f32_16x16x32_f16 v[200:203], v[24:27], v[132:135], v[200:203]
    s_waitcnt lgkmcnt(5)
    v_mfma_f32_16x16x32_f16 v[200:203], v[28:31], v[136:139], v[200:203]
    s_waitcnt lgkmcnt(4)
    v_mfma_f32_16x16x32_f16 v[200:203], v[32:35], v[140:143], v[200:203]
    s_waitcnt lgkmcnt(3)
    v_mfma_f32_16x16x32_f16 v[200:203], v[36:39], v[144:147], v[200:203]
    s_waitcnt lgkmcnt(2)
    v_mfma_f32_16x16x32_f16 v[200:203], v[40:43], v[148:151], v[200:203]
    s_waitcnt lgkmcnt(1)
    v_mfma_f32_16x16x32_f16 v[200:203], v[44:47], v[152:155], v[200:203]
    s_waitcnt lgkmcnt(0)
    v_mfma_f32_16x16x32_f16 v[200:203], v[48:51], v[156:159], v[200:203]
    v_cvt_pk_f16_f32 v192, v192, v193
    v_cvt_pk_f16_f32 v193, v194, v195
    ds_write_b64 v120, v[192:193]
    v_cvt_pk_f16_f32 v196, v196, v197
    v_cvt_pk_f16_f32 v197, v198, v199
    ds_write_b16 v121, v196
    ds_write_b16_d16_hi v122, v196
    ds_write_b16 v123, v197
    ds_write_b16_d16_hi v124, v197
    v_cvt_pk_f16_f32 v200, v200, v201
    v_cvt_pk_f16_f32 v201, v202, v203
    ds_write_b16 v125, v200 offset:2048
    ds_write_b16_d16_hi v125, v200 offset:2304
    ds_write_b16 v125, v201 offset:2560
    ds_write_b16_d16_hi v125, v201 offset:2816
    ds_read_b128 v[8:11], v127
    ds_read_u16 v12, v127 offset:16
    ds_read_u16 v13, v127 offset:1024
    ds_read_u16 v14, v127 offset:1032
    ds_read_u16 v15, v127 offset:1040
    ds_read_u16 v16, v127 offset:2048
    ds_read_u16 v17, v127 offset:2064
    ds_read_u16 v18, v127 offset:3072
    ds_read_u16 v19, v127 offset:3088
    s_lshl_b32 s51, s48, 12
    s_add_u32 s51, s51, 5242880
    s_mov_b32 s60, 0xaaaaaaaa
    s_mov_b32 s61, 0xaaaaaaaa
    s_waitcnt lgkmcnt(7)
    v_perm_b32 v20, v8, v8, s57
    v_perm_b32 v21, v10, v9, s57
    v_perm_b32 v22, v10, v10, s57
    v_perm_b32 v23, v12, v11, s57
    v_cndmask_b32 v20, v20, v8, vcc
    v_cndmask_b32 v21, v21, v9, vcc
    v_cndmask_b32 v22, v22, v10, vcc
    v_cndmask_b32 v23, v23, v11, vcc
    buffer_store_dwordx4 v[20:23], v126, s[24:27], s51 offen sc1
    s_waitcnt lgkmcnt(4)
    v_perm_b32 v24, v13, v13, s57
    v_perm_b32 v25, v14, v13, s57
    v_perm_b32 v26, v14, v14, s57
    v_perm_b32 v27, v15, v15, s57
    buffer_store_dwordx4 v[24:27], v126, s[24:27], s51 offen offset:1024 sc1
    s_waitcnt lgkmcnt(2)
    v_perm_b32 v28, v16, v16, s57
    v_cndmask_b32_e64 v30, v16, v17, s[60:61]
    v_perm_b32 v31, v17, v17, s57
    v_mov_b32 v29, v28
    v_perm_b32 v30, v17, v30, s57
    buffer_store_dwordx4 v[28:31], v126, s[24:27], s51 offen offset:2048 sc1
    s_waitcnt lgkmcnt(0)
    v_perm_b32 v32, v18, v18, s57
    v_cndmask_b32_e64 v34, v18, v19, s[60:61]
    v_perm_b32 v35, v19, v19, s57
    v_mov_b32 v33, v32
    v_perm_b32 v34, v19, v34, s57
    buffer_store_dwordx4 v[32:35], v126, s[24:27], s51 offen offset:3072 sc1
    s_branch k1_kernel_x
k1_kernel_ln:
    v_mul_u32_u24 v6, 1216, v3
    v_lshl_add_u32 v6, v4, 4, v6
    v_add_u32 v6, s37, v6
    v_bfe_u32 v7, v1, 2, 2
    v_mul_u32_u24 v7, 1216, v7
    v_lshrrev_b32 v8, 4, v1
    v_lshl_add_u32 v7, v8, 5, v7
    v_and_b32 v8, 3, v1
    v_lshl_add_u32 v7, v8, 3, v7
    v_add_u32 v7, s37, v7
    v_lshlrev_b32 v8, 4, v1
    v_mov_b32 v9, 0x3f803f80
    v_mov_b32 v10, 0
    v_mov_b32 v11, 0
    s_mov_b32 s46, 0xffff0000
    v_lshlrev_b32 v2, 8, v4
    v_lshl_add_u32 v2, v3, 4, v2
    s_lshr_b32 s43, s2, 1
    s_mul_i32 s43, s43, 18432
    s_and_b32 s44, s2, 1
    s_lshl_b32 s44, s44, 7
    s_add_u32 s43, s43, s44
    s_add_u32 s43, s43, 2621440
    s_mov_b64 exec, 0
    s_branch L_pad_k1_kernel_1
L_ret_k1_kernel_1:
    s_mov_b64 exec, -1
    s_setprio 2
    s_waitcnt vmcnt(8)
    v_dot2c_f32_bf16 v10, v16, v9
    v_lshlrev_b32 v52, 16, v16
    v_and_b32 v53, s46, v16
    v_dot2c_f32_bf16 v11, v17, v9
    v_lshlrev_b32 v54, 16, v17
    v_and_b32 v55, s46, v17
    v_dot2c_f32_bf16 v10, v18, v9
    v_lshlrev_b32 v56, 16, v18
    v_and_b32 v57, s46, v18
    v_dot2c_f32_bf16 v11, v19, v9
    v_lshlrev_b32 v58, 16, v19
    v_and_b32 v59, s46, v19
    s_waitcnt vmcnt(7)
    v_dot2c_f32_bf16 v10, v20, v9
    v_lshlrev_b32 v60, 16, v20
    v_and_b32 v61, s46, v20
    v_dot2c_f32_bf16 v11, v21, v9
    v_lshlrev_b32 v62, 16, v21
    v_and_b32 v63, s46, v21
    v_dot2c_f32_bf16 v10, v22, v9
    v_lshlrev_b32 v64, 16, v22
    v_and_b32 v65, s46, v22
    v_dot2c_f32_bf16 v11, v23, v9
    v_lshlrev_b32 v66, 16, v23
    v_and_b32 v67, s46, v23
    s_waitcnt vmcnt(6)
    v_dot2c_f32_bf16 v10, v24, v9
    v_lshlrev_b32 v68, 16, v24
    v_and_b32 v69, s46, v24
    v_dot2c_f32_bf16 v11, v25, v9
    v_lshlrev_b32 v70, 16, v25
    v_and_b32 v71, s46, v25
    v_dot2c_f32_bf16 v10, v26, v9
    v_lshlrev_b32 v72, 16, v26
    v_and_b32 v73, s46, v26
    v_dot2c_f32_bf16 v11, v27, v9
    v_lshlrev_b32 v74, 16, v27
    v_and_b32 v75, s46, v27
    s_waitcnt vmcnt(5)
    v_dot2c_f32_bf16 v10, v28, v9
    v_lshlrev_b32 v76, 16, v28
    v_and_b32 v77, s46, v28
    v_dot2c_f32_bf16 v11, v29, v9
    v_lshlrev_b32 v78, 16, v29
    v_and_b32 v79, s46, v29
    v_dot2c_f32_bf16 v10, v30, v9
    v_lshlrev_b32 v80, 16, v30
    v_and_b32 v81, s46, v30
    v_dot2c_f32_bf16 v11, v31, v9
    v_lshlrev_b32 v82, 16, v31
    v_and_b32 v83, s46, v31
    s_waitcnt vmcnt(4)
    v_dot2c_f32_bf16 v10, v32, v9
    v_lshlrev_b32 v84, 16, v32
    v_and_b32 v85, s46, v32
    v_dot2c_f32_bf16 v11, v33, v9
    v_lshlrev_b32 v86, 16, v33
    v_and_b32 v87, s46, v33
    v_dot2c_f32_bf16 v10, v34, v9
    v_lshlrev_b32 v88, 16, v34
    v_and_b32 v89, s46, v34
    v_dot2c_f32_bf16 v11, v35, v9
    v_lshlrev_b32 v90, 16, v35
    v_and_b32 v91, s46, v35
    s_waitcnt vmcnt(3)
    v_dot2c_f32_bf16 v10, v36, v9
    v_lshlrev_b32 v92, 16, v36
    v_and_b32 v93, s46, v36
    v_dot2c_f32_bf16 v11, v37, v9
    v_lshlrev_b32 v94, 16, v37
    v_and_b32 v95, s46, v37
    v_dot2c_f32_bf16 v10, v38, v9
    v_lshlrev_b32 v96, 16, v38
    v_and_b32 v97, s46, v38
    v_dot2c_f32_bf16 v11, v39, v9
    v_lshlrev_b32 v98, 16, v39
    v_and_b32 v99, s46, v39
    s_waitcnt vmcnt(2)
    v_dot2c_f32_bf16 v10, v40, v9
    v_lshlrev_b32 v100, 16, v40
    v_and_b32 v101, s46, v40
    v_dot2c_f32_bf16 v11, v41, v9
    v_lshlrev_b32 v102, 16, v41
    v_and_b32 v103, s46, v41
    v_dot2c_f32_bf16 v10, v42, v9
    v_lshlrev_b32 v104, 16, v42
    v_and_b32 v105, s46, v42
    v_dot2c_f32_bf16 v11, v43, v9
    v_lshlrev_b32 v106, 16, v43
    v_and_b32 v107, s46, v43
    s_waitcnt vmcnt(1)
    v_dot2c_f32_bf16 v10, v44, v9
    v_lshlrev_b32 v108, 16, v44
    v_and_b32 v109, s46, v44
    v_dot2c_f32_bf16 v11, v45, v9
    v_lshlrev_b32 v110, 16, v45
    v_and_b32 v111, s46, v45
    v_dot2c_f32_bf16 v10, v46, v9
    v_lshlrev_b32 v112, 16, v46
    v_and_b32 v113, s46, v46
    v_dot2c_f32_bf16 v11, v47, v9
    v_lshlrev_b32 v114, 16, v47
    v_and_b32 v115, s46, v47
    s_waitcnt vmcnt(0)
    v_dot2c_f32_bf16 v10, v48, v9
    v_lshlrev_b32 v116, 16, v48
    v_and_b32 v117, s46, v48
    v_dot2c_f32_bf16 v11, v49, v9
    v_lshlrev_b32 v118, 16, v49
    v_and_b32 v119, s46, v49
    v_dot2c_f32_bf16 v10, v50, v9
    v_lshlrev_b32 v120, 16, v50
    v_and_b32 v121, s46, v50
    v_dot2c_f32_bf16 v11, v51, v9
    v_lshlrev_b32 v122, 16, v51
    v_and_b32 v123, s46, v51
    s_nop 0
    v_add_f32 v10, v10, v11
    s_nop 1
    v_add_f32_dpp v10, v10, v10 quad_perm:[1,0,3,2] row_mask:0xf bank_mask:0xf
    s_nop 1
    v_add_f32_dpp v10, v10, v10 quad_perm:[2,3,0,1] row_mask:0xf bank_mask:0xf
    s_nop 1
    v_add_f32_dpp v10, v10, v10 row_half_mirror row_mask:0xf bank_mask:0xf
    v_mul_f32 v10, 0xbae38e39, v10
    v_mov_b32 v11, v10
    v_mov_b32 v12, 0
    v_mov_b32 v13, 0
    v_mov_b32 v124, 0
    v_mov_b32 v125, 0
    v_pk_add_f32 v[126:127], v[52:53], v[10:11]
    v_pk_fma_f32 v[124:125], v[126:127], v[126:127], v[124:125]
    v_pk_add_f32 v[14:15], v[54:55], v[10:11]
    v_pk_fma_f32 v[12:13], v[14:15], v[14:15], v[12:13]
    v_pk_add_f32 v[126:127], v[56:57], v[10:11]
    v_pk_fma_f32 v[124:125], v[126:127], v[126:127], v[124:125]
    v_pk_add_f32 v[14:15], v[58:59], v[10:11]
    v_pk_fma_f32 v[12:13], v[14:15], v[14:15], v[12:13]
    buffer_store_dwordx4 v[16:19], v2, s[24:27], s43 offen offset:0 sc1
    v_pk_add_f32 v[126:127], v[60:61], v[10:11]
    v_pk_fma_f32 v[124:125], v[126:127], v[126:127], v[124:125]
    v_pk_add_f32 v[14:15], v[62:63], v[10:11]
    v_pk_fma_f32 v[12:13], v[14:15], v[14:15], v[12:13]
    v_pk_add_f32 v[126:127], v[64:65], v[10:11]
    v_pk_fma_f32 v[124:125], v[126:127], v[126:127], v[124:125]
    v_pk_add_f32 v[14:15], v[66:67], v[10:11]
    v_pk_fma_f32 v[12:13], v[14:15], v[14:15], v[12:13]
    buffer_store_dwordx4 v[20:23], v2, s[24:27], s43 offen offset:2048 sc1
    s_add_u32 s43, s43, 4096
    v_pk_add_f32 v[126:127], v[68:69], v[10:11]
    v_pk_fma_f32 v[124:125], v[126:127], v[126:127], v[124:125]
    v_pk_add_f32 v[14:15], v[70:71], v[10:11]
    v_pk_fma_f32 v[12:13], v[14:15], v[14:15], v[12:13]
    v_pk_add_f32 v[126:127], v[72:73], v[10:11]
    v_pk_fma_f32 v[124:125], v[126:127], v[126:127], v[124:125]
    v_pk_add_f32 v[14:15], v[74:75], v[10:11]
    v_pk_fma_f32 v[12:13], v[14:15], v[14:15], v[12:13]
    buffer_store_dwordx4 v[24:27], v2, s[24:27], s43 offen offset:0 sc1
    v_pk_add_f32 v[126:127], v[76:77], v[10:11]
    v_pk_fma_f32 v[124:125], v[126:127], v[126:127], v[124:125]
    v_pk_add_f32 v[14:15], v[78:79], v[10:11]
    v_pk_fma_f32 v[12:13], v[14:15], v[14:15], v[12:13]
    v_pk_add_f32 v[126:127], v[80:81], v[10:11]
    v_pk_fma_f32 v[124:125], v[126:127], v[126:127], v[124:125]
    v_pk_add_f32 v[14:15], v[82:83], v[10:11]
    v_pk_fma_f32 v[12:13], v[14:15], v[14:15], v[12:13]
    buffer_store_dwordx4 v[28:31], v2, s[24:27], s43 offen offset:2048 sc1
    s_add_u32 s43, s43, 4096
    v_pk_add_f32 v[126:127], v[84:85], v[10:11]
    v_pk_fma_f32 v[124:125], v[126:127], v[126:127], v[124:125]
    v_pk_add_f32 v[14:15], v[86:87], v[10:11]
    v_pk_fma_f32 v[12:13], v[14:15], v[14:15], v[12:13]
    v_pk_add_f32 v[126:127], v[88:89], v[10:11]
    v_pk_fma_f32 v[124:125], v[126:127], v[126:127], v[124:125]
    v_pk_add_f32 v[14:15], v[90:91], v[10:11]
    v_pk_fma_f32 v[12:13], v[14:15], v[14:15], v[12:13]
    buffer_store_dwordx4 v[32:35], v2, s[24:27], s43 offen offset:0 sc1
    v_pk_add_f32 v[126:127], v[92:93], v[10:11]
    v_pk_fma_f32 v[124:125], v[126:127], v[126:127], v[124:125]
    v_pk_add_f32 v[14:15], v[94:95], v[10:11]
    v_pk_fma_f32 v[12:13], v[14:15], v[14:15], v[12:13]
    v_pk_add_f32 v[126:127], v[96:97], v[10:11]
    v_pk_fma_f32 v[124:125], v[126:127], v[126:127], v[124:125]
    v_pk_add_f32 v[14:15], v[98:99], v[10:11]
    v_pk_fma_f32 v[12:13], v[14:15], v[14:15], v[12:13]
    buffer_store_dwordx4 v[36:39], v2, s[24:27], s43 offen offset:2048 sc1
    s_add_u32 s43, s43, 4096
    v_pk_add_f32 v[126:127], v[100:101], v[10:11]
    v_pk_fma_f32 v[124:125], v[126:127], v[126:127], v[124:125]
    v_pk_add_f32 v[14:15], v[102:103], v[10:11]
    v_pk_fma_f32 v[12:13], v[14:15], v[14:15], v[12:13]
    v_pk_add_f32 v[126:127], v[104:105], v[10:11]
    v_pk_fma_f32 v[124:125], v[126:127], v[126:127], v[124:125]
    v_pk_add_f32 v[14:15], v[106:107], v[10:11]
    v_pk_fma_f32 v[12:13], v[14:15], v[14:15], v[12:13]
    buffer_store_dwordx4 v[40:43], v2, s[24:27], s43 offen offset:0 sc1
    v_pk_add_f32 v[126:127], v[108:109], v[10:11]
    v_pk_fma_f32 v[124:125], v[126:127], v[126:127], v[124:125]
    v_pk_add_f32 v[14:15], v[110:111], v[10:11]
    v_pk_fma_f32 v[12:13], v[14:15], v[14:15], v[12:13]
    v_pk_add_f32 v[126:127], v[112:113], v[10:11]
    v_pk_fma_f32 v[124:125], v[126:127], v[126:127], v[124:125]
    v_pk_add_f32 v[14:15], v[114:115], v[10:11]
    v_pk_fma_f32 v[12:13], v[14:15], v[14:15], v[12:13]
    buffer_store_dwordx4 v[44:47], v2, s[24:27], s43 offen offset:2048 sc1
    s_add_u32 s43, s43, 4096
    v_pk_add_f32 v[126:127], v[116:117], v[10:11]
    v_pk_fma_f32 v[124:125], v[126:127], v[126:127], v[124:125]
    v_pk_add_f32 v[14:15], v[118:119], v[10:11]
    v_pk_fma_f32 v[12:13], v[14:15], v[14:15], v[12:13]
    v_pk_add_f32 v[126:127], v[120:121], v[10:11]
    v_pk_fma_f32 v[124:125], v[126:127], v[126:127], v[124:125]
    v_pk_add_f32 v[14:15], v[122:123], v[10:11]
    v_pk_fma_f32 v[12:13], v[14:15], v[14:15], v[12:13]
    buffer_store_dwordx4 v[48:51], v2, s[24:27], s43 offen offset:0 sc1
    v_pk_add_f32 v[12:13], v[12:13], v[124:125]
    v_add_f32 v12, v12, v13
    s_nop 1
    v_add_f32_dpp v12, v12, v12 quad_perm:[1,0,3,2] row_mask:0xf bank_mask:0xf
    s_nop 1
    v_add_f32_dpp v12, v12, v12 quad_perm:[2,3,0,1] row_mask:0xf bank_mask:0xf
    s_nop 1
    v_add_f32_dpp v12, v12, v12 row_half_mirror row_mask:0xf bank_mask:0xf
    v_mul_f32 v12, 0x3ae38e39, v12
    v_cvt_pk_bf16_f32 v13, v12, v10
    v_and_b32 v10, s46, v13
    v_mov_b32 v11, v10
    v_lshlrev_b32 v12, 16, v13
    v_pk_add_f32 v[52:53], v[52:53], v[10:11]
    v_pk_add_f32 v[54:55], v[54:55], v[10:11]
    v_add_f32 v12, 0x3727c5ac, v12
    v_pk_add_f32 v[56:57], v[56:57], v[10:11]
    v_pk_add_f32 v[58:59], v[58:59], v[10:11]
    v_cvt_pk_bf16_f32 v12, v12, v12
    v_pk_add_f32 v[60:61], v[60:61], v[10:11]
    v_pk_add_f32 v[62:63], v[62:63], v[10:11]
    v_lshlrev_b32 v12, 16, v12
    v_pk_add_f32 v[64:65], v[64:65], v[10:11]
    v_pk_add_f32 v[66:67], v[66:67], v[10:11]
    v_sqrt_f32 v12, v12
    v_pk_add_f32 v[68:69], v[68:69], v[10:11]
    v_pk_add_f32 v[70:71], v[70:71], v[10:11]
    v_cvt_pk_bf16_f32 v12, v12, v12
    v_pk_add_f32 v[72:73], v[72:73], v[10:11]
    v_pk_add_f32 v[74:75], v[74:75], v[10:11]
    v_lshlrev_b32 v12, 16, v12
    v_pk_add_f32 v[76:77], v[76:77], v[10:11]
    v_pk_add_f32 v[78:79], v[78:79], v[10:11]
    v_rcp_f32 v12, v12
    v_pk_add_f32 v[80:81], v[80:81], v[10:11]
    v_pk_add_f32 v[82:83], v[82:83], v[10:11]
    v_mul_f32 v12, 0x45000000, v12
    v_pk_add_f32 v[84:85], v[84:85], v[10:11]
    v_pk_add_f32 v[86:87], v[86:87], v[10:11]
    v_mov_b32 v13, v12
    v_pk_add_f32 v[88:89], v[88:89], v[10:11]
    v_pk_add_f32 v[90:91], v[90:91], v[10:11]
    v_pk_add_f32 v[92:93], v[92:93], v[10:11]
    v_pk_add_f32 v[94:95], v[94:95], v[10:11]
    v_pk_add_f32 v[96:97], v[96:97], v[10:11]
    v_pk_add_f32 v[98:99], v[98:99], v[10:11]
    v_pk_add_f32 v[100:101], v[100:101], v[10:11]
    v_pk_add_f32 v[102:103], v[102:103], v[10:11]
    v_pk_add_f32 v[104:105], v[104:105], v[10:11]
    v_pk_add_f32 v[106:107], v[106:107], v[10:11]
    v_pk_add_f32 v[108:109], v[108:109], v[10:11]
    v_pk_add_f32 v[110:111], v[110:111], v[10:11]
    v_pk_add_f32 v[112:113], v[112:113], v[10:11]
    v_pk_add_f32 v[114:115], v[114:115], v[10:11]
    v_pk_add_f32 v[116:117], v[116:117], v[10:11]
    v_pk_add_f32 v[118:119], v[118:119], v[10:11]
    v_pk_add_f32 v[120:121], v[120:121], v[10:11]
    v_pk_add_f32 v[122:123], v[122:123], v[10:11]
    v_cvt_pk_bf16_f32 v53, v52, v53
    v_cvt_pk_bf16_f32 v55, v54, v55
    v_cvt_pk_bf16_f32 v57, v56, v57
    v_cvt_pk_bf16_f32 v59, v58, v59
    v_cvt_pk_bf16_f32 v61, v60, v61
    v_cvt_pk_bf16_f32 v63, v62, v63
    v_cvt_pk_bf16_f32 v65, v64, v65
    v_cvt_pk_bf16_f32 v67, v66, v67
    v_cvt_pk_bf16_f32 v69, v68, v69
    v_cvt_pk_bf16_f32 v71, v70, v71
    v_cvt_pk_bf16_f32 v73, v72, v73
    v_cvt_pk_bf16_f32 v75, v74, v75
    v_cvt_pk_bf16_f32 v77, v76, v77
    v_cvt_pk_bf16_f32 v79, v78, v79
    v_cvt_pk_bf16_f32 v81, v80, v81
    v_cvt_pk_bf16_f32 v83, v82, v83
    v_cvt_pk_bf16_f32 v85, v84, v85
    v_cvt_pk_bf16_f32 v87, v86, v87
    v_cvt_pk_bf16_f32 v89, v88, v89
    v_cvt_pk_bf16_f32 v91, v90, v91
    v_cvt_pk_bf16_f32 v93, v92, v93
    v_cvt_pk_bf16_f32 v95, v94, v95
    v_cvt_pk_bf16_f32 v97, v96, v97
    v_cvt_pk_bf16_f32 v99, v98, v99
    v_cvt_pk_bf16_f32 v101, v100, v101
    v_cvt_pk_bf16_f32 v103, v102, v103
    v_cvt_pk_bf16_f32 v105, v104, v105
    v_cvt_pk_bf16_f32 v107, v106, v107
    v_cvt_pk_bf16_f32 v109, v108, v109
    v_cvt_pk_bf16_f32 v111, v110, v111
    v_cvt_pk_bf16_f32 v113, v112, v113
    v_cvt_pk_bf16_f32 v115, v114, v115
    v_cvt_pk_bf16_f32 v117, v116, v117
    v_cvt_pk_bf16_f32 v119, v118, v119
    v_cvt_pk_bf16_f32 v121, v120, v121
    v_cvt_pk_bf16_f32 v123, v122, v123
    v_lshlrev_b32 v52, 16, v53
    v_and_b32 v53, s46, v53
    v_lshlrev_b32 v54, 16, v55
    v_and_b32 v55, s46, v55
    v_lshlrev_b32 v56, 16, v57
    v_and_b32 v57, s46, v57
    v_lshlrev_b32 v58, 16, v59
    v_and_b32 v59, s46, v59
    v_lshlrev_b32 v60, 16, v61
    v_and_b32 v61, s46, v61
    v_lshlrev_b32 v62, 16, v63
    v_and_b32 v63, s46, v63
    v_lshlrev_b32 v64, 16, v65
    v_and_b32 v65, s46, v65
    v_lshlrev_b32 v66, 16, v67
    v_and_b32 v67, s46, v67
    v_lshlrev_b32 v68, 16, v69
    v_and_b32 v69, s46, v69
    v_lshlrev_b32 v70, 16, v71
    v_and_b32 v71, s46, v71
    v_lshlrev_b32 v72, 16, v73
    v_and_b32 v73, s46, v73
    v_lshlrev_b32 v74, 16, v75
    v_and_b32 v75, s46, v75
    v_lshlrev_b32 v76, 16, v77
    v_and_b32 v77, s46, v77
    v_lshlrev_b32 v78, 16, v79
    v_and_b32 v79, s46, v79
    v_lshlrev_b32 v80, 16, v81
    v_and_b32 v81, s46, v81
    v_lshlrev_b32 v82, 16, v83
    v_and_b32 v83, s46, v83
    v_lshlrev_b32 v84, 16, v85
    v_and_b32 v85, s46, v85
    v_lshlrev_b32 v86, 16, v87
    v_and_b32 v87, s46, v87
    v_lshlrev_b32 v88, 16, v89
    v_and_b32 v89, s46, v89
    v_lshlrev_b32 v90, 16, v91
    v_and_b32 v91, s46, v91
    v_lshlrev_b32 v92, 16, v93
    v_and_b32 v93, s46, v93
    v_lshlrev_b32 v94, 16, v95
    v_and_b32 v95, s46, v95
    v_lshlrev_b32 v96, 16, v97
    v_and_b32 v97, s46, v97
    v_lshlrev_b32 v98, 16, v99
    v_and_b32 v99, s46, v99
    v_lshlrev_b32 v100, 16, v101
    v_and_b32 v101, s46, v101
    v_lshlrev_b32 v102, 16, v103
    v_and_b32 v103, s46, v103
    v_lshlrev_b32 v104, 16, v105
    v_and_b32 v105, s46, v105
    v_lshlrev_b32 v106, 16, v107
    v_and_b32 v107, s46, v107
    v_lshlrev_b32 v108, 16, v109
    v_and_b32 v109, s46, v109
    v_lshlrev_b32 v110, 16, v111
    v_and_b32 v111, s46, v111
    v_lshlrev_b32 v112, 16, v113
    v_and_b32 v113, s46, v113
    v_lshlrev_b32 v114, 16, v115
    v_and_b32 v115, s46, v115
    v_lshlrev_b32 v116, 16, v117
    v_and_b32 v117, s46, v117
    v_lshlrev_b32 v118, 16, v119
    v_and_b32 v119, s46, v119
    v_lshlrev_b32 v120, 16, v121
    v_and_b32 v121, s46, v121
    v_lshlrev_b32 v122, 16, v123
    v_and_b32 v123, s46, v123
    v_pk_mul_f32 v[52:53], v[52:53], v[12:13]
    v_pk_mul_f32 v[54:55], v[54:55], v[12:13]
    v_pk_mul_f32 v[56:57], v[56:57], v[12:13]
    v_pk_mul_f32 v[58:59], v[58:59], v[12:13]
    v_pk_mul_f32 v[60:61], v[60:61], v[12:13]
    v_pk_mul_f32 v[62:63], v[62:63], v[12:13]
    v_pk_mul_f32 v[64:65], v[64:65], v[12:13]
    v_pk_mul_f32 v[66:67], v[66:67], v[12:13]
    v_pk_mul_f32 v[68:69], v[68:69], v[12:13]
    v_pk_mul_f32 v[70:71], v[70:71], v[12:13]
    v_pk_mul_f32 v[72:73], v[72:73], v[12:13]
    v_pk_mul_f32 v[74:75], v[74:75], v[12:13]
    v_pk_mul_f32 v[76:77], v[76:77], v[12:13]
    v_pk_mul_f32 v[78:79], v[78:79], v[12:13]
    v_pk_mul_f32 v[80:81], v[80:81], v[12:13]
    v_pk_mul_f32 v[82:83], v[82:83], v[12:13]
    v_pk_mul_f32 v[84:85], v[84:85], v[12:13]
    v_pk_mul_f32 v[86:87], v[86:87], v[12:13]
    v_pk_mul_f32 v[88:89], v[88:89], v[12:13]
    v_pk_mul_f32 v[90:91], v[90:91], v[12:13]
    v_pk_mul_f32 v[92:93], v[92:93], v[12:13]
    v_pk_mul_f32 v[94:95], v[94:95], v[12:13]
    v_pk_mul_f32 v[96:97], v[96:97], v[12:13]
    v_pk_mul_f32 v[98:99], v[98:99], v[12:13]
    v_pk_mul_f32 v[100:101], v[100:101], v[12:13]
    v_pk_mul_f32 v[102:103], v[102:103], v[12:13]
    v_pk_mul_f32 v[104:105], v[104:105], v[12:13]
    v_pk_mul_f32 v[106:107], v[106:107], v[12:13]
    v_pk_mul_f32 v[108:109], v[108:109], v[12:13]
    v_pk_mul_f32 v[110:111], v[110:111], v[12:13]
    v_pk_mul_f32 v[112:113], v[112:113], v[12:13]
    v_pk_mul_f32 v[114:115], v[114:115], v[12:13]
    v_pk_mul_f32 v[116:117], v[116:117], v[12:13]
    v_pk_mul_f32 v[118:119], v[118:119], v[12:13]
    v_pk_mul_f32 v[120:121], v[120:121], v[12:13]
    v_pk_mul_f32 v[122:123], v[122:123], v[12:13]
    v_cvt_pk_bf16_f32 v53, v52, v53
    v_cvt_pk_bf16_f32 v55, v54, v55
    v_cvt_pk_bf16_f32 v57, v56, v57
    v_cvt_pk_bf16_f32 v59, v58, v59
    v_cvt_pk_bf16_f32 v61, v60, v61
    v_cvt_pk_bf16_f32 v63, v62, v63
    v_cvt_pk_bf16_f32 v65, v64, v65
    v_cvt_pk_bf16_f32 v67, v66, v67
    v_cvt_pk_bf16_f32 v69, v68, v69
    v_cvt_pk_bf16_f32 v71, v70, v71
    v_cvt_pk_bf16_f32 v73, v72, v73
    v_cvt_pk_bf16_f32 v75, v74, v75
    v_cvt_pk_bf16_f32 v77, v76, v77
    v_cvt_pk_bf16_f32 v79, v78, v79
    v_cvt_pk_bf16_f32 v81, v80, v81
    v_cvt_pk_bf16_f32 v83, v82, v83
    v_cvt_pk_bf16_f32 v85, v84, v85
    v_cvt_pk_bf16_f32 v87, v86, v87
    v_cvt_pk_bf16_f32 v89, v88, v89
    v_cvt_pk_bf16_f32 v91, v90, v91
    v_cvt_pk_bf16_f32 v93, v92, v93
    v_cvt_pk_bf16_f32 v95, v94, v95
    v_cvt_pk_bf16_f32 v97, v96, v97
    v_cvt_pk_bf16_f32 v99, v98, v99
    v_cvt_pk_bf16_f32 v101, v100, v101
    v_cvt_pk_bf16_f32 v103, v102, v103
    v_cvt_pk_bf16_f32 v105, v104, v105
    v_cvt_pk_bf16_f32 v107, v106, v107
    v_cvt_pk_bf16_f32 v109, v108, v109
    v_cvt_pk_bf16_f32 v111, v110, v111
    v_cvt_pk_bf16_f32 v113, v112, v113
    v_cvt_pk_bf16_f32 v115, v114, v115
    v_cvt_pk_bf16_f32 v117, v116, v117
    v_cvt_pk_bf16_f32 v119, v118, v119
    v_cvt_pk_bf16_f32 v121, v120, v121
    v_cvt_pk_bf16_f32 v123, v122, v123
    v_lshlrev_b32 v52, 16, v53
    v_and_b32 v53, s46, v53
    v_lshlrev_b32 v54, 16, v55
L_pad_k1_kernel_1:
    s_cbranch_execz L_ret_k1_kernel_1
    v_and_b32 v55, s46, v55
    v_lshlrev_b32 v56, 16, v57
    v_and_b32 v57, s46, v57
    v_lshlrev_b32 v58, 16, v59
    v_and_b32 v59, s46, v59
    v_lshlrev_b32 v60, 16, v61
    v_and_b32 v61, s46, v61
    v_lshlrev_b32 v62, 16, v63
    v_and_b32 v63, s46, v63
    v_lshlrev_b32 v64, 16, v65
    v_and_b32 v65, s46, v65
    v_lshlrev_b32 v66, 16, v67
    v_and_b32 v67, s46, v67
    v_lshlrev_b32 v68, 16, v69
    v_and_b32 v69, s46, v69
    v_lshlrev_b32 v70, 16, v71
    v_and_b32 v71, s46, v71
    v_lshlrev_b32 v72, 16, v73
    v_and_b32 v73, s46, v73
    v_lshlrev_b32 v74, 16, v75
    v_and_b32 v75, s46, v75
    v_lshlrev_b32 v76, 16, v77
    v_and_b32 v77, s46, v77
    v_lshlrev_b32 v78, 16, v79
    v_and_b32 v79, s46, v79
    v_lshlrev_b32 v80, 16, v81
    v_and_b32 v81, s46, v81
    v_lshlrev_b32 v82, 16, v83
    v_and_b32 v83, s46, v83
    v_lshlrev_b32 v84, 16, v85
    v_and_b32 v85, s46, v85
    v_lshlrev_b32 v86, 16, v87
    v_and_b32 v87, s46, v87
    v_lshlrev_b32 v88, 16, v89
    v_and_b32 v89, s46, v89
    v_lshlrev_b32 v90, 16, v91
    v_and_b32 v91, s46, v91
    v_lshlrev_b32 v92, 16, v93
    v_and_b32 v93, s46, v93
    v_lshlrev_b32 v94, 16, v95
    v_and_b32 v95, s46, v95
    v_lshlrev_b32 v96, 16, v97
    v_and_b32 v97, s46, v97
    v_lshlrev_b32 v98, 16, v99
    v_and_b32 v99, s46, v99
    v_lshlrev_b32 v100, 16, v101
    v_and_b32 v101, s46, v101
    v_lshlrev_b32 v102, 16, v103
    v_and_b32 v103, s46, v103
    v_lshlrev_b32 v104, 16, v105
    v_and_b32 v105, s46, v105
    v_lshlrev_b32 v106, 16, v107
    v_and_b32 v107, s46, v107
    v_lshlrev_b32 v108, 16, v109
    v_and_b32 v109, s46, v109
    v_lshlrev_b32 v110, 16, v111
    v_and_b32 v111, s46, v111
    v_lshlrev_b32 v112, 16, v113
    v_and_b32 v113, s46, v113
    v_lshlrev_b32 v114, 16, v115
    v_and_b32 v115, s46, v115
    v_lshlrev_b32 v116, 16, v117
    v_and_b32 v117, s46, v117
    v_lshlrev_b32 v118, 16, v119
    v_and_b32 v119, s46, v119
    v_lshlrev_b32 v120, 16, v121
    v_and_b32 v121, s46, v121
    v_lshlrev_b32 v122, 16, v123
    v_and_b32 v123, s46, v123
    v_cvt_pk_f16_f32 v52, v52, v53
    v_cvt_pk_f16_f32 v53, v54, v55
    v_cvt_pk_f16_f32 v54, v56, v57
    v_cvt_pk_f16_f32 v55, v58, v59
    ds_write_b128 v6, v[52:55] offset:0
    v_cvt_pk_f16_f32 v56, v60, v61
    v_cvt_pk_f16_f32 v57, v62, v63
    v_cvt_pk_f16_f32 v58, v64, v65
    v_cvt_pk_f16_f32 v59, v66, v67
    ds_write_b128 v6, v[56:59] offset:128
    v_cvt_pk_f16_f32 v60, v68, v69
    v_cvt_pk_f16_f32 v61, v70, v71
    v_cvt_pk_f16_f32 v62, v72, v73
    v_cvt_pk_f16_f32 v63, v74, v75
    ds_write_b128 v6, v[60:63] offset:256
    v_cvt_pk_f16_f32 v64, v76, v77
    v_cvt_pk_f16_f32 v65, v78, v79
    v_cvt_pk_f16_f32 v66, v80, v81
    v_cvt_pk_f16_f32 v67, v82, v83
    ds_write_b128 v6, v[64:67] offset:384
    v_cvt_pk_f16_f32 v68, v84, v85
    v_cvt_pk_f16_f32 v69, v86, v87
    v_cvt_pk_f16_f32 v70, v88, v89
    v_cvt_pk_f16_f32 v71, v90, v91
    ds_write_b128 v6, v[68:71] offset:512
    v_cvt_pk_f16_f32 v72, v92, v93
    v_cvt_pk_f16_f32 v73, v94, v95
    v_cvt_pk_f16_f32 v74, v96, v97
    v_cvt_pk_f16_f32 v75, v98, v99
    ds_write_b128 v6, v[72:75] offset:640
    v_cvt_pk_f16_f32 v76, v100, v101
    v_cvt_pk_f16_f32 v77, v102, v103
    v_cvt_pk_f16_f32 v78, v104, v105
    v_cvt_pk_f16_f32 v79, v106, v107
    ds_write_b128 v6, v[76:79] offset:768
    v_cvt_pk_f16_f32 v80, v108, v109
    v_cvt_pk_f16_f32 v81, v110, v111
    v_cvt_pk_f16_f32 v82, v112, v113
    v_cvt_pk_f16_f32 v83, v114, v115
    ds_write_b128 v6, v[80:83] offset:896
    v_cvt_pk_f16_f32 v84, v116, v117
    v_cvt_pk_f16_f32 v85, v118, v119
    v_cvt_pk_f16_f32 v86, v120, v121
    v_cvt_pk_f16_f32 v87, v122, v123
    ds_write_b128 v6, v[84:87] offset:1024
    ds_read_b64_tr_b16 v[88:89], v7 offset:0
    ds_read_b64_tr_b16 v[90:91], v7 offset:4864
    ds_read_b64_tr_b16 v[92:93], v7 offset:128
    ds_read_b64_tr_b16 v[94:95], v7 offset:4992
    ds_read_b64_tr_b16 v[96:97], v7 offset:256
    ds_read_b64_tr_b16 v[98:99], v7 offset:5120
    ds_read_b64_tr_b16 v[100:101], v7 offset:384
    ds_read_b64_tr_b16 v[102:103], v7 offset:5248
    ds_read_b64_tr_b16 v[104:105], v7 offset:512
    ds_read_b64_tr_b16 v[106:107], v7 offset:5376
    ds_read_b64_tr_b16 v[108:109], v7 offset:640
    ds_read_b64_tr_b16 v[110:111], v7 offset:5504
    ds_read_b64_tr_b16 v[112:113], v7 offset:768
    ds_read_b64_tr_b16 v[114:115], v7 offset:5632
    ds_read_b64_tr_b16 v[116:117], v7 offset:896
    ds_read_b64_tr_b16 v[118:119], v7 offset:5760
    ds_read_b64_tr_b16 v[120:121], v7 offset:1024
    ds_read_b64_tr_b16 v[122:123], v7 offset:5888
    s_add_u32 s43, s41, 0
    s_add_u32 s44, s43, 4096
    s_add_u32 s45, s43, 8192
    s_waitcnt lgkmcnt(15)
    buffer_store_dwordx4 v[88:91], v8, s[24:27], s43 offen offset:0 sc1
    s_waitcnt lgkmcnt(14)
    buffer_store_dwordx4 v[92:95], v8, s[24:27], s43 offen offset:1024 sc1
    s_waitcnt lgkmcnt(12)
    buffer_store_dwordx4 v[96:99], v8, s[24:27], s43 offen offset:2048 sc1
    s_waitcnt lgkmcnt(10)
    buffer_store_dwordx4 v[100:103], v8, s[24:27], s43 offen offset:3072 sc1
    s_waitcnt lgkmcnt(8)
    buffer_store_dwordx4 v[104:107], v8, s[24:27], s44 offen offset:0 sc1
    s_waitcnt lgkmcnt(6)
    buffer_store_dwordx4 v[108:111], v8, s[24:27], s44 offen offset:1024 sc1
    s_waitcnt lgkmcnt(4)
    buffer_store_dwordx4 v[112:115], v8, s[24:27], s44 offen offset:2048 sc1
    s_waitcnt lgkmcnt(2)
    buffer_store_dwordx4 v[116:119], v8, s[24:27], s44 offen offset:3072 sc1
    s_waitcnt lgkmcnt(0)
    buffer_store_dwordx4 v[120:123], v8, s[24:27], s45 offen offset:0 sc1
    s_branch k1_kernel_x
k1_kernel_sw:
    s_lshr_b32 s38, s36, 3
    s_cmp_ge_u32 s38, 10
    s_cbranch_scc1 L_pf_skip1
    s_getpc_b64 s[60:61]
L_pf_pc1:
    s_add_u32 s60, s60, k1_kernel-L_pf_pc1
    s_addc_u32 s61, s61, (k1_kernel-L_pf_pc1)>>32
    s_lshl_b32 s62, s38, 13
    v_lshlrev_b32 v100, 7, v1
    v_add_u32 v100, s62, v100
    v_min_u32 v100, L_text_end-k1_kernel-4, v100
    v_mov_b32 v101, s61
    v_add_co_u32 v100, vcc, s60, v100
    s_nop 1
    v_addc_co_u32 v101, vcc, 0, v101, vcc
    global_load_dword v102, v[100:101], off
L_pf_skip1:
    s_cmp_ge_u32 s36, 16
    s_cbranch_scc1 k1_kernel_nz
    v_lshlrev_b32 v100, 7, v1
    v_mov_b32 v101, 0
    s_lshl_b32 s38, s36, 13
    s_add_u32 s38, s38, 13762560
    buffer_store_dword v101, v100, s[24:27], s38 offen sc1
k1_kernel_nz:
    s_mov_b32 s28, s16
    s_and_b32 s29, s17, 0xffff
    s_mov_b32 s30, 5308416
    s_mov_b32 s31, 0x20000
    s_mov_b32 s32, s18
    s_and_b32 s33, s19, 0xffff
    s_mov_b32 s34, 5308416
    s_mov_b32 s35, 0x20000
    s_cmp_ge_u32 s36, 192
    s_cbranch_scc1 k1_kernel_end
    s_mul_i32 s40, s36, 3641
    s_lshr_b32 s40, s40, 18
    s_mul_i32 s43, s40, 72
    s_sub_u32 s41, s36, s43
    v_lshrrev_b32 v10, 3, v1
    v_mul_u32_u24 v8, 9216, v10
    v_and_b32 v10, 2, v10
    v_and_b32 v9, 7, v1
    v_xor_b32 v9, v9, v10
    v_lshl_add_u32 v8, v9, 4, v8
    v_xor_b32 v9, 64, v8
    s_mul_i32 s42, s40, 294912
    s_lshl_b32 s43, s41, 7
    s_add_u32 s42, s42, s43
    s_add_u32 m0, s37, 0
    s_nop 0
    buffer_load_dwordx4 v8, s[28:31], s42 offen nt lds
    s_add_u32 m0, s37, 4096
    s_nop 0
    buffer_load_dwordx4 v8, s[32:35], s42 offen nt lds
    s_add_u32 s42, s42, 73728
    s_add_u32 m0, s37, 1024
    s_nop 0
    buffer_load_dwordx4 v9, s[28:31], s42 offen nt lds
    s_add_u32 m0, s37, 5120
    s_nop 0
    buffer_load_dwordx4 v9, s[32:35], s42 offen nt lds
    s_add_u32 s42, s42, 73728
    s_add_u32 m0, s37, 2048
    s_nop 0
    buffer_load_dwordx4 v8, s[28:31], s42 offen nt lds
    s_add_u32 m0, s37, 6144
    s_nop 0
    buffer_load_dwordx4 v8, s[32:35], s42 offen nt lds
    s_add_u32 s42, s42, 73728
    s_add_u32 m0, s37, 3072
    s_nop 0
    buffer_load_dwordx4 v9, s[28:31], s42 offen nt lds
    s_add_u32 m0, s37, 7168
    s_nop 0
    buffer_load_dwordx4 v9, s[32:35], s42 offen nt lds
    v_lshrrev_b32 v13, 4, v1
    v_lshlrev_b32 v16, 10, v13
    v_and_b32 v13, 1, v13
    v_lshlrev_b32 v13, 6, v13
    v_bfe_u32 v17, v1, 2, 2
    v_lshl_add_u32 v16, v17, 7, v16
    v_bfe_u32 v17, v1, 3, 1
    v_lshl_add_u32 v13, v17, 5, v13
    v_and_b32 v17, 3, v1
    v_lshl_add_u32 v16, v17, 3, v16
    v_add_u32 v16, v16, v13
    v_add_u32 v16, s37, v16
    v_xor_b32 v17, 32, v16
    v_xor_b32 v18, 64, v16
    v_xor_b32 v19, 96, v16
    s_waitcnt vmcnt(0) lgkmcnt(0)
    ds_read_b64_tr_b16 v[24:25], v16 offset:0
    ds_read_b64_tr_b16 v[26:27], v16 offset:512
    ds_read_b64_tr_b16 v[28:29], v16 offset:4096
    ds_read_b64_tr_b16 v[30:31], v16 offset:4608
    ds_read_b64_tr_b16 v[32:33], v17 offset:0
    ds_read_b64_tr_b16 v[34:35], v17 offset:512
    ds_read_b64_tr_b16 v[36:37], v17 offset:4096
    ds_read_b64_tr_b16 v[38:39], v17 offset:4608
    ds_read_b64_tr_b16 v[40:41], v18 offset:0
    ds_read_b64_tr_b16 v[42:43], v18 offset:512
    ds_read_b64_tr_b16 v[44:45], v18 offset:4096
    ds_read_b64_tr_b16 v[46:47], v18 offset:4608
    ds_read_b64_tr_b16 v[48:49], v19 offset:0
    ds_read_b64_tr_b16 v[50:51], v19 offset:512
    ds_read_b64_tr_b16 v[52:53], v19 offset:4096
    ds_read_b64_tr_b16 v[54:55], v19 offset:4608
    v_mov_b32 v20, 0x3f803f80
    v_mov_b32 v21, 0x3f803f80
    v_mov_b32 v22, 0x3f803f80
    v_mov_b32 v23, 0x3f803f80
    v_lshlrev_b32 v12, 4, v1
    s_mul_i32 s42, s41, 147456
    s_lshl_b32 s43, s40, 11
    s_add_u32 s42, s42, s43
    s_add_u32 s42, s42, 16777216
    s_waitcnt lgkmcnt(14)
    buffer_store_dwordx4 v[24:27], v12, s[24:27], s42 offen offset:0 sc1
    v_mfma_f32_16x16x32_bf16 v[56:59], v[24:27], v[20:23], 0
    s_waitcnt lgkmcnt(12)
    buffer_store_dwordx4 v[28:31], v12, s[24:27], s42 offen offset:1024 sc1
    v_mfma_f32_16x16x32_bf16 v[60:63], v[28:31], v[20:23], 0
    s_add_u32 s42, s42, 36864
    s_waitcnt lgkmcnt(10)
    buffer_store_dwordx4 v[32:35], v12, s[24:27], s42 offen offset:0 sc1
    v_mfma_f32_16x16x32_bf16 v[64:67], v[32:35], v[20:23], 0
    s_waitcnt lgkmcnt(8)
    buffer_store_dwordx4 v[36:39], v12, s[24:27], s42 offen offset:1024 sc1
    v_mfma_f32_16x16x32_bf16 v[68:71], v[36:39], v[20:23], 0
    s_add_u32 s42, s42, 36864
    s_waitcnt lgkmcnt(6)
    buffer_store_dwordx4 v[40:43], v12, s[24:27], s42 offen offset:0 sc1
    v_mfma_f32_16x16x32_bf16 v[72:75], v[40:43], v[20:23], 0
    s_waitcnt lgkmcnt(4)
    buffer_store_dwordx4 v[44:47], v12, s[24:27], s42 offen offset:1024 sc1
    v_mfma_f32_16x16x32_bf16 v[76:79], v[44:47], v[20:23], 0
    s_add_u32 s42, s42, 36864
    s_waitcnt lgkmcnt(2)
    buffer_store_dwordx4 v[48:51], v12, s[24:27], s42 offen offset:0 sc1
    v_mfma_f32_16x16x32_bf16 v[80:83], v[48:51], v[20:23], 0
    s_waitcnt lgkmcnt(0)
    buffer_store_dwordx4 v[52:55], v12, s[24:27], s42 offen offset:1024 sc1
    v_mfma_f32_16x16x32_bf16 v[84:87], v[52:55], v[20:23], 0
    v_and_b32 v13, 15, v1
    v_cmp_eq_u32 vcc, 1, v13
    s_nop 1
    v_cndmask_b32 v56, v56, v60, vcc
    v_cndmask_b32 v57, v57, v61, vcc
    v_cndmask_b32 v58, v58, v62, vcc
    v_cndmask_b32 v59, v59, v63, vcc
    v_cmp_eq_u32 vcc, 2, v13
    s_nop 1
    v_cndmask_b32 v56, v56, v64, vcc
    v_cndmask_b32 v57, v57, v65, vcc
    v_cndmask_b32 v58, v58, v66, vcc
    v_cndmask_b32 v59, v59, v67, vcc
    v_cmp_eq_u32 vcc, 3, v13
    s_nop 1
    v_cndmask_b32 v56, v56, v68, vcc
    v_cndmask_b32 v57, v57, v69, vcc
    v_cndmask_b32 v58, v58, v70, vcc
    v_cndmask_b32 v59, v59, v71, vcc
    v_cmp_eq_u32 vcc, 4, v13
    s_nop 1
    v_cndmask_b32 v56, v56, v72, vcc
    v_cndmask_b32 v57, v57, v73, vcc
    v_cndmask_b32 v58, v58, v74, vcc
    v_cndmask_b32 v59, v59, v75, vcc
    v_cmp_eq_u32 vcc, 5, v13
    s_nop 1
    v_cndmask_b32 v56, v56, v76, vcc
    v_cndmask_b32 v57, v57, v77, vcc
    v_cndmask_b32 v58, v58, v78, vcc
    v_cndmask_b32 v59, v59, v79, vcc
    v_cmp_eq_u32 vcc, 6, v13
    s_nop 1
    v_cndmask_b32 v56, v56, v80, vcc
    v_cndmask_b32 v57, v57, v81, vcc
    v_cndmask_b32 v58, v58, v82, vcc
    v_cndmask_b32 v59, v59, v83, vcc
    v_cmp_eq_u32 vcc, 7, v13
    s_nop 1
    v_cndmask_b32 v56, v56, v84, vcc
    v_cndmask_b32 v57, v57, v85, vcc
    v_cndmask_b32 v58, v58, v86, vcc
    v_cndmask_b32 v59, v59, v87, vcc
    v_and_b32 v14, 48, v1
    v_lshl_add_u32 v14, v13, 6, v14
    s_mul_i32 s42, s40, 36864
    s_lshl_b32 s43, s41, 9
    s_add_u32 s42, s42, s43
    s_add_u32 s42, s42, 12582912
    s_mov_b32 exec_lo, 0x00ff00ff
    s_mov_b32 exec_hi, 0x00ff00ff
    buffer_store_dwordx4 v[56:59], v14, s[24:27], s42 offen sc1
    s_mov_b64 exec, -1
k1_kernel_x:
    s_mov_b64 exec, 0
    s_cmp_eq_u32 s3, 0
    s_cbranch_scc1 L_pad_k2_kernel_0
    s_cmp_eq_u32 s3, 1
    s_cbranch_scc1 L_pad_k2_kernel_1
    s_cmp_eq_u32 s3, 2
    s_cbranch_scc1 L_pad_k2_kernel_2
    s_cmp_eq_u32 s3, 3
    s_cbranch_scc1 L_pad_k2_kernel_3
k1_kernel_end:
    s_endpgm

.globl k2_kernel
.p2align 12
.type k2_kernel,@function
k2_kernel:
L_pad_k2_kernel_0:
    s_cbranch_execz k2_kernel_end
    s_cmp_ge_u32 s2, 256
    s_cbranch_scc1 k2_kernel_end
    s_load_dwordx2 s[4:5], s[0:1], 48
    s_load_dwordx4 s[16:19], s[0:1], 64
    s_load_dwordx2 s[20:21], s[0:1], 104
    s_load_dwordx2 s[6:7], s[0:1], 80
    v_and_b32 v1, 63, v0
    v_lshrrev_b32 v2, 6, v0
    s_nop 0
    v_readfirstlane_b32 s3, v2
    s_lshr_b32 s36, s2, 3
    s_mul_i32 s37, s36, 86
    s_lshr_b32 s37, s37, 8
    s_mul_i32 s38, s37, 3
    s_sub_u32 s38, s36, s38
    s_and_b32 s39, s2, 7
    s_mul_i32 s40, s39, 9
    s_add_u32 s40, s40, s37
    s_waitcnt lgkmcnt(0)
    s_mov_b32 s24, s20
    s_and_b32 s25, s21, 0xffff
    s_mov_b32 s26, 268435456
    s_mov_b32 s27, 0x20000
    s_mov_b32 s60, s16
    s_and_b32 s61, s17, 0xffff
    s_mov_b32 s62, 5308416
    s_mov_b32 s63, 0x20000
    s_mov_b32 s64, s18
    s_and_b32 s65, s19, 0xffff
    s_mov_b32 s66, 5308416
    s_mov_b32 s67, 0x20000
    s_cmp_ge_u32 s2, 216
    s_cbranch_scc1 k2_kernel_sw
    s_mov_b32 s28, s4
    s_and_b32 s29, s5, 0xffff
    s_mov_b32 s30, 1152
    s_mov_b32 s31, 0x20000
    s_mov_b32 s32, s6
    s_and_b32 s33, s7, 0xffff
    s_mov_b32 s34, 5308416
    s_mov_b32 s35, 0x20000
    s_cmp_eq_u32 s38, 1
    s_cbranch_scc1 k2_kernel_p1
    s_cmp_eq_u32 s38, 2
    s_cbranch_scc1 k2_kernel_p2
    v_lshrrev_b32 v3, 3, v1
    v_and_b32 v4, 7, v1
    v_mul_u32_u24 v5, 9216, v3
    v_lshl_add_u32 v5, v4, 4, v5
    s_mul_i32 s41, s3, 73728
    s_lshl_b32 s42, s40, 7
    s_add_u32 s41, s41, s42
    s_add_u32 s43, s41, 0
    buffer_load_dwordx4 v[120:123], v5, s[24:27], s43 offen
    s_add_u32 s43, s43, 589824
    buffer_load_dwordx4 v[124:127], v5, s[24:27], s43 offen
    v_lshlrev_b32 v6, 4, v1
    s_lshl_b32 s44, s40, 3
    s_add_u32 s44, s44, s3
    s_lshl_b32 s45, s44, 12
    s_add_u32 s45, s45, 5242880
    s_mul_i32 s46, s3, 4352
    s_add_u32 s46, s46, 103040
    s_add_u32 m0, s46, 256
    s_lshl_b32 s47, s44, 1
    s_lshl_b32 s53, s44, 2
    s_add_u32 s53, s53, 13697024
    buffer_load_dwordx4 v6, s[24:27], s45 offen offset:0  lds
    buffer_load_dwordx4 v6, s[24:27], s45 offen offset:1024  lds
    v_mov_b32 v7, 0
    buffer_load_ushort v8, v7, s[28:31], s47 offen
    buffer_load_dword v2, v7, s[24:27], s53 offen
    s_mul_i32 s48, s3, 4368
    s_add_u32 s48, s48, 0
    v_lshlrev_b32 v9, 2, v1
    v_add_u32 v10, s48, v9
    v_add_u32 v9, s46, v9
    ds_write_b32 v10, v7
    ds_write_b32 v9, v7
    s_lshl_b32 s49, s3, 7
    v_lshlrev_b32 v9, 4, v3
    v_add_u32 v9, s49, v9
    v_mul_u32_u24 v10, 4368, v4
    v_add_u32 v10, v10, v9
    v_lshrrev_b32 v12, 4, v1
    v_bfe_u32 v13, v1, 2, 2
    v_and_b32 v14, 3, v1
    v_lshlrev_b32 v15, 5, v14
    v_lshl_add_u32 v15, v13, 3, v15
    v_lshl_add_u32 v15, v12, 6, v15
    v_add_u32 v15, s46, v15
    v_add_u32 v15, 160, v15
    v_sub_u32 v14, v14, v13
    v_lshlrev_b32 v12, 3, v12
    v_sub_u32 v14, v14, v12
    v_lshlrev_b32 v14, 3, v14
    v_add_u32 v14, s48, v14
    v_add_u32 v14, 320, v14
    v_lshlrev_b32 v12, 1, v1
    v_add_u32 v12, s48, v12
    s_lshl_b32 s50, s3, 1
    v_add_u32 v9, s50, v6
    s_mov_b32 s52, 0xffff0000
    v_lshrrev_b32 v11, 4, v1
    v_mul_u32_u24 v11, 18432, v11
    v_and_b32 v13, 15, v1
    v_lshl_add_u32 v11, v13, 4, v11
    s_lshl_b32 s42, s40, 8
    s_mul_i32 s43, s3, 73728
    s_add_u32 s42, s42, s43
    s_add_u32 s43, s42, 2621440
    s_add_u32 s42, s42, 7864320
    s_waitcnt vmcnt(5)
    ds_write_b128 v10, v[120:123] offset:256
    s_waitcnt vmcnt(4)
    ds_write_b128 v10, v[124:127] offset:1280
    s_waitcnt vmcnt(3)
    ds_read_b64_tr_b16 v[24:25], v15 offset:0
    ds_read_b64_tr_b16 v[26:27], v15 offset:32
    ds_read_b64_tr_b16 v[28:29], v15 offset:256
    ds_read_b64_tr_b16 v[30:31], v15 offset:288
    ds_read_b64_tr_b16 v[32:33], v15 offset:512
    ds_read_b64_tr_b16 v[34:35], v15 offset:544
    ds_read_b64_tr_b16 v[36:37], v15 offset:768
    ds_read_b64_tr_b16 v[38:39], v15 offset:800
    s_waitcnt vmcnt(2)
    ds_read_b64_tr_b16 v[40:41], v15 offset:1024
    ds_read_b64_tr_b16 v[42:43], v15 offset:1056
    ds_read_b64_tr_b16 v[44:45], v15 offset:1280
    ds_read_b64_tr_b16 v[46:47], v15 offset:1312
    ds_read_b64_tr_b16 v[48:49], v15 offset:1536
    ds_read_b64_tr_b16 v[50:51], v15 offset:1568
    s_waitcnt lgkmcnt(14)
    s_barrier
    ds_read_b64_tr_b16 v[52:53], v15 offset:1792
    ds_read_b64_tr_b16 v[54:55], v15 offset:1824
    s_waitcnt vmcnt(0)
    buffer_load_dwordx4 v[184:187], v11, s[24:27], s43 offen
    s_add_u32 s43, s43, 589824
    buffer_load_dwordx4 v[188:191], v11, s[24:27], s43 offen
    s_lshr_b32 s54, s3, 1
    s_lshl_b32 s55, s40, 2
    s_add_u32 s55, s55, s54
    s_add_u32 s55, s55, 512
    s_and_b32 s51, s3, 1
    s_cmp_eq_u32 s51, 0
    s_cselect_b32 s64, s60, s64
    s_cselect_b32 s65, s61, s65
    s_cmp_lt_u32 s55, 1296
    s_cselect_b32 s66, s66, 0
    s_lshl_b32 s54, s3, 12
    s_add_u32 s54, s54, 59520
    s_mul_i32 s56, s55, 3641
    s_lshr_b32 s56, s56, 18
    s_mul_i32 s59, s56, 72
    s_sub_u32 s57, s55, s59
    v_lshrrev_b32 v18, 3, v1
    v_mul_u32_u24 v16, 9216, v18
    v_and_b32 v18, 2, v18
    v_and_b32 v17, 7, v1
    v_xor_b32 v17, v17, v18
    v_lshl_add_u32 v16, v17, 4, v16
    v_xor_b32 v17, 64, v16
    s_mul_i32 s58, s56, 294912
    s_lshl_b32 s59, s57, 7
    s_add_u32 s58, s58, s59
    s_add_u32 m0, s54, 0
    s_add_u32 s59, s58, 0
    buffer_load_dwordx4 v16, s[64:67], s59 offen nt lds
    s_add_u32 m0, s54, 1024
    s_add_u32 s59, s58, 73728
    buffer_load_dwordx4 v17, s[64:67], s59 offen nt lds
    s_add_u32 m0, s54, 2048
    s_add_u32 s59, s58, 147456
    buffer_load_dwordx4 v16, s[64:67], s59 offen nt lds
    s_add_u32 m0, s54, 3072
    s_add_u32 s59, s58, 221184
    buffer_load_dwordx4 v17, s[64:67], s59 offen nt lds
    v_lshlrev_b32 v8, 16, v8
    v_mul_f32 v8, 0x3a000000, v8
    ds_read_b64_tr_b16 v[56:57], v14 offset:32
    ds_read_b64_tr_b16 v[58:59], v14 offset:0
    ds_read_b64_tr_b16 v[60:61], v14 offset:160
    ds_read_b64_tr_b16 v[62:63], v14 offset:128
    ds_read_b64_tr_b16 v[64:65], v14 offset:288
    ds_read_b64_tr_b16 v[66:67], v14 offset:256
    ds_read_b64_tr_b16 v[68:69], v14 offset:416
    ds_read_b64_tr_b16 v[70:71], v14 offset:384
    s_waitcnt lgkmcnt(15)
    s_waitcnt lgkmcnt(6)
    v_mfma_f32_16x16x32_f16 v[120:123], v[24:27], v[56:59], 0
    ds_read_b64_tr_b16 v[72:73], v14 offset:544
    ds_read_b64_tr_b16 v[74:75], v14 offset:512
    s_waitcnt lgkmcnt(6)
    v_mfma_f32_16x16x32_f16 v[124:127], v[24:27], v[60:63], 0
    ds_read_b64_tr_b16 v[76:77], v14 offset:672
    ds_read_b64_tr_b16 v[78:79], v14 offset:640
    v_mfma_f32_16x16x32_f16 v[128:131], v[28:31], v[56:59], 0
    ds_read_b64_tr_b16 v[80:81], v14 offset:800
    ds_read_b64_tr_b16 v[82:83], v14 offset:768
    v_mfma_f32_16x16x32_f16 v[132:135], v[28:31], v[60:63], 0
    ds_read_u16 v192, v12 offset:256
    s_waitcnt lgkmcnt(9)
    v_mfma_f32_16x16x32_f16 v[128:131], v[24:27], v[64:67], v[128:131]
    ds_read_b64_tr_b16 v[84:85], v14 offset:928
    ds_read_b64_tr_b16 v[86:87], v14 offset:896
    s_waitcnt lgkmcnt(9)
    v_mfma_f32_16x16x32_f16 v[132:135], v[24:27], v[68:71], v[132:135]
    ds_read_u16 v193, v12 offset:384
    v_add_f32_dpp v5, v123, v122 wave_shr:1 row_mask:0xf bank_mask:0xf bound_ctrl:0
    v_add_f32_dpp v13, v123, v126 wave_ror:1 row_mask:0xf bank_mask:0xf
    v_mfma_f32_16x16x32_f16 v[136:139], v[32:35], v[56:59], 0
    ds_read_b64_tr_b16 v[88:89], v14 offset:1056
    ds_read_b64_tr_b16 v[90:91], v14 offset:1024
    v_add_f32_dpp v13, v127, v126 wave_shr:1 row_mask:0xf bank_mask:0xf
    v_add_f32_dpp v4, v5, v121 wave_shr:1 row_mask:0xf bank_mask:0xf bound_ctrl:0
    v_mfma_f32_16x16x32_f16 v[140:143], v[32:35], v[60:63], 0
    ds_read_u16 v194, v12 offset:512
    v_add_f32_dpp v10, v5, v125 wave_ror:1 row_mask:0xf bank_mask:0xf
    s_nop 1
    v_add_f32_dpp v10, v13, v125 wave_shr:1 row_mask:0xf bank_mask:0xf
    v_mfma_f32_16x16x32_f16 v[136:139], v[28:31], v[64:67], v[136:139]
    ds_read_b64_tr_b16 v[92:93], v14 offset:1184
    ds_read_b64_tr_b16 v[94:95], v14 offset:1152
    v_add_f32_dpp v3, v4, v120 wave_shr:1 row_mask:0xf bank_mask:0xf bound_ctrl:0
    v_add_f32_dpp v7, v4, v124 wave_ror:1 row_mask:0xf bank_mask:0xf
    v_mfma_f32_16x16x32_f16 v[140:143], v[28:31], v[68:71], v[140:143]
    ds_read_u16 v195, v12 offset:640
    v_add_f32_dpp v7, v10, v124 wave_shr:1 row_mask:0xf bank_mask:0xf
    v_mul_f32 v120, v2, v3
    s_waitcnt lgkmcnt(14)
    v_mfma_f32_16x16x32_f16 v[136:139], v[24:27], v[72:75], v[136:139]
    ds_read_b64_tr_b16 v[96:97], v14 offset:1312
    ds_read_b64_tr_b16 v[98:99], v14 offset:1280
    v_mul_f32 v124, v2, v7
    s_waitcnt lgkmcnt(11)
    v_fma_mix_f32 v192, v192, v8, 0 op_sel_hi:[1,0,0]
    v_mfma_f32_16x16x32_f16 v[140:143], v[24:27], v[76:79], v[140:143]
    ds_read_u16 v196, v12 offset:768
    s_waitcnt lgkmcnt(9)
    v_fma_mix_f32 v193, v193, v8, 0 op_sel_hi:[1,0,0]
    v_cvt_pk_bf16_f32 v20, v120, v124
    v_mfma_f32_16x16x32_f16 v[144:147], v[36:39], v[56:59], 0
    ds_read_b64_tr_b16 v[100:101], v14 offset:1440
    ds_read_b64_tr_b16 v[102:103], v14 offset:1408
    v_cvt_pk_bf16_f32 v21, v192, v193
    v_lshlrev_b32 v22, 16, v20
    v_mfma_f32_16x16x32_f16 v[148:151], v[36:39], v[60:63], 0
    ds_read_u16 v197, v12 offset:896
    v_and_b32 v20, s52, v20
    v_lshlrev_b32 v23, 16, v21
    v_mfma_f32_16x16x32_f16 v[144:147], v[32:35], v[64:67], v[144:147]
    ds_read_b64_tr_b16 v[104:105], v14 offset:1568
    ds_read_b64_tr_b16 v[106:107], v14 offset:1536
    v_and_b32 v21, s52, v21
    v_add_f32 v22, v22, v23
    v_mfma_f32_16x16x32_f16 v[148:151], v[32:35], v[68:71], v[148:151]
    ds_read_u16 v198, v12 offset:1024
    v_add_f32 v20, v20, v21
    v_cvt_pk_bf16_f32 v192, v22, v20
    v_mfma_f32_16x16x32_f16 v[144:147], v[28:31], v[72:75], v[144:147]
    ds_read_b64_tr_b16 v[108:109], v14 offset:1696
    ds_read_b64_tr_b16 v[110:111], v14 offset:1664
    ds_write_b16 v9, v192 offset:34944
    ds_write_b16_d16_hi v9, v192 offset:35968
    v_mfma_f32_16x16x32_f16 v[148:151], v[28:31], v[76:79], v[148:151]
    ds_read_u16 v199, v12 offset:1152
    v_add_f32_dpp v18, v127, v130 wave_ror:1 row_mask:0xf bank_mask:0xf
    v_add_f32_dpp v5, v131, v134 wave_ror:1 row_mask:0xf bank_mask:0xf
    v_mfma_f32_16x16x32_f16 v[144:147], v[24:27], v[80:83], v[144:147]
    ds_read_b64_tr_b16 v[112:113], v14 offset:1824
    ds_read_b64_tr_b16 v[114:115], v14 offset:1792
    v_add_f32_dpp v18, v131, v130 wave_shr:1 row_mask:0xf bank_mask:0xf
    v_add_f32_dpp v5, v135, v134 wave_shr:1 row_mask:0xf bank_mask:0xf
    v_mfma_f32_16x16x32_f16 v[148:151], v[24:27], v[84:87], v[148:151]
    ds_read_u16 v200, v12 offset:1280
    v_add_f32_dpp v17, v13, v129 wave_ror:1 row_mask:0xf bank_mask:0xf
    v_add_f32_dpp v4, v18, v133 wave_ror:1 row_mask:0xf bank_mask:0xf
    v_mfma_f32_16x16x32_f16 v[152:155], v[40:43], v[56:59], 0
    ds_read_b64_tr_b16 v[116:117], v14 offset:1952
    ds_read_b64_tr_b16 v[118:119], v14 offset:1920
    v_add_f32_dpp v17, v18, v129 wave_shr:1 row_mask:0xf bank_mask:0xf
    v_add_f32_dpp v4, v5, v133 wave_shr:1 row_mask:0xf bank_mask:0xf
    v_mfma_f32_16x16x32_f16 v[156:159], v[40:43], v[60:63], 0
    ds_read_u16 v201, v12 offset:1408
    v_add_f32_dpp v16, v10, v128 wave_ror:1 row_mask:0xf bank_mask:0xf
    v_add_f32_dpp v3, v17, v132 wave_ror:1 row_mask:0xf bank_mask:0xf
    v_mfma_f32_16x16x32_f16 v[152:155], v[36:39], v[64:67], v[152:155]
    ds_read_u16 v202, v12 offset:1536
    v_add_f32_dpp v16, v17, v128 wave_shr:1 row_mask:0xf bank_mask:0xf
    v_add_f32_dpp v3, v4, v132 wave_shr:1 row_mask:0xf bank_mask:0xf
    v_mfma_f32_16x16x32_f16 v[156:159], v[36:39], v[68:71], v[156:159]
    ds_read_u16 v203, v12 offset:1664
    v_mul_f32 v128, v2, v16
    v_mul_f32 v132, v2, v3
    v_mfma_f32_16x16x32_f16 v[152:155], v[32:35], v[72:75], v[152:155]
    ds_read_u16 v204, v12 offset:1792
    s_waitcnt lgkmcnt(15)
    v_fma_mix_f32 v194, v194, v8, 0 op_sel_hi:[1,0,0]
    v_fma_mix_f32 v195, v195, v8, 0 op_sel_hi:[1,0,0]
    v_mfma_f32_16x16x32_f16 v[156:159], v[32:35], v[76:79], v[156:159]
    ds_read_u16 v205, v12 offset:1920
    v_cvt_pk_bf16_f32 v20, v128, v132
    v_cvt_pk_bf16_f32 v21, v194, v195
    v_mfma_f32_16x16x32_f16 v[152:155], v[28:31], v[80:83], v[152:155]
    ds_read_u16 v206, v12 offset:2048
    v_lshlrev_b32 v22, 16, v20
    v_and_b32 v20, s52, v20
    v_mfma_f32_16x16x32_f16 v[156:159], v[28:31], v[84:87], v[156:159]
    ds_read_u16 v207, v12 offset:2176
    v_lshlrev_b32 v23, 16, v21
    v_and_b32 v21, s52, v21
    v_mfma_f32_16x16x32_f16 v[152:155], v[24:27], v[88:91], v[152:155]
    v_add_f32 v22, v22, v23
    v_add_f32 v20, v20, v21
    v_cvt_pk_bf16_f32 v194, v22, v20
    v_mfma_f32_16x16x32_f16 v[156:159], v[24:27], v[92:95], v[156:159]
    ds_write_b16 v9, v194 offset:36992
    ds_write_b16_d16_hi v9, v194 offset:38016
    v_add_f32_dpp v13, v135, v138 wave_ror:1 row_mask:0xf bank_mask:0xf
    v_mfma_f32_16x16x32_f16 v[160:163], v[44:47], v[56:59], 0
    v_add_f32_dpp v18, v139, v142 wave_ror:1 row_mask:0xf bank_mask:0xf
    v_add_f32_dpp v13, v139, v138 wave_shr:1 row_mask:0xf bank_mask:0xf
    s_nop 0
    v_add_f32_dpp v18, v143, v142 wave_shr:1 row_mask:0xf bank_mask:0xf
    v_mfma_f32_16x16x32_f16 v[164:167], v[44:47], v[60:63], 0
    v_add_f32_dpp v10, v5, v137 wave_ror:1 row_mask:0xf bank_mask:0xf
    v_add_f32_dpp v17, v13, v141 wave_ror:1 row_mask:0xf bank_mask:0xf
    s_nop 0
    v_add_f32_dpp v10, v13, v137 wave_shr:1 row_mask:0xf bank_mask:0xf
    v_mfma_f32_16x16x32_f16 v[160:163], v[40:43], v[64:67], v[160:163]
    v_add_f32_dpp v17, v18, v141 wave_shr:1 row_mask:0xf bank_mask:0xf
    v_add_f32_dpp v7, v4, v136 wave_ror:1 row_mask:0xf bank_mask:0xf
    v_add_f32_dpp v16, v10, v140 wave_ror:1 row_mask:0xf bank_mask:0xf
    v_mfma_f32_16x16x32_f16 v[164:167], v[40:43], v[68:71], v[164:167]
    v_add_f32_dpp v7, v10, v136 wave_shr:1 row_mask:0xf bank_mask:0xf
    v_add_f32_dpp v16, v17, v140 wave_shr:1 row_mask:0xf bank_mask:0xf
    v_mul_f32 v136, v2, v7
    v_mfma_f32_16x16x32_f16 v[160:163], v[36:39], v[72:75], v[160:163]
    v_mul_f32 v140, v2, v16
    v_fma_mix_f32 v196, v196, v8, 0 op_sel_hi:[1,0,0]
    v_fma_mix_f32 v197, v197, v8, 0 op_sel_hi:[1,0,0]
    v_mfma_f32_16x16x32_f16 v[164:167], v[36:39], v[76:79], v[164:167]
    v_cvt_pk_bf16_f32 v20, v136, v140
    v_cvt_pk_bf16_f32 v21, v196, v197
    v_lshlrev_b32 v22, 16, v20
    v_mfma_f32_16x16x32_f16 v[160:163], v[32:35], v[80:83], v[160:163]
    v_and_b32 v20, s52, v20
    v_lshlrev_b32 v23, 16, v21
    v_and_b32 v21, s52, v21
    v_mfma_f32_16x16x32_f16 v[164:167], v[32:35], v[84:87], v[164:167]
    v_add_f32 v22, v22, v23
    v_add_f32 v20, v20, v21
    v_cvt_pk_bf16_f32 v196, v22, v20
    v_mfma_f32_16x16x32_f16 v[160:163], v[28:31], v[88:91], v[160:163]
    ds_write_b16 v9, v196 offset:39040
    ds_write_b16_d16_hi v9, v196 offset:40064
    v_add_f32_dpp v5, v143, v146 wave_ror:1 row_mask:0xf bank_mask:0xf
    v_mfma_f32_16x16x32_f16 v[164:167], v[28:31], v[92:95], v[164:167]
    v_add_f32_dpp v13, v147, v150 wave_ror:1 row_mask:0xf bank_mask:0xf
    v_add_f32_dpp v5, v147, v146 wave_shr:1 row_mask:0xf bank_mask:0xf
    s_nop 0
    v_add_f32_dpp v13, v151, v150 wave_shr:1 row_mask:0xf bank_mask:0xf
    v_mfma_f32_16x16x32_f16 v[160:163], v[24:27], v[96:99], v[160:163]
    v_add_f32_dpp v4, v18, v145 wave_ror:1 row_mask:0xf bank_mask:0xf
    v_add_f32_dpp v10, v5, v149 wave_ror:1 row_mask:0xf bank_mask:0xf
    s_nop 0
    v_add_f32_dpp v4, v5, v145 wave_shr:1 row_mask:0xf bank_mask:0xf
    v_mfma_f32_16x16x32_f16 v[164:167], v[24:27], v[100:103], v[164:167]
    v_add_f32_dpp v10, v13, v149 wave_shr:1 row_mask:0xf bank_mask:0xf
    v_add_f32_dpp v3, v17, v144 wave_ror:1 row_mask:0xf bank_mask:0xf
    v_add_f32_dpp v7, v4, v148 wave_ror:1 row_mask:0xf bank_mask:0xf
    v_mfma_f32_16x16x32_f16 v[168:171], v[48:51], v[56:59], 0
    v_add_f32_dpp v3, v4, v144 wave_shr:1 row_mask:0xf bank_mask:0xf
    v_add_f32_dpp v7, v10, v148 wave_shr:1 row_mask:0xf bank_mask:0xf
    v_mul_f32 v144, v2, v3
    v_mfma_f32_16x16x32_f16 v[172:175], v[48:51], v[60:63], 0
    v_mul_f32 v148, v2, v7
    s_waitcnt lgkmcnt(15)
    v_fma_mix_f32 v198, v198, v8, 0 op_sel_hi:[1,0,0]
    v_fma_mix_f32 v199, v199, v8, 0 op_sel_hi:[1,0,0]
    v_mfma_f32_16x16x32_f16 v[168:171], v[44:47], v[64:67], v[168:171]
    v_cvt_pk_bf16_f32 v20, v144, v148
    v_cvt_pk_bf16_f32 v21, v198, v199
    v_lshlrev_b32 v22, 16, v20
    v_mfma_f32_16x16x32_f16 v[172:175], v[44:47], v[68:71], v[172:175]
    v_and_b32 v20, s52, v20
    v_lshlrev_b32 v23, 16, v21
    v_and_b32 v21, s52, v21
    v_mfma_f32_16x16x32_f16 v[168:171], v[40:43], v[72:75], v[168:171]
    v_add_f32 v22, v22, v23
    v_add_f32 v20, v20, v21
    v_cvt_pk_bf16_f32 v198, v22, v20
    v_mfma_f32_16x16x32_f16 v[172:175], v[40:43], v[76:79], v[172:175]
    ds_write_b16 v9, v198 offset:41088
    ds_write_b16_d16_hi v9, v198 offset:42112
    v_add_f32_dpp v18, v151, v154 wave_ror:1 row_mask:0xf bank_mask:0xf
    v_mfma_f32_16x16x32_f16 v[168:171], v[36:39], v[80:83], v[168:171]
    v_add_f32_dpp v5, v155, v158 wave_ror:1 row_mask:0xf bank_mask:0xf
    v_add_f32_dpp v18, v155, v154 wave_shr:1 row_mask:0xf bank_mask:0xf
    s_nop 0
    v_add_f32_dpp v5, v159, v158 wave_shr:1 row_mask:0xf bank_mask:0xf
    v_mfma_f32_16x16x32_f16 v[172:175], v[36:39], v[84:87], v[172:175]
    v_add_f32_dpp v17, v13, v153 wave_ror:1 row_mask:0xf bank_mask:0xf
    v_add_f32_dpp v4, v18, v157 wave_ror:1 row_mask:0xf bank_mask:0xf
    s_nop 0
    v_add_f32_dpp v17, v18, v153 wave_shr:1 row_mask:0xf bank_mask:0xf
    v_mfma_f32_16x16x32_f16 v[168:171], v[32:35], v[88:91], v[168:171]
    v_add_f32_dpp v4, v5, v157 wave_shr:1 row_mask:0xf bank_mask:0xf
    v_add_f32_dpp v16, v10, v152 wave_ror:1 row_mask:0xf bank_mask:0xf
    v_add_f32_dpp v3, v17, v156 wave_ror:1 row_mask:0xf bank_mask:0xf
    v_mfma_f32_16x16x32_f16 v[172:175], v[32:35], v[92:95], v[172:175]
    v_add_f32_dpp v16, v17, v152 wave_shr:1 row_mask:0xf bank_mask:0xf
    v_add_f32_dpp v3, v4, v156 wave_shr:1 row_mask:0xf bank_mask:0xf
    v_mul_f32 v152, v2, v16
    v_mfma_f32_16x16x32_f16 v[168:171], v[28:31], v[96:99], v[168:171]
    v_mul_f32 v156, v2, v3
    s_waitcnt lgkmcnt(15)
    v_fma_mix_f32 v200, v200, v8, 0 op_sel_hi:[1,0,0]
    s_waitcnt lgkmcnt(12)
    v_fma_mix_f32 v201, v201, v8, 0 op_sel_hi:[1,0,0]
    v_mfma_f32_16x16x32_f16 v[172:175], v[28:31], v[100:103], v[172:175]
    v_cvt_pk_bf16_f32 v20, v152, v156
    v_cvt_pk_bf16_f32 v21, v200, v201
    v_lshlrev_b32 v22, 16, v20
    v_mfma_f32_16x16x32_f16 v[168:171], v[24:27], v[104:107], v[168:171]
    v_and_b32 v20, s52, v20
    v_lshlrev_b32 v23, 16, v21
    v_and_b32 v21, s52, v21
    v_mfma_f32_16x16x32_f16 v[172:175], v[24:27], v[108:111], v[172:175]
    v_add_f32 v22, v22, v23
    v_add_f32 v20, v20, v21
    v_cvt_pk_bf16_f32 v200, v22, v20
    v_mfma_f32_16x16x32_f16 v[176:179], v[52:55], v[56:59], 0
    ds_write_b16 v9, v200 offset:43136
    ds_write_b16_d16_hi v9, v200 offset:44160
    v_add_f32_dpp v13, v159, v162 wave_ror:1 row_mask:0xf bank_mask:0xf
    v_mfma_f32_16x16x32_f16 v[180:183], v[52:55], v[60:63], 0
    v_add_f32_dpp v18, v163, v166 wave_ror:1 row_mask:0xf bank_mask:0xf
    v_add_f32_dpp v13, v163, v162 wave_shr:1 row_mask:0xf bank_mask:0xf
    s_nop 0
    v_add_f32_dpp v18, v167, v166 wave_shr:1 row_mask:0xf bank_mask:0xf
    v_mfma_f32_16x16x32_f16 v[176:179], v[48:51], v[64:67], v[176:179]
    v_add_f32_dpp v10, v5, v161 wave_ror:1 row_mask:0xf bank_mask:0xf
    v_add_f32_dpp v17, v13, v165 wave_ror:1 row_mask:0xf bank_mask:0xf
    s_nop 0
    v_add_f32_dpp v10, v13, v161 wave_shr:1 row_mask:0xf bank_mask:0xf
    v_mfma_f32_16x16x32_f16 v[180:183], v[48:51], v[68:71], v[180:183]
    v_add_f32_dpp v17, v18, v165 wave_shr:1 row_mask:0xf bank_mask:0xf
    v_add_f32_dpp v7, v4, v160 wave_ror:1 row_mask:0xf bank_mask:0xf
    v_add_f32_dpp v16, v10, v164 wave_ror:1 row_mask:0xf bank_mask:0xf
    v_mfma_f32_16x16x32_f16 v[176:179], v[44:47], v[72:75], v[176:179]
    v_add_f32_dpp v7, v10, v160 wave_shr:1 row_mask:0xf bank_mask:0xf
    v_add_f32_dpp v16, v17, v164 wave_shr:1 row_mask:0xf bank_mask:0xf
    v_mul_f32 v160, v2, v7
    v_mfma_f32_16x16x32_f16 v[180:183], v[44:47], v[76:79], v[180:183]
    v_mul_f32 v164, v2, v16
    s_waitcnt lgkmcnt(13)
    v_fma_mix_f32 v202, v202, v8, 0 op_sel_hi:[1,0,0]
    s_waitcnt lgkmcnt(12)
    v_fma_mix_f32 v203, v203, v8, 0 op_sel_hi:[1,0,0]
    v_mfma_f32_16x16x32_f16 v[176:179], v[40:43], v[80:83], v[176:179]
    v_cvt_pk_bf16_f32 v20, v160, v164
    v_cvt_pk_bf16_f32 v21, v202, v203
    v_lshlrev_b32 v22, 16, v20
    v_mfma_f32_16x16x32_f16 v[180:183], v[40:43], v[84:87], v[180:183]
    v_and_b32 v20, s52, v20
    v_lshlrev_b32 v23, 16, v21
    v_and_b32 v21, s52, v21
    v_mfma_f32_16x16x32_f16 v[176:179], v[36:39], v[88:91], v[176:179]
    v_add_f32 v22, v22, v23
    v_add_f32 v20, v20, v21
    v_cvt_pk_bf16_f32 v202, v22, v20
    v_mfma_f32_16x16x32_f16 v[180:183], v[36:39], v[92:95], v[180:183]
    ds_write_b16 v9, v202 offset:45184
    ds_write_b16_d16_hi v9, v202 offset:46208
    v_add_f32_dpp v5, v167, v170 wave_ror:1 row_mask:0xf bank_mask:0xf
    v_mfma_f32_16x16x32_f16 v[176:179], v[32:35], v[96:99], v[176:179]
    v_add_f32_dpp v13, v171, v174 wave_ror:1 row_mask:0xf bank_mask:0xf
    v_add_f32_dpp v5, v171, v170 wave_shr:1 row_mask:0xf bank_mask:0xf
    s_nop 0
    v_add_f32_dpp v13, v175, v174 wave_shr:1 row_mask:0xf bank_mask:0xf
    v_mfma_f32_16x16x32_f16 v[180:183], v[32:35], v[100:103], v[180:183]
    v_add_f32_dpp v4, v18, v169 wave_ror:1 row_mask:0xf bank_mask:0xf
    v_add_f32_dpp v10, v5, v173 wave_ror:1 row_mask:0xf bank_mask:0xf
    s_nop 0
    v_add_f32_dpp v4, v5, v169 wave_shr:1 row_mask:0xf bank_mask:0xf
    v_mfma_f32_16x16x32_f16 v[176:179], v[28:31], v[104:107], v[176:179]
    v_add_f32_dpp v10, v13, v173 wave_shr:1 row_mask:0xf bank_mask:0xf
    v_add_f32_dpp v3, v17, v168 wave_ror:1 row_mask:0xf bank_mask:0xf
    v_add_f32_dpp v7, v4, v172 wave_ror:1 row_mask:0xf bank_mask:0xf
    v_mfma_f32_16x16x32_f16 v[180:183], v[28:31], v[108:111], v[180:183]
    v_add_f32_dpp v3, v4, v168 wave_shr:1 row_mask:0xf bank_mask:0xf
    v_add_f32_dpp v7, v10, v172 wave_shr:1 row_mask:0xf bank_mask:0xf
    v_mul_f32 v168, v2, v3
    v_mfma_f32_16x16x32_f16 v[176:179], v[24:27], v[112:115], v[176:179]
    v_mul_f32 v172, v2, v7
    s_waitcnt lgkmcnt(13)
    v_fma_mix_f32 v204, v204, v8, 0 op_sel_hi:[1,0,0]
    s_waitcnt lgkmcnt(12)
    v_fma_mix_f32 v205, v205, v8, 0 op_sel_hi:[1,0,0]
    v_mfma_f32_16x16x32_f16 v[180:183], v[24:27], v[116:119], v[180:183]
    v_cvt_pk_bf16_f32 v20, v168, v172
    v_cvt_pk_bf16_f32 v21, v204, v205
    v_lshlrev_b32 v22, 16, v20
    v_and_b32 v20, s52, v20
    v_lshlrev_b32 v23, 16, v21
    v_and_b32 v21, s52, v21
    v_add_f32 v22, v22, v23
    v_add_f32 v20, v20, v21
    v_cvt_pk_bf16_f32 v204, v22, v20
    ds_write_b16 v9, v204 offset:47232
    ds_write_b16_d16_hi v9, v204 offset:48256
    v_add_f32_dpp v18, v175, v178 wave_ror:1 row_mask:0xf bank_mask:0xf
    v_add_f32_dpp v5, v179, v182 wave_ror:1 row_mask:0xf bank_mask:0xf
    s_nop 0
    v_add_f32_dpp v18, v179, v178 wave_shr:1 row_mask:0xf bank_mask:0xf
    v_add_f32_dpp v5, v183, v182 wave_shr:1 row_mask:0xf bank_mask:0xf
    v_add_f32_dpp v17, v13, v177 wave_ror:1 row_mask:0xf bank_mask:0xf
    v_add_f32_dpp v4, v18, v181 wave_ror:1 row_mask:0xf bank_mask:0xf
    s_nop 0
    v_add_f32_dpp v17, v18, v177 wave_shr:1 row_mask:0xf bank_mask:0xf
    v_add_f32_dpp v4, v5, v181 wave_shr:1 row_mask:0xf bank_mask:0xf
    v_add_f32_dpp v16, v10, v176 wave_ror:1 row_mask:0xf bank_mask:0xf
    v_add_f32_dpp v3, v17, v180 wave_ror:1 row_mask:0xf bank_mask:0xf
    s_nop 0
    v_add_f32_dpp v16, v17, v176 wave_shr:1 row_mask:0xf bank_mask:0xf
    v_add_f32_dpp v3, v4, v180 wave_shr:1 row_mask:0xf bank_mask:0xf
    v_mul_f32 v176, v2, v16
    v_mul_f32 v180, v2, v3
    s_waitcnt lgkmcnt(13)
    v_fma_mix_f32 v206, v206, v8, 0 op_sel_hi:[1,0,0]
    s_waitcnt lgkmcnt(12)
    v_fma_mix_f32 v207, v207, v8, 0 op_sel_hi:[1,0,0]
    v_cvt_pk_bf16_f32 v20, v176, v180
    v_cvt_pk_bf16_f32 v21, v206, v207
    v_lshlrev_b32 v22, 16, v20
    v_and_b32 v20, s52, v20
    v_lshlrev_b32 v23, 16, v21
    v_and_b32 v21, s52, v21
    v_add_f32 v22, v22, v23
    v_add_f32 v20, v20, v21
    v_cvt_pk_bf16_f32 v206, v22, v20
    ds_write_b16 v9, v206 offset:49280
    ds_write_b16_d16_hi v9, v206 offset:50304
    v_lshlrev_b32 v7, 3, v1
    v_mov_b32 v5, 0x3f803f80
    s_lshl_b32 s41, s3, 10
    v_add_u32 v6, s41, v6
    s_mul_i32 s43, s40, 16512
    s_lshl_b32 s44, s3, 9
    s_add_u32 s43, s43, s44
    s_add_u32 s43, s43, 10485760
    s_nop 0
    s_waitcnt lgkmcnt(0)
    s_barrier
    ds_read_b128 v[24:27], v6 offset:34944
    ds_read_b128 v[48:51], v6 offset:43136
    s_waitcnt vmcnt(4)
    v_lshlrev_b32 v40, 16, v184
    v_and_b32 v41, s52, v184
    v_lshlrev_b32 v42, 16, v185
    v_and_b32 v43, s52, v185
    v_lshlrev_b32 v44, 16, v186
    v_and_b32 v45, s52, v186
    v_lshlrev_b32 v46, 16, v187
    v_and_b32 v47, s52, v187
    v_mov_b32 v28, 0
    v_mov_b32 v29, 0
    s_waitcnt lgkmcnt(1)
    v_lshlrev_b32 v32, 16, v24
    v_and_b32 v33, s52, v24
    v_lshlrev_b32 v34, 16, v25
    v_and_b32 v35, s52, v25
    v_lshlrev_b32 v36, 16, v26
    v_and_b32 v37, s52, v26
    v_lshlrev_b32 v38, 16, v27
    v_and_b32 v39, s52, v27
    v_pk_add_f32 v[32:33], v[32:33], v[40:41]
    v_pk_add_f32 v[34:35], v[34:35], v[42:43]
    v_pk_add_f32 v[36:37], v[36:37], v[44:45]
    v_pk_add_f32 v[38:39], v[38:39], v[46:47]
    v_cvt_pk_bf16_f32 v24, v32, v33
    v_cvt_pk_bf16_f32 v25, v34, v35
    v_cvt_pk_bf16_f32 v26, v36, v37
    v_cvt_pk_bf16_f32 v27, v38, v39
    buffer_store_dwordx4 v[24:27], v11, s[24:27], s42 offen sc1
    v_dot2c_f32_bf16 v28, v24, v5
    v_dot2c_f32_bf16 v29, v24, v24
    v_dot2c_f32_bf16 v28, v25, v5
    v_dot2c_f32_bf16 v29, v25, v25
    v_dot2c_f32_bf16 v28, v26, v5
    v_dot2c_f32_bf16 v29, v26, v26
    v_dot2c_f32_bf16 v28, v27, v5
    v_dot2c_f32_bf16 v29, v27, v27
    s_nop 2
    buffer_store_dwordx2 v[28:29], v7, s[24:27], s43 offen sc1
    s_add_u32 s42, s42, 589824
    s_add_u32 s43, s43, 4096
    v_lshlrev_b32 v64, 16, v188
    v_and_b32 v65, s52, v188
    v_lshlrev_b32 v66, 16, v189
    v_and_b32 v67, s52, v189
    v_lshlrev_b32 v68, 16, v190
    v_and_b32 v69, s52, v190
    v_lshlrev_b32 v70, 16, v191
    v_and_b32 v71, s52, v191
    v_mov_b32 v52, 0
    v_mov_b32 v53, 0
    s_waitcnt lgkmcnt(0)
    v_lshlrev_b32 v56, 16, v48
    v_and_b32 v57, s52, v48
    v_lshlrev_b32 v58, 16, v49
    v_and_b32 v59, s52, v49
    v_lshlrev_b32 v60, 16, v50
    v_and_b32 v61, s52, v50
    v_lshlrev_b32 v62, 16, v51
    v_and_b32 v63, s52, v51
    v_pk_add_f32 v[56:57], v[56:57], v[64:65]
    v_pk_add_f32 v[58:59], v[58:59], v[66:67]
    v_pk_add_f32 v[60:61], v[60:61], v[68:69]
    v_pk_add_f32 v[62:63], v[62:63], v[70:71]
    v_cvt_pk_bf16_f32 v48, v56, v57
    v_cvt_pk_bf16_f32 v49, v58, v59
    v_cvt_pk_bf16_f32 v50, v60, v61
    v_cvt_pk_bf16_f32 v51, v62, v63
    buffer_store_dwordx4 v[48:51], v11, s[24:27], s42 offen sc1
    v_dot2c_f32_bf16 v52, v48, v5
    v_dot2c_f32_bf16 v53, v48, v48
    v_dot2c_f32_bf16 v52, v49, v5
    v_dot2c_f32_bf16 v53, v49, v49
    v_dot2c_f32_bf16 v52, v50, v5
    v_dot2c_f32_bf16 v53, v50, v50
    v_dot2c_f32_bf16 v52, v51, v5
    v_dot2c_f32_bf16 v53, v51, v51
    s_nop 2
L_pad_k2_kernel_1:
    s_cbranch_execz k2_kernel_end
    buffer_store_dwordx2 v[52:53], v7, s[24:27], s43 offen sc1
k2_kernel_e0:
    s_cmp_ge_u32 s55, 1296
    s_cbranch_scc1 k2_kernel_nf0
    v_lshrrev_b32 v105, 4, v1
    v_lshlrev_b32 v108, 10, v105
    v_and_b32 v105, 1, v105
    v_lshlrev_b32 v105, 6, v105
    v_bfe_u32 v109, v1, 2, 2
    v_lshl_add_u32 v108, v109, 7, v108
    v_bfe_u32 v109, v1, 3, 1
    v_lshl_add_u32 v105, v109, 5, v105
    v_and_b32 v109, 3, v1
    v_lshl_add_u32 v108, v109, 3, v108
    v_add_u32 v108, v108, v105
    v_add_u32 v108, s54, v108
    v_xor_b32 v109, 32, v108
    v_xor_b32 v110, 64, v108
    v_xor_b32 v111, 96, v108
    v_mov_b32 v112, 0x3f803f80
    v_mov_b32 v113, 0x3f803f80
    v_mov_b32 v114, 0x3f803f80
    v_mov_b32 v115, 0x3f803f80
    v_lshlrev_b32 v104, 4, v1
    v_and_b32 v105, 15, v1
    v_and_b32 v106, 48, v1
    v_lshl_add_u32 v106, v105, 7, v106
    s_mul_i32 s58, s57, 147456
    s_lshl_b32 s59, s56, 11
    s_add_u32 s58, s58, s59
    s_lshl_b32 s59, s51, 10
    s_add_u32 s58, s58, s59
    s_add_u32 s58, s58, 16777216
    s_mul_i32 s56, s56, 36864
    s_lshl_b32 s59, s57, 9
    s_add_u32 s56, s56, s59
    s_lshl_b32 s59, s51, 6
    s_add_u32 s56, s56, s59
    s_add_u32 s56, s56, 12582912
    s_waitcnt vmcnt(4) lgkmcnt(0)
    ds_read_b64_tr_b16 v[116:117], v108
    ds_read_b64_tr_b16 v[118:119], v108 offset:512
    ds_read_b64_tr_b16 v[120:121], v109
    ds_read_b64_tr_b16 v[122:123], v109 offset:512
    ds_read_b64_tr_b16 v[124:125], v110
    ds_read_b64_tr_b16 v[126:127], v110 offset:512
    ds_read_b64_tr_b16 v[128:129], v111
    ds_read_b64_tr_b16 v[130:131], v111 offset:512
    s_waitcnt lgkmcnt(6)
    buffer_store_dwordx4 v[116:119], v104, s[24:27], s58 offen sc1
    v_mfma_f32_16x16x32_bf16 v[132:135], v[116:119], v[112:115], 0
    s_add_u32 s58, s58, 36864
    s_waitcnt lgkmcnt(4)
    buffer_store_dwordx4 v[120:123], v104, s[24:27], s58 offen sc1
    v_mfma_f32_16x16x32_bf16 v[136:139], v[120:123], v[112:115], 0
    s_add_u32 s58, s58, 36864
    s_waitcnt lgkmcnt(2)
    buffer_store_dwordx4 v[124:127], v104, s[24:27], s58 offen sc1
    v_mfma_f32_16x16x32_bf16 v[140:143], v[124:127], v[112:115], 0
    s_add_u32 s58, s58, 36864
    s_waitcnt lgkmcnt(0)
    buffer_store_dwordx4 v[128:131], v104, s[24:27], s58 offen sc1
    v_mfma_f32_16x16x32_bf16 v[144:147], v[128:131], v[112:115], 0
    v_cmp_eq_u32 vcc, 1, v105
    s_nop 1
    v_cndmask_b32 v132, v132, v136, vcc
    v_cndmask_b32 v133, v133, v137, vcc
    v_cndmask_b32 v134, v134, v138, vcc
    v_cndmask_b32 v135, v135, v139, vcc
    v_cmp_eq_u32 vcc, 2, v105
    s_nop 1
    v_cndmask_b32 v132, v132, v140, vcc
    v_cndmask_b32 v133, v133, v141, vcc
    v_cndmask_b32 v134, v134, v142, vcc
    v_cndmask_b32 v135, v135, v143, vcc
    v_cmp_eq_u32 vcc, 3, v105
    s_nop 1
    v_cndmask_b32 v132, v132, v144, vcc
    v_cndmask_b32 v133, v133, v145, vcc
    v_cndmask_b32 v134, v134, v146, vcc
    v_cndmask_b32 v135, v135, v147, vcc
    s_mov_b32 exec_lo, 0x000f000f
    s_mov_b32 exec_hi, 0x000f000f
    buffer_store_dwordx4 v[132:135], v106, s[24:27], s56 offen sc1
    s_mov_b64 exec, -1
k2_kernel_nf0:
    s_mov_b64 exec, 0
    s_cmp_eq_u32 s3, 0
    s_cbranch_scc1 L_pad_k3_kernel_0
    s_cmp_eq_u32 s3, 1
    s_cbranch_scc1 L_pad_k3_kernel_1
    s_cmp_eq_u32 s3, 2
    s_cbranch_scc1 L_pad_k3_kernel_2
    s_cmp_eq_u32 s3, 3
    s_cbranch_scc1 L_pad_k3_kernel_3
    s_cmp_eq_u32 s3, 4
    s_cbranch_scc1 L_pad_k3_kernel_4
    s_cmp_eq_u32 s3, 5
    s_cbranch_scc1 L_pad_k3_kernel_5
    s_cmp_eq_u32 s3, 6
    s_cbranch_scc1 L_pad_k3_kernel_6
    s_cmp_eq_u32 s3, 7
    s_cbranch_scc1 L_pad_k3_kernel_7
    s_endpgm
k2_kernel_p1:
    v_lshrrev_b32 v3, 3, v1
    v_and_b32 v4, 7, v1
    v_mul_u32_u24 v5, 9216, v3
    v_lshl_add_u32 v5, v4, 4, v5
    s_mul_i32 s41, s3, 73728
    s_lshl_b32 s42, s40, 7
    s_add_u32 s41, s41, s42
    s_add_u32 s43, s41, 0
    buffer_load_dwordx4 v[176:179], v5, s[24:27], s43 offen
    s_add_u32 s43, s43, 589824
    buffer_load_dwordx4 v[180:183], v5, s[24:27], s43 offen
    s_add_u32 s43, s43, 589824
    buffer_load_dwordx4 v[184:187], v5, s[24:27], s43 offen
    s_add_u32 s43, s43, 589824
    buffer_load_dwordx4 v[188:191], v5, s[24:27], s43 offen
    v_lshlrev_b32 v6, 4, v1
    s_lshl_b32 s44, s40, 3
    s_add_u32 s44, s44, s3
    s_lshl_b32 s45, s44, 12
    s_add_u32 s45, s45, 5242880
    s_mul_i32 s46, s3, 4352
    s_add_u32 s46, s46, 103040
    s_add_u32 m0, s46, 256
    s_lshl_b32 s47, s44, 1
    s_lshl_b32 s53, s44, 2
    s_add_u32 s53, s53, 13697024
    buffer_load_dwordx4 v6, s[24:27], s45 offen offset:0  lds
    buffer_load_dwordx4 v6, s[24:27], s45 offen offset:1024  lds
    buffer_load_dwordx4 v6, s[24:27], s45 offen offset:2048  lds
    buffer_load_dwordx4 v6, s[24:27], s45 offen offset:3072  lds
    v_mov_b32 v7, 0
    buffer_load_ushort v8, v7, s[28:31], s47 offen
    buffer_load_dword v2, v7, s[24:27], s53 offen
    s_mul_i32 s48, s3, 4368
    s_add_u32 s48, s48, 0
    v_lshlrev_b32 v9, 2, v1
    v_add_u32 v10, s48, v9
    v_add_u32 v9, s46, v9
    ds_write_b32 v10, v7
    ds_write_b32 v9, v7
    s_lshl_b32 s49, s3, 7
    v_lshlrev_b32 v9, 4, v3
    v_add_u32 v9, s49, v9
    v_mul_u32_u24 v10, 4368, v4
    v_add_u32 v10, v10, v9
    v_lshrrev_b32 v12, 4, v1
    v_bfe_u32 v13, v1, 2, 2
    v_and_b32 v14, 3, v1
    v_lshlrev_b32 v15, 5, v14
    v_lshl_add_u32 v15, v13, 3, v15
    v_lshl_add_u32 v15, v12, 6, v15
    v_add_u32 v15, s46, v15
    v_add_u32 v15, 160, v15
    v_sub_u32 v14, v14, v13
    v_lshlrev_b32 v12, 3, v12
    v_sub_u32 v14, v14, v12
    v_lshlrev_b32 v14, 3, v14
    v_add_u32 v14, s48, v14
    v_add_u32 v14, 320, v14
    v_lshlrev_b32 v12, 1, v1
    v_add_u32 v12, s48, v12
    s_lshl_b32 s50, s3, 1
    v_add_u32 v9, s50, v6
    s_mov_b32 s52, 0xffff0000
    v_lshrrev_b32 v11, 4, v1
    v_mul_u32_u24 v11, 18432, v11
    v_and_b32 v13, 15, v1
    v_lshl_add_u32 v11, v13, 4, v11
    s_lshl_b32 s42, s40, 8
    s_mul_i32 s43, s3, 73728
    s_add_u32 s42, s42, s43
    s_add_u32 s43, s42, 3801088
    s_add_u32 s42, s42, 9043968
    s_waitcnt vmcnt(9)
    ds_write_b128 v10, v[176:179] offset:256
    s_waitcnt vmcnt(8)
    ds_write_b128 v10, v[180:183] offset:1280
    s_waitcnt vmcnt(7)
    ds_write_b128 v10, v[184:187] offset:2304
    s_waitcnt vmcnt(6)
    ds_write_b128 v10, v[188:191] offset:3328
    s_waitcnt vmcnt(5)
    ds_read_b64_tr_b16 v[24:25], v15 offset:0
    ds_read_b64_tr_b16 v[26:27], v15 offset:32
    ds_read_b64_tr_b16 v[28:29], v15 offset:256
    ds_read_b64_tr_b16 v[30:31], v15 offset:288
    ds_read_b64_tr_b16 v[32:33], v15 offset:512
    ds_read_b64_tr_b16 v[34:35], v15 offset:544
    ds_read_b64_tr_b16 v[36:37], v15 offset:768
    ds_read_b64_tr_b16 v[38:39], v15 offset:800
    s_waitcnt vmcnt(4)
    ds_read_b64_tr_b16 v[40:41], v15 offset:1024
    ds_read_b64_tr_b16 v[42:43], v15 offset:1056
    ds_read_b64_tr_b16 v[44:45], v15 offset:1280
    ds_read_b64_tr_b16 v[46:47], v15 offset:1312
    ds_read_b64_tr_b16 v[48:49], v15 offset:1536
    ds_read_b64_tr_b16 v[50:51], v15 offset:1568
    s_waitcnt lgkmcnt(14)
    s_barrier
    ds_read_b64_tr_b16 v[52:53], v15 offset:1792
    ds_read_b64_tr_b16 v[54:55], v15 offset:1824
    s_waitcnt vmcnt(3)
    ds_read_b64_tr_b16 v[56:57], v15 offset:2048
    ds_read_b64_tr_b16 v[58:59], v15 offset:2080
    ds_read_b64_tr_b16 v[60:61], v15 offset:2304
    ds_read_b64_tr_b16 v[62:63], v15 offset:2336
    ds_read_b64_tr_b16 v[64:65], v15 offset:2560
    ds_read_b64_tr_b16 v[66:67], v15 offset:2592
    ds_read_b64_tr_b16 v[68:69], v15 offset:2816
    ds_read_b64_tr_b16 v[70:71], v15 offset:2848
    s_waitcnt vmcnt(2)
    ds_read_b64_tr_b16 v[72:73], v15 offset:3072
    ds_read_b64_tr_b16 v[74:75], v15 offset:3104
    s_waitcnt vmcnt(0)
    buffer_load_dwordx4 v[200:203], v11, s[24:27], s43 offen
    s_add_u32 s43, s43, 589824
    buffer_load_dwordx4 v[204:207], v11, s[24:27], s43 offen
    s_lshr_b32 s54, s3, 1
    s_lshl_b32 s55, s40, 2
    s_add_u32 s55, s55, s54
    s_add_u32 s55, s55, 800
    s_and_b32 s51, s3, 1
    s_cmp_eq_u32 s51, 0
    s_cselect_b32 s64, s60, s64
    s_cselect_b32 s65, s61, s65
    s_cmp_lt_u32 s55, 1296
    s_cselect_b32 s66, s66, 0
    s_lshl_b32 s54, s3, 12
    s_add_u32 s54, s54, 59520
    s_mul_i32 s56, s55, 3641
    s_lshr_b32 s56, s56, 18
    s_mul_i32 s59, s56, 72
    s_sub_u32 s57, s55, s59
    v_lshrrev_b32 v18, 3, v1
    v_mul_u32_u24 v16, 9216, v18
    v_and_b32 v18, 2, v18
    v_and_b32 v17, 7, v1
    v_xor_b32 v17, v17, v18
    v_lshl_add_u32 v16, v17, 4, v16
    v_xor_b32 v17, 64, v16
    s_mul_i32 s58, s56, 294912
    s_lshl_b32 s59, s57, 7
    s_add_u32 s58, s58, s59
    s_add_u32 m0, s54, 0
    s_add_u32 s59, s58, 0
    buffer_load_dwordx4 v16, s[64:67], s59 offen nt lds
    s_add_u32 m0, s54, 1024
    s_add_u32 s59, s58, 73728
    buffer_load_dwordx4 v17, s[64:67], s59 offen nt lds
    s_add_u32 m0, s54, 2048
    s_add_u32 s59, s58, 147456
    buffer_load_dwordx4 v16, s[64:67], s59 offen nt lds
    s_add_u32 m0, s54, 3072
    s_add_u32 s59, s58, 221184
    buffer_load_dwordx4 v17, s[64:67], s59 offen nt lds
    v_lshlrev_b32 v8, 16, v8
    v_mul_f32 v8, 0x3a000000, v8
    ds_read_b64_tr_b16 v[76:77], v14 offset:32
    ds_read_b64_tr_b16 v[78:79], v14 offset:0
    ds_read_b64_tr_b16 v[80:81], v14 offset:160
    ds_read_b64_tr_b16 v[82:83], v14 offset:128
    ds_read_b64_tr_b16 v[84:85], v14 offset:288
    ds_read_b64_tr_b16 v[86:87], v14 offset:256
    ds_read_b64_tr_b16 v[88:89], v14 offset:416
    ds_read_b64_tr_b16 v[90:91], v14 offset:384
    s_waitcnt lgkmcnt(15)
    s_waitcnt lgkmcnt(6)
    v_mfma_f32_16x16x32_f16 v[180:183], v[56:59], v[76:79], 0
    ds_read_b64_tr_b16 v[92:93], v14 offset:544
    ds_read_b64_tr_b16 v[94:95], v14 offset:512
    v_mfma_f32_16x16x32_f16 v[188:191], v[60:63], v[76:79], 0
    ds_read_b64_tr_b16 v[96:97], v14 offset:672
    ds_read_b64_tr_b16 v[98:99], v14 offset:640
    s_waitcnt lgkmcnt(8)
    v_mfma_f32_16x16x32_f16 v[176:179], v[52:55], v[80:83], 0
    ds_read_b64_tr_b16 v[100:101], v14 offset:800
    ds_read_b64_tr_b16 v[102:103], v14 offset:768
    v_mfma_f32_16x16x32_f16 v[184:187], v[56:59], v[80:83], 0
    ds_read_b64_tr_b16 v[104:105], v14 offset:928
    ds_read_b64_tr_b16 v[106:107], v14 offset:896
    s_waitcnt lgkmcnt(10)
    v_mfma_f32_16x16x32_f16 v[180:183], v[52:55], v[84:87], v[180:183]
    ds_read_b64_tr_b16 v[108:109], v14 offset:1056
    ds_read_b64_tr_b16 v[110:111], v14 offset:1024
    v_mfma_f32_16x16x32_f16 v[188:191], v[56:59], v[84:87], v[188:191]
    ds_read_b64_tr_b16 v[112:113], v14 offset:1184
    ds_read_b64_tr_b16 v[114:115], v14 offset:1152
    s_waitcnt lgkmcnt(12)
    v_mfma_f32_16x16x32_f16 v[176:179], v[48:51], v[88:91], v[176:179]
    ds_read_b64_tr_b16 v[116:117], v14 offset:1312
    ds_read_b64_tr_b16 v[118:119], v14 offset:1280
    v_mfma_f32_16x16x32_f16 v[184:187], v[52:55], v[88:91], v[184:187]
    ds_read_b64_tr_b16 v[120:121], v14 offset:1440
    ds_read_b64_tr_b16 v[122:123], v14 offset:1408
    s_waitcnt lgkmcnt(14)
    v_mfma_f32_16x16x32_f16 v[180:183], v[48:51], v[92:95], v[180:183]
    ds_read_b64_tr_b16 v[124:125], v14 offset:1568
    ds_read_b64_tr_b16 v[126:127], v14 offset:1536
    v_mfma_f32_16x16x32_f16 v[188:191], v[52:55], v[92:95], v[188:191]
    ds_read_b64_tr_b16 v[128:129], v14 offset:1696
    ds_read_b64_tr_b16 v[130:131], v14 offset:1664
    s_waitcnt lgkmcnt(15)
    v_mfma_f32_16x16x32_f16 v[176:179], v[44:47], v[96:99], v[176:179]
    ds_read_u16 v208, v12 offset:2304
    v_mfma_f32_16x16x32_f16 v[184:187], v[48:51], v[96:99], v[184:187]
    ds_read_b64_tr_b16 v[132:133], v14 offset:1824
    ds_read_b64_tr_b16 v[134:135], v14 offset:1792
    s_waitcnt lgkmcnt(15)
    v_mfma_f32_16x16x32_f16 v[180:183], v[44:47], v[100:103], v[180:183]
    ds_read_u16 v209, v12 offset:2432
    v_mfma_f32_16x16x32_f16 v[188:191], v[48:51], v[100:103], v[188:191]
    ds_read_b64_tr_b16 v[136:137], v14 offset:1952
    ds_read_b64_tr_b16 v[138:139], v14 offset:1920
    v_mfma_f32_16x16x32_f16 v[176:179], v[40:43], v[104:107], v[176:179]
    ds_read_u16 v210, v12 offset:2560
    v_mfma_f32_16x16x32_f16 v[184:187], v[44:47], v[104:107], v[184:187]
    ds_read_b64_tr_b16 v[140:141], v14 offset:2080
    ds_read_b64_tr_b16 v[142:143], v14 offset:2048
    s_waitcnt lgkmcnt(15)
    v_mfma_f32_16x16x32_f16 v[180:183], v[40:43], v[108:111], v[180:183]
    ds_read_u16 v211, v12 offset:2688
    v_mfma_f32_16x16x32_f16 v[188:191], v[44:47], v[108:111], v[188:191]
    ds_read_b64_tr_b16 v[144:145], v14 offset:2208
    ds_read_b64_tr_b16 v[146:147], v14 offset:2176
    v_mfma_f32_16x16x32_f16 v[176:179], v[36:39], v[112:115], v[176:179]
    ds_read_u16 v212, v12 offset:2816
    v_mfma_f32_16x16x32_f16 v[184:187], v[40:43], v[112:115], v[184:187]
    ds_read_b64_tr_b16 v[148:149], v14 offset:2336
    ds_read_b64_tr_b16 v[150:151], v14 offset:2304
    v_mfma_f32_16x16x32_f16 v[180:183], v[36:39], v[116:119], v[180:183]
    ds_read_u16 v213, v12 offset:2944
    v_mfma_f32_16x16x32_f16 v[188:191], v[40:43], v[116:119], v[188:191]
    ds_read_b64_tr_b16 v[152:153], v14 offset:2464
    ds_read_b64_tr_b16 v[154:155], v14 offset:2432
    s_waitcnt lgkmcnt(15)
    v_mfma_f32_16x16x32_f16 v[176:179], v[32:35], v[120:123], v[176:179]
    ds_read_u16 v214, v12 offset:3072
    v_mfma_f32_16x16x32_f16 v[184:187], v[36:39], v[120:123], v[184:187]
    ds_read_b64_tr_b16 v[156:157], v14 offset:2592
    ds_read_b64_tr_b16 v[158:159], v14 offset:2560
    v_mfma_f32_16x16x32_f16 v[180:183], v[32:35], v[124:127], v[180:183]
    ds_read_u16 v215, v12 offset:3200
    v_mfma_f32_16x16x32_f16 v[188:191], v[36:39], v[124:127], v[188:191]
    ds_read_b64_tr_b16 v[160:161], v14 offset:2720
    ds_read_b64_tr_b16 v[162:163], v14 offset:2688
    v_mfma_f32_16x16x32_f16 v[176:179], v[28:31], v[128:131], v[176:179]
    ds_read_u16 v216, v12 offset:3328
    v_mfma_f32_16x16x32_f16 v[184:187], v[32:35], v[128:131], v[184:187]
    ds_read_b64_tr_b16 v[164:165], v14 offset:2848
    ds_read_b64_tr_b16 v[166:167], v14 offset:2816
    v_mfma_f32_16x16x32_f16 v[180:183], v[28:31], v[132:135], v[180:183]
    ds_read_b64_tr_b16 v[168:169], v14 offset:2976
    ds_read_b64_tr_b16 v[170:171], v14 offset:2944
    v_mfma_f32_16x16x32_f16 v[188:191], v[32:35], v[132:135], v[188:191]
    ds_read_b64_tr_b16 v[172:173], v14 offset:3104
    ds_read_b64_tr_b16 v[174:175], v14 offset:3072
    s_waitcnt lgkmcnt(15)
    v_mfma_f32_16x16x32_f16 v[176:179], v[24:27], v[136:139], v[176:179]
    v_mfma_f32_16x16x32_f16 v[184:187], v[28:31], v[136:139], v[184:187]
    v_mfma_f32_16x16x32_f16 v[180:183], v[24:27], v[140:143], v[180:183]
    v_mfma_f32_16x16x32_f16 v[188:191], v[28:31], v[140:143], v[188:191]
    v_mfma_f32_16x16x32_f16 v[184:187], v[24:27], v[144:147], v[184:187]
    v_mfma_f32_16x16x32_f16 v[188:191], v[24:27], v[148:151], v[188:191]
    v_mfma_f32_16x16x32_f16 v[192:195], v[60:63], v[80:83], 0
    s_nop 1
    v_add_f32_dpp v5, v179, v178 wave_shr:1 row_mask:0xf bank_mask:0xf bound_ctrl:0
    s_nop 0
    v_add_f32_dpp v13, v179, v182 wave_ror:1 row_mask:0xf bank_mask:0xf
    s_nop 1
    v_add_f32_dpp v13, v183, v182 wave_shr:1 row_mask:0xf bank_mask:0xf
    v_mfma_f32_16x16x32_f16 v[196:199], v[64:67], v[76:79], 0
    v_add_f32_dpp v4, v5, v177 wave_shr:1 row_mask:0xf bank_mask:0xf bound_ctrl:0
    v_add_f32_dpp v10, v5, v181 wave_ror:1 row_mask:0xf bank_mask:0xf
    s_nop 1
    v_add_f32_dpp v10, v13, v181 wave_shr:1 row_mask:0xf bank_mask:0xf
    v_mfma_f32_16x16x32_f16 v[192:195], v[56:59], v[88:91], v[192:195]
    v_add_f32_dpp v7, v4, v180 wave_ror:1 row_mask:0xf bank_mask:0xf
    s_nop 1
    v_add_f32_dpp v7, v10, v180 wave_shr:1 row_mask:0xf bank_mask:0xf
    v_mul_f32 v180, v2, v7
    v_mfma_f32_16x16x32_f16 v[196:199], v[60:63], v[84:87], v[196:199]
    v_add_f32_dpp v18, v183, v186 wave_ror:1 row_mask:0xf bank_mask:0xf
    v_add_f32_dpp v5, v187, v190 wave_ror:1 row_mask:0xf bank_mask:0xf
    s_nop 0
    v_add_f32_dpp v18, v187, v186 wave_shr:1 row_mask:0xf bank_mask:0xf
    v_mfma_f32_16x16x32_f16 v[192:195], v[52:55], v[96:99], v[192:195]
    v_add_f32_dpp v5, v191, v190 wave_shr:1 row_mask:0xf bank_mask:0xf
    v_add_f32_dpp v17, v13, v185 wave_ror:1 row_mask:0xf bank_mask:0xf
    v_add_f32_dpp v4, v18, v189 wave_ror:1 row_mask:0xf bank_mask:0xf
    v_mfma_f32_16x16x32_f16 v[196:199], v[56:59], v[92:95], v[196:199]
    v_add_f32_dpp v17, v18, v185 wave_shr:1 row_mask:0xf bank_mask:0xf
    v_add_f32_dpp v4, v5, v189 wave_shr:1 row_mask:0xf bank_mask:0xf
    v_add_f32_dpp v16, v10, v184 wave_ror:1 row_mask:0xf bank_mask:0xf
    v_mfma_f32_16x16x32_f16 v[192:195], v[48:51], v[104:107], v[192:195]
    v_add_f32_dpp v3, v17, v188 wave_ror:1 row_mask:0xf bank_mask:0xf
    v_add_f32_dpp v16, v17, v184 wave_shr:1 row_mask:0xf bank_mask:0xf
    s_nop 0
    v_add_f32_dpp v3, v4, v188 wave_shr:1 row_mask:0xf bank_mask:0xf
    v_mfma_f32_16x16x32_f16 v[196:199], v[52:55], v[100:103], v[196:199]
    v_mul_f32 v184, v2, v16
    v_mul_f32 v188, v2, v3
    v_fma_mix_f32 v208, v208, v8, 0 op_sel_hi:[1,0,0]
    v_mfma_f32_16x16x32_f16 v[192:195], v[44:47], v[112:115], v[192:195]
    v_fma_mix_f32 v209, v209, v8, 0 op_sel_hi:[1,0,0]
    v_cvt_pk_bf16_f32 v20, v180, v184
    v_cvt_pk_bf16_f32 v21, v208, v209
    v_mfma_f32_16x16x32_f16 v[196:199], v[48:51], v[108:111], v[196:199]
    v_lshlrev_b32 v22, 16, v20
    v_and_b32 v20, s52, v20
    v_lshlrev_b32 v23, 16, v21
    v_mfma_f32_16x16x32_f16 v[192:195], v[40:43], v[120:123], v[192:195]
    v_and_b32 v21, s52, v21
    v_add_f32 v22, v22, v23
    v_add_f32 v20, v20, v21
    v_mfma_f32_16x16x32_f16 v[196:199], v[44:47], v[116:119], v[196:199]
    v_cvt_pk_bf16_f32 v208, v22, v20
    ds_write_b16 v9, v208 offset:34944
    ds_write_b16_d16_hi v9, v208 offset:35968
    v_mfma_f32_16x16x32_f16 v[192:195], v[36:39], v[128:131], v[192:195]
    v_mfma_f32_16x16x32_f16 v[196:199], v[40:43], v[124:127], v[196:199]
    v_mfma_f32_16x16x32_f16 v[192:195], v[32:35], v[136:139], v[192:195]
    v_mfma_f32_16x16x32_f16 v[196:199], v[36:39], v[132:135], v[196:199]
    v_mfma_f32_16x16x32_f16 v[192:195], v[28:31], v[144:147], v[192:195]
    v_mfma_f32_16x16x32_f16 v[196:199], v[32:35], v[140:143], v[196:199]
    s_waitcnt lgkmcnt(15)
    v_mfma_f32_16x16x32_f16 v[192:195], v[24:27], v[152:155], v[192:195]
    v_mfma_f32_16x16x32_f16 v[196:199], v[28:31], v[148:151], v[196:199]
    s_waitcnt lgkmcnt(12)
    v_mfma_f32_16x16x32_f16 v[196:199], v[24:27], v[156:159], v[196:199]
    v_mfma_f32_16x16x32_f16 v[176:179], v[64:67], v[80:83], 0
    v_mfma_f32_16x16x32_f16 v[180:183], v[68:71], v[76:79], 0
    v_mfma_f32_16x16x32_f16 v[176:179], v[60:63], v[88:91], v[176:179]
    v_mfma_f32_16x16x32_f16 v[180:183], v[64:67], v[84:87], v[180:183]
    s_nop 0
    v_add_f32_dpp v13, v191, v194 wave_ror:1 row_mask:0xf bank_mask:0xf
    s_nop 1
    v_add_f32_dpp v18, v195, v198 wave_ror:1 row_mask:0xf bank_mask:0xf
    v_add_f32_dpp v13, v195, v194 wave_shr:1 row_mask:0xf bank_mask:0xf
    v_mfma_f32_16x16x32_f16 v[176:179], v[56:59], v[96:99], v[176:179]
    v_add_f32_dpp v18, v199, v198 wave_shr:1 row_mask:0xf bank_mask:0xf
    v_add_f32_dpp v10, v5, v193 wave_ror:1 row_mask:0xf bank_mask:0xf
    v_add_f32_dpp v17, v13, v197 wave_ror:1 row_mask:0xf bank_mask:0xf
    v_mfma_f32_16x16x32_f16 v[180:183], v[60:63], v[92:95], v[180:183]
    v_add_f32_dpp v10, v13, v193 wave_shr:1 row_mask:0xf bank_mask:0xf
    v_add_f32_dpp v17, v18, v197 wave_shr:1 row_mask:0xf bank_mask:0xf
    v_add_f32_dpp v7, v4, v192 wave_ror:1 row_mask:0xf bank_mask:0xf
    v_mfma_f32_16x16x32_f16 v[176:179], v[52:55], v[104:107], v[176:179]
    v_add_f32_dpp v16, v10, v196 wave_ror:1 row_mask:0xf bank_mask:0xf
    v_add_f32_dpp v7, v10, v192 wave_shr:1 row_mask:0xf bank_mask:0xf
    s_nop 0
    v_add_f32_dpp v16, v17, v196 wave_shr:1 row_mask:0xf bank_mask:0xf
    v_mfma_f32_16x16x32_f16 v[180:183], v[56:59], v[100:103], v[180:183]
    v_mul_f32 v192, v2, v7
    v_mul_f32 v196, v2, v16
    v_fma_mix_f32 v210, v210, v8, 0 op_sel_hi:[1,0,0]
    v_mfma_f32_16x16x32_f16 v[176:179], v[48:51], v[112:115], v[176:179]
    v_fma_mix_f32 v211, v211, v8, 0 op_sel_hi:[1,0,0]
    v_cvt_pk_bf16_f32 v20, v188, v192
    v_cvt_pk_bf16_f32 v21, v210, v211
    v_mfma_f32_16x16x32_f16 v[180:183], v[52:55], v[108:111], v[180:183]
    v_lshlrev_b32 v22, 16, v20
    v_and_b32 v20, s52, v20
    v_lshlrev_b32 v23, 16, v21
    v_mfma_f32_16x16x32_f16 v[176:179], v[44:47], v[120:123], v[176:179]
    v_and_b32 v21, s52, v21
    v_add_f32 v22, v22, v23
    v_add_f32 v20, v20, v21
    v_mfma_f32_16x16x32_f16 v[180:183], v[48:51], v[116:119], v[180:183]
    v_cvt_pk_bf16_f32 v210, v22, v20
    ds_write_b16 v9, v210 offset:36992
    ds_write_b16_d16_hi v9, v210 offset:38016
    v_mfma_f32_16x16x32_f16 v[176:179], v[40:43], v[128:131], v[176:179]
    v_mfma_f32_16x16x32_f16 v[180:183], v[44:47], v[124:127], v[180:183]
    v_mfma_f32_16x16x32_f16 v[176:179], v[36:39], v[136:139], v[176:179]
    v_mfma_f32_16x16x32_f16 v[180:183], v[40:43], v[132:135], v[180:183]
    v_mfma_f32_16x16x32_f16 v[176:179], v[32:35], v[144:147], v[176:179]
    v_mfma_f32_16x16x32_f16 v[180:183], v[36:39], v[140:143], v[180:183]
    v_mfma_f32_16x16x32_f16 v[176:179], v[28:31], v[152:155], v[176:179]
    v_mfma_f32_16x16x32_f16 v[180:183], v[32:35], v[148:151], v[180:183]
    s_waitcnt lgkmcnt(11)
    v_mfma_f32_16x16x32_f16 v[176:179], v[24:27], v[160:163], v[176:179]
    v_mfma_f32_16x16x32_f16 v[180:183], v[28:31], v[156:159], v[180:183]
    s_waitcnt lgkmcnt(8)
    v_mfma_f32_16x16x32_f16 v[180:183], v[24:27], v[164:167], v[180:183]
    v_mfma_f32_16x16x32_f16 v[184:187], v[68:71], v[80:83], 0
    v_mfma_f32_16x16x32_f16 v[188:191], v[72:75], v[76:79], 0
    v_mfma_f32_16x16x32_f16 v[184:187], v[64:67], v[88:91], v[184:187]
    v_mfma_f32_16x16x32_f16 v[188:191], v[68:71], v[84:87], v[188:191]
    s_nop 0
    v_add_f32_dpp v5, v199, v178 wave_ror:1 row_mask:0xf bank_mask:0xf
    s_nop 1
    v_add_f32_dpp v13, v179, v182 wave_ror:1 row_mask:0xf bank_mask:0xf
    v_add_f32_dpp v5, v179, v178 wave_shr:1 row_mask:0xf bank_mask:0xf
    v_mfma_f32_16x16x32_f16 v[184:187], v[60:63], v[96:99], v[184:187]
    v_add_f32_dpp v13, v183, v182 wave_shr:1 row_mask:0xf bank_mask:0xf
    v_add_f32_dpp v4, v18, v177 wave_ror:1 row_mask:0xf bank_mask:0xf
    v_add_f32_dpp v10, v5, v181 wave_ror:1 row_mask:0xf bank_mask:0xf
    v_mfma_f32_16x16x32_f16 v[188:191], v[64:67], v[92:95], v[188:191]
    v_add_f32_dpp v4, v5, v177 wave_shr:1 row_mask:0xf bank_mask:0xf
    v_add_f32_dpp v10, v13, v181 wave_shr:1 row_mask:0xf bank_mask:0xf
    v_add_f32_dpp v3, v17, v176 wave_ror:1 row_mask:0xf bank_mask:0xf
    v_mfma_f32_16x16x32_f16 v[184:187], v[56:59], v[104:107], v[184:187]
    v_add_f32_dpp v7, v4, v180 wave_ror:1 row_mask:0xf bank_mask:0xf
    v_add_f32_dpp v3, v4, v176 wave_shr:1 row_mask:0xf bank_mask:0xf
    s_nop 0
    v_add_f32_dpp v7, v10, v180 wave_shr:1 row_mask:0xf bank_mask:0xf
    v_mfma_f32_16x16x32_f16 v[188:191], v[60:63], v[100:103], v[188:191]
    v_mul_f32 v176, v2, v3
    v_mul_f32 v180, v2, v7
    v_fma_mix_f32 v212, v212, v8, 0 op_sel_hi:[1,0,0]
    v_mfma_f32_16x16x32_f16 v[184:187], v[52:55], v[112:115], v[184:187]
    v_fma_mix_f32 v213, v213, v8, 0 op_sel_hi:[1,0,0]
    v_cvt_pk_bf16_f32 v20, v196, v176
    v_cvt_pk_bf16_f32 v21, v212, v213
    v_mfma_f32_16x16x32_f16 v[188:191], v[56:59], v[108:111], v[188:191]
    v_lshlrev_b32 v22, 16, v20
    v_and_b32 v20, s52, v20
    v_lshlrev_b32 v23, 16, v21
    v_mfma_f32_16x16x32_f16 v[184:187], v[48:51], v[120:123], v[184:187]
    v_and_b32 v21, s52, v21
    v_add_f32 v22, v22, v23
    v_add_f32 v20, v20, v21
    v_mfma_f32_16x16x32_f16 v[188:191], v[52:55], v[116:119], v[188:191]
    v_cvt_pk_bf16_f32 v212, v22, v20
    ds_write_b16 v9, v212 offset:39040
    ds_write_b16_d16_hi v9, v212 offset:40064
    v_mfma_f32_16x16x32_f16 v[184:187], v[44:47], v[128:131], v[184:187]
    v_mfma_f32_16x16x32_f16 v[188:191], v[48:51], v[124:127], v[188:191]
    v_mfma_f32_16x16x32_f16 v[184:187], v[40:43], v[136:139], v[184:187]
    v_mfma_f32_16x16x32_f16 v[188:191], v[44:47], v[132:135], v[188:191]
    v_mfma_f32_16x16x32_f16 v[184:187], v[36:39], v[144:147], v[184:187]
    v_mfma_f32_16x16x32_f16 v[188:191], v[40:43], v[140:143], v[188:191]
    v_mfma_f32_16x16x32_f16 v[184:187], v[32:35], v[152:155], v[184:187]
    v_mfma_f32_16x16x32_f16 v[188:191], v[36:39], v[148:151], v[188:191]
    v_mfma_f32_16x16x32_f16 v[184:187], v[28:31], v[160:163], v[184:187]
    v_mfma_f32_16x16x32_f16 v[188:191], v[32:35], v[156:159], v[188:191]
    s_waitcnt lgkmcnt(8)
    v_mfma_f32_16x16x32_f16 v[184:187], v[24:27], v[168:171], v[184:187]
    v_mfma_f32_16x16x32_f16 v[188:191], v[28:31], v[164:167], v[188:191]
    s_waitcnt lgkmcnt(6)
    v_mfma_f32_16x16x32_f16 v[188:191], v[24:27], v[172:175], v[188:191]
    s_nop 4
    v_add_f32_dpp v18, v183, v186 wave_ror:1 row_mask:0xf bank_mask:0xf
    s_nop 1
    v_add_f32_dpp v5, v187, v190 wave_ror:1 row_mask:0xf bank_mask:0xf
    v_add_f32_dpp v18, v187, v186 wave_shr:1 row_mask:0xf bank_mask:0xf
    s_nop 0
    v_add_f32_dpp v5, v191, v190 wave_shr:1 row_mask:0xf bank_mask:0xf
    v_add_f32_dpp v17, v13, v185 wave_ror:1 row_mask:0xf bank_mask:0xf
    v_add_f32_dpp v4, v18, v189 wave_ror:1 row_mask:0xf bank_mask:0xf
    s_nop 0
    v_add_f32_dpp v17, v18, v185 wave_shr:1 row_mask:0xf bank_mask:0xf
    v_add_f32_dpp v4, v5, v189 wave_shr:1 row_mask:0xf bank_mask:0xf
    v_add_f32_dpp v16, v10, v184 wave_ror:1 row_mask:0xf bank_mask:0xf
    v_add_f32_dpp v3, v17, v188 wave_ror:1 row_mask:0xf bank_mask:0xf
    s_nop 0
    v_add_f32_dpp v16, v17, v184 wave_shr:1 row_mask:0xf bank_mask:0xf
    v_add_f32_dpp v3, v4, v188 wave_shr:1 row_mask:0xf bank_mask:0xf
    v_mul_f32 v184, v2, v16
    v_mul_f32 v188, v2, v3
    v_fma_mix_f32 v214, v214, v8, 0 op_sel_hi:[1,0,0]
    v_fma_mix_f32 v215, v215, v8, 0 op_sel_hi:[1,0,0]
    v_cvt_pk_bf16_f32 v20, v180, v184
    v_cvt_pk_bf16_f32 v21, v214, v215
    v_lshlrev_b32 v22, 16, v20
    v_and_b32 v20, s52, v20
    v_lshlrev_b32 v23, 16, v21
    v_and_b32 v21, s52, v21
    v_add_f32 v22, v22, v23
    v_add_f32 v20, v20, v21
    v_cvt_pk_bf16_f32 v214, v22, v20
    ds_write_b16 v9, v214 offset:41088
    ds_write_b16_d16_hi v9, v214 offset:42112
    v_fma_mix_f32 v216, v216, v8, 0 op_sel_hi:[1,0,0]
    v_cvt_pk_bf16_f32 v20, v188, v188
    v_cvt_pk_bf16_f32 v21, v216, v216
    v_lshlrev_b32 v22, 16, v20
    v_and_b32 v20, s52, v20
    v_lshlrev_b32 v23, 16, v21
    v_and_b32 v21, s52, v21
    v_add_f32 v22, v22, v23
    v_add_f32 v20, v20, v21
    v_cvt_pk_bf16_f32 v216, v22, v20
    ds_write_b16 v9, v216 offset:43136
    v_lshlrev_b32 v7, 3, v1
    v_mov_b32 v5, 0x3f803f80
    s_lshl_b32 s41, s3, 10
    v_add_u32 v6, s41, v6
    s_mul_i32 s43, s40, 16512
    s_lshl_b32 s44, s3, 9
    s_add_u32 s43, s43, s44
    s_add_u32 s43, s43, 10493952
    s_nop 0
    s_waitcnt lgkmcnt(0)
    s_barrier
    ds_read_b128 v[24:27], v6 offset:34944
    ds_read_b128 v[48:51], v6 offset:43136
    s_waitcnt vmcnt(4)
    v_lshlrev_b32 v40, 16, v200
    v_and_b32 v41, s52, v200
    v_lshlrev_b32 v42, 16, v201
    v_and_b32 v43, s52, v201
    v_lshlrev_b32 v44, 16, v202
    v_and_b32 v45, s52, v202
    v_lshlrev_b32 v46, 16, v203
    v_and_b32 v47, s52, v203
    v_mov_b32 v28, 0
    v_mov_b32 v29, 0
    s_waitcnt lgkmcnt(1)
    v_lshlrev_b32 v32, 16, v24
    v_and_b32 v33, s52, v24
    v_lshlrev_b32 v34, 16, v25
    v_and_b32 v35, s52, v25
    v_lshlrev_b32 v36, 16, v26
    v_and_b32 v37, s52, v26
    v_lshlrev_b32 v38, 16, v27
    v_and_b32 v39, s52, v27
    v_pk_add_f32 v[32:33], v[32:33], v[40:41]
    v_pk_add_f32 v[34:35], v[34:35], v[42:43]
    v_pk_add_f32 v[36:37], v[36:37], v[44:45]
    v_pk_add_f32 v[38:39], v[38:39], v[46:47]
    v_cvt_pk_bf16_f32 v24, v32, v33
    v_cvt_pk_bf16_f32 v25, v34, v35
    v_cvt_pk_bf16_f32 v26, v36, v37
    v_cvt_pk_bf16_f32 v27, v38, v39
    buffer_store_dwordx4 v[24:27], v11, s[24:27], s42 offen sc1
    v_dot2c_f32_bf16 v28, v24, v5
L_pad_k2_kernel_2:
    s_cbranch_execz k2_kernel_end
    v_dot2c_f32_bf16 v29, v24, v24
    v_dot2c_f32_bf16 v28, v25, v5
    v_dot2c_f32_bf16 v29, v25, v25
    v_dot2c_f32_bf16 v28, v26, v5
    v_dot2c_f32_bf16 v29, v26, v26
    v_dot2c_f32_bf16 v28, v27, v5
    v_dot2c_f32_bf16 v29, v27, v27
    s_nop 2
    buffer_store_dwordx2 v[28:29], v7, s[24:27], s43 offen sc1
    s_add_u32 s42, s42, 589824
    s_add_u32 s43, s43, 4096
    s_cmp_ge_u32 s3, 1
    s_cbranch_scc1 k2_kernel_e1
    v_lshlrev_b32 v64, 16, v204
    v_and_b32 v65, s52, v204
    v_lshlrev_b32 v66, 16, v205
    v_and_b32 v67, s52, v205
    v_lshlrev_b32 v68, 16, v206
    v_and_b32 v69, s52, v206
    v_lshlrev_b32 v70, 16, v207
    v_and_b32 v71, s52, v207
    v_mov_b32 v52, 0
    v_mov_b32 v53, 0
    s_waitcnt lgkmcnt(0)
    v_lshlrev_b32 v56, 16, v48
    v_and_b32 v57, s52, v48
    v_lshlrev_b32 v58, 16, v49
    v_and_b32 v59, s52, v49
    v_lshlrev_b32 v60, 16, v50
    v_and_b32 v61, s52, v50
    v_lshlrev_b32 v62, 16, v51
    v_and_b32 v63, s52, v51
    v_pk_add_f32 v[56:57], v[56:57], v[64:65]
    v_pk_add_f32 v[58:59], v[58:59], v[66:67]
    v_pk_add_f32 v[60:61], v[60:61], v[68:69]
    v_pk_add_f32 v[62:63], v[62:63], v[70:71]
    v_cvt_pk_bf16_f32 v48, v56, v57
    v_cvt_pk_bf16_f32 v49, v58, v59
    v_cvt_pk_bf16_f32 v50, v60, v61
    v_cvt_pk_bf16_f32 v51, v62, v63
    buffer_store_dwordx4 v[48:51], v11, s[24:27], s42 offen sc1
    v_dot2c_f32_bf16 v52, v48, v5
    v_dot2c_f32_bf16 v53, v48, v48
    v_dot2c_f32_bf16 v52, v49, v5
    v_dot2c_f32_bf16 v53, v49, v49
    v_dot2c_f32_bf16 v52, v50, v5
    v_dot2c_f32_bf16 v53, v50, v50
    v_dot2c_f32_bf16 v52, v51, v5
    v_dot2c_f32_bf16 v53, v51, v51
    s_nop 2
    buffer_store_dwordx2 v[52:53], v7, s[24:27], s43 offen sc1
k2_kernel_e1:
    s_cmp_ge_u32 s55, 1296
    s_cbranch_scc1 k2_kernel_nf1
    v_lshrrev_b32 v105, 4, v1
    v_lshlrev_b32 v108, 10, v105
    v_and_b32 v105, 1, v105
    v_lshlrev_b32 v105, 6, v105
    v_bfe_u32 v109, v1, 2, 2
    v_lshl_add_u32 v108, v109, 7, v108
    v_bfe_u32 v109, v1, 3, 1
    v_lshl_add_u32 v105, v109, 5, v105
    v_and_b32 v109, 3, v1
    v_lshl_add_u32 v108, v109, 3, v108
    v_add_u32 v108, v108, v105
    v_add_u32 v108, s54, v108
    v_xor_b32 v109, 32, v108
    v_xor_b32 v110, 64, v108
    v_xor_b32 v111, 96, v108
    v_mov_b32 v112, 0x3f803f80
    v_mov_b32 v113, 0x3f803f80
    v_mov_b32 v114, 0x3f803f80
    v_mov_b32 v115, 0x3f803f80
    v_lshlrev_b32 v104, 4, v1
    v_and_b32 v105, 15, v1
    v_and_b32 v106, 48, v1
    v_lshl_add_u32 v106, v105, 7, v106
    s_mul_i32 s58, s57, 147456
    s_lshl_b32 s59, s56, 11
    s_add_u32 s58, s58, s59
    s_lshl_b32 s59, s51, 10
    s_add_u32 s58, s58, s59
    s_add_u32 s58, s58, 16777216
    s_mul_i32 s56, s56, 36864
    s_lshl_b32 s59, s57, 9
    s_add_u32 s56, s56, s59
    s_lshl_b32 s59, s51, 6
    s_add_u32 s56, s56, s59
    s_add_u32 s56, s56, 12582912
    s_waitcnt vmcnt(2) lgkmcnt(0)
    ds_read_b64_tr_b16 v[116:117], v108
    ds_read_b64_tr_b16 v[118:119], v108 offset:512
    ds_read_b64_tr_b16 v[120:121], v109
    ds_read_b64_tr_b16 v[122:123], v109 offset:512
    ds_read_b64_tr_b16 v[124:125], v110
    ds_read_b64_tr_b16 v[126:127], v110 offset:512
    ds_read_b64_tr_b16 v[128:129], v111
    ds_read_b64_tr_b16 v[130:131], v111 offset:512
    s_waitcnt lgkmcnt(6)
    buffer_store_dwordx4 v[116:119], v104, s[24:27], s58 offen sc1
    v_mfma_f32_16x16x32_bf16 v[132:135], v[116:119], v[112:115], 0
    s_add_u32 s58, s58, 36864
    s_waitcnt lgkmcnt(4)
    buffer_store_dwordx4 v[120:123], v104, s[24:27], s58 offen sc1
    v_mfma_f32_16x16x32_bf16 v[136:139], v[120:123], v[112:115], 0
    s_add_u32 s58, s58, 36864
    s_waitcnt lgkmcnt(2)
    buffer_store_dwordx4 v[124:127], v104, s[24:27], s58 offen sc1
    v_mfma_f32_16x16x32_bf16 v[140:143], v[124:127], v[112:115], 0
    s_add_u32 s58, s58, 36864
    s_waitcnt lgkmcnt(0)
    buffer_store_dwordx4 v[128:131], v104, s[24:27], s58 offen sc1
    v_mfma_f32_16x16x32_bf16 v[144:147], v[128:131], v[112:115], 0
    v_cmp_eq_u32 vcc, 1, v105
    s_nop 1
    v_cndmask_b32 v132, v132, v136, vcc
    v_cndmask_b32 v133, v133, v137, vcc
    v_cndmask_b32 v134, v134, v138, vcc
    v_cndmask_b32 v135, v135, v139, vcc
    v_cmp_eq_u32 vcc, 2, v105
    s_nop 1
    v_cndmask_b32 v132, v132, v140, vcc
    v_cndmask_b32 v133, v133, v141, vcc
    v_cndmask_b32 v134, v134, v142, vcc
    v_cndmask_b32 v135, v135, v143, vcc
    v_cmp_eq_u32 vcc, 3, v105
    s_nop 1
    v_cndmask_b32 v132, v132, v144, vcc
    v_cndmask_b32 v133, v133, v145, vcc
    v_cndmask_b32 v134, v134, v146, vcc
    v_cndmask_b32 v135, v135, v147, vcc
    s_mov_b32 exec_lo, 0x000f000f
    s_mov_b32 exec_hi, 0x000f000f
    buffer_store_dwordx4 v[132:135], v106, s[24:27], s56 offen sc1
    s_mov_b64 exec, -1
k2_kernel_nf1:
    s_mov_b64 exec, 0
    s_cmp_eq_u32 s3, 0
    s_cbranch_scc1 L_pad_k3_kernel_0
    s_cmp_eq_u32 s3, 1
    s_cbranch_scc1 L_pad_k3_kernel_1
    s_cmp_eq_u32 s3, 2
    s_cbranch_scc1 L_pad_k3_kernel_2
    s_cmp_eq_u32 s3, 3
    s_cbranch_scc1 L_pad_k3_kernel_3
    s_cmp_eq_u32 s3, 4
    s_cbranch_scc1 L_pad_k3_kernel_4
    s_cmp_eq_u32 s3, 5
    s_cbranch_scc1 L_pad_k3_kernel_5
    s_cmp_eq_u32 s3, 6
    s_cbranch_scc1 L_pad_k3_kernel_6
    s_cmp_eq_u32 s3, 7
    s_cbranch_scc1 L_pad_k3_kernel_7
    s_endpgm
k2_kernel_p2:
    v_lshrrev_b32 v3, 3, v1
    v_and_b32 v4, 7, v1
    v_mul_u32_u24 v5, 9216, v3
    v_lshl_add_u32 v5, v4, 4, v5
    s_mul_i32 s41, s3, 73728
    s_lshl_b32 s42, s40, 7
    s_add_u32 s41, s41, s42
    s_add_u32 s43, s41, 0
    buffer_load_dwordx4 v[216:219], v5, s[24:27], s43 offen
    s_add_u32 s43, s43, 589824
    buffer_load_dwordx4 v[220:223], v5, s[24:27], s43 offen
    s_add_u32 s43, s43, 589824
    buffer_load_dwordx4 v[224:227], v5, s[24:27], s43 offen
    s_add_u32 s43, s43, 589824
    buffer_load_dwordx4 v[228:231], v5, s[24:27], s43 offen
    v_lshlrev_b32 v6, 4, v1
    s_lshl_b32 s44, s40, 3
    s_add_u32 s44, s44, s3
    s_lshl_b32 s45, s44, 12
    s_add_u32 s45, s45, 5242880
    s_mul_i32 s46, s3, 4352
    s_add_u32 s46, s46, 103040
    s_add_u32 m0, s46, 256
    s_lshl_b32 s47, s44, 1
    s_lshl_b32 s53, s44, 2
    s_add_u32 s53, s53, 13697024
    buffer_load_dwordx4 v6, s[24:27], s45 offen offset:0  lds
    buffer_load_dwordx4 v6, s[24:27], s45 offen offset:1024  lds
    buffer_load_dwordx4 v6, s[24:27], s45 offen offset:2048  lds
    buffer_load_dwordx4 v6, s[24:27], s45 offen offset:3072  lds
    v_mov_b32 v7, 0
    buffer_load_ushort v8, v7, s[28:31], s47 offen
    buffer_load_dword v2, v7, s[24:27], s53 offen
    s_mul_i32 s48, s3, 4368
    s_add_u32 s48, s48, 0
    v_lshlrev_b32 v9, 2, v1
    v_add_u32 v10, s48, v9
    v_add_u32 v9, s46, v9
    ds_write_b32 v10, v7
    ds_write_b32 v9, v7
    s_lshl_b32 s49, s3, 7
    v_lshlrev_b32 v9, 4, v3
    v_add_u32 v9, s49, v9
    v_mul_u32_u24 v10, 4368, v4
    v_add_u32 v10, v10, v9
    v_lshrrev_b32 v12, 4, v1
    v_bfe_u32 v13, v1, 2, 2
    v_and_b32 v14, 3, v1
    v_lshlrev_b32 v15, 5, v14
    v_lshl_add_u32 v15, v13, 3, v15
    v_lshl_add_u32 v15, v12, 6, v15
    v_add_u32 v15, s46, v15
    v_add_u32 v15, 160, v15
    v_sub_u32 v14, v14, v13
    v_lshlrev_b32 v12, 3, v12
    v_sub_u32 v14, v14, v12
    v_lshlrev_b32 v14, 3, v14
    v_add_u32 v14, s48, v14
    v_add_u32 v14, 320, v14
    v_lshlrev_b32 v12, 1, v1
    v_add_u32 v12, s48, v12
    s_lshl_b32 s50, s3, 1
    v_add_u32 v9, s50, v6
    s_mov_b32 s52, 0xffff0000
    v_lshrrev_b32 v11, 4, v1
    v_mul_u32_u24 v11, 18432, v11
    v_and_b32 v13, 15, v1
    v_lshl_add_u32 v11, v13, 4, v11
    s_lshl_b32 s42, s40, 8
    s_mul_i32 s43, s3, 73728
    s_add_u32 s42, s42, s43
    s_add_u32 s43, s42, 4464640
    s_add_u32 s42, s42, 9707520
    s_waitcnt vmcnt(9)
    ds_write_b128 v10, v[216:219] offset:256
    s_waitcnt vmcnt(8)
    ds_write_b128 v10, v[220:223] offset:1280
    s_waitcnt vmcnt(7)
    ds_write_b128 v10, v[224:227] offset:2304
    s_waitcnt vmcnt(6)
    ds_write_b128 v10, v[228:231] offset:3328
    s_waitcnt vmcnt(5)
    ds_read_b64_tr_b16 v[24:25], v15 offset:0
    ds_read_b64_tr_b16 v[26:27], v15 offset:32
    ds_read_b64_tr_b16 v[28:29], v15 offset:256
    ds_read_b64_tr_b16 v[30:31], v15 offset:288
    ds_read_b64_tr_b16 v[32:33], v15 offset:512
    ds_read_b64_tr_b16 v[34:35], v15 offset:544
    ds_read_b64_tr_b16 v[36:37], v15 offset:768
    ds_read_b64_tr_b16 v[38:39], v15 offset:800
    s_waitcnt vmcnt(4)
    ds_read_b64_tr_b16 v[40:41], v15 offset:1024
    ds_read_b64_tr_b16 v[42:43], v15 offset:1056
    ds_read_b64_tr_b16 v[44:45], v15 offset:1280
    ds_read_b64_tr_b16 v[46:47], v15 offset:1312
    ds_read_b64_tr_b16 v[48:49], v15 offset:1536
    ds_read_b64_tr_b16 v[50:51], v15 offset:1568
    s_waitcnt lgkmcnt(14)
    s_barrier
    ds_read_b64_tr_b16 v[52:53], v15 offset:1792
    ds_read_b64_tr_b16 v[54:55], v15 offset:1824
    s_waitcnt vmcnt(3)
    ds_read_b64_tr_b16 v[56:57], v15 offset:2048
    ds_read_b64_tr_b16 v[58:59], v15 offset:2080
    ds_read_b64_tr_b16 v[60:61], v15 offset:2304
    ds_read_b64_tr_b16 v[62:63], v15 offset:2336
    ds_read_b64_tr_b16 v[64:65], v15 offset:2560
    ds_read_b64_tr_b16 v[66:67], v15 offset:2592
    ds_read_b64_tr_b16 v[68:69], v15 offset:2816
    ds_read_b64_tr_b16 v[70:71], v15 offset:2848
    s_waitcnt vmcnt(2)
    ds_read_b64_tr_b16 v[72:73], v15 offset:3072
    ds_read_b64_tr_b16 v[74:75], v15 offset:3104
    ds_read_b64_tr_b16 v[76:77], v15 offset:3328
    ds_read_b64_tr_b16 v[78:79], v15 offset:3360
    ds_read_b64_tr_b16 v[80:81], v15 offset:3584
    ds_read_b64_tr_b16 v[82:83], v15 offset:3616
    ds_read_b64_tr_b16 v[84:85], v15 offset:3840
    ds_read_b64_tr_b16 v[86:87], v15 offset:3872
    s_waitcnt vmcnt(0)
    buffer_load_dwordx4 v[240:243], v11, s[24:27], s43 offen
    s_lshr_b32 s54, s3, 1
    s_lshl_b32 s55, s40, 2
    s_add_u32 s55, s55, s54
    s_add_u32 s55, s55, 1088
    s_and_b32 s51, s3, 1
    s_cmp_eq_u32 s51, 0
    s_cselect_b32 s64, s60, s64
    s_cselect_b32 s65, s61, s65
    s_cmp_lt_u32 s55, 1296
    s_cselect_b32 s66, s66, 0
    s_lshl_b32 s54, s3, 12
    s_add_u32 s54, s54, 59520
    s_mul_i32 s56, s55, 3641
    s_lshr_b32 s56, s56, 18
    s_mul_i32 s59, s56, 72
    s_sub_u32 s57, s55, s59
    v_lshrrev_b32 v18, 3, v1
    v_mul_u32_u24 v16, 9216, v18
    v_and_b32 v18, 2, v18
    v_and_b32 v17, 7, v1
    v_xor_b32 v17, v17, v18
    v_lshl_add_u32 v16, v17, 4, v16
    v_xor_b32 v17, 64, v16
    s_mul_i32 s58, s56, 294912
    s_lshl_b32 s59, s57, 7
    s_add_u32 s58, s58, s59
    s_add_u32 m0, s54, 0
    s_add_u32 s59, s58, 0
    buffer_load_dwordx4 v16, s[64:67], s59 offen nt lds
    s_add_u32 m0, s54, 1024
    s_add_u32 s59, s58, 73728
    buffer_load_dwordx4 v17, s[64:67], s59 offen nt lds
    s_add_u32 m0, s54, 2048
    s_add_u32 s59, s58, 147456
    buffer_load_dwordx4 v16, s[64:67], s59 offen nt lds
    s_add_u32 m0, s54, 3072
    s_add_u32 s59, s58, 221184
    buffer_load_dwordx4 v17, s[64:67], s59 offen nt lds
    v_lshlrev_b32 v8, 16, v8
    v_mul_f32 v8, 0x3a000000, v8
    ds_read_b64_tr_b16 v[88:89], v14 offset:32
    ds_read_b64_tr_b16 v[90:91], v14 offset:0
    ds_read_b64_tr_b16 v[92:93], v14 offset:160
    ds_read_b64_tr_b16 v[94:95], v14 offset:128
    ds_read_b64_tr_b16 v[96:97], v14 offset:288
    ds_read_b64_tr_b16 v[98:99], v14 offset:256
    ds_read_b64_tr_b16 v[100:101], v14 offset:416
    ds_read_b64_tr_b16 v[102:103], v14 offset:384
    s_waitcnt lgkmcnt(14)
    s_waitcnt lgkmcnt(6)
    v_mfma_f32_16x16x32_f16 v[216:219], v[72:75], v[88:91], 0
    ds_read_b64_tr_b16 v[104:105], v14 offset:544
    ds_read_b64_tr_b16 v[106:107], v14 offset:512
    v_mfma_f32_16x16x32_f16 v[224:227], v[76:79], v[88:91], 0
    ds_read_b64_tr_b16 v[108:109], v14 offset:672
    ds_read_b64_tr_b16 v[110:111], v14 offset:640
    s_waitcnt lgkmcnt(8)
    v_mfma_f32_16x16x32_f16 v[220:223], v[72:75], v[92:95], 0
    ds_read_b64_tr_b16 v[112:113], v14 offset:800
    ds_read_b64_tr_b16 v[114:115], v14 offset:768
    v_mfma_f32_16x16x32_f16 v[228:231], v[76:79], v[92:95], 0
    ds_read_b64_tr_b16 v[116:117], v14 offset:928
    ds_read_b64_tr_b16 v[118:119], v14 offset:896
    s_waitcnt lgkmcnt(10)
    v_mfma_f32_16x16x32_f16 v[216:219], v[68:71], v[96:99], v[216:219]
    ds_read_b64_tr_b16 v[120:121], v14 offset:1056
    ds_read_b64_tr_b16 v[122:123], v14 offset:1024
    v_mfma_f32_16x16x32_f16 v[224:227], v[72:75], v[96:99], v[224:227]
    ds_read_b64_tr_b16 v[124:125], v14 offset:1184
    ds_read_b64_tr_b16 v[126:127], v14 offset:1152
    s_waitcnt lgkmcnt(12)
    v_mfma_f32_16x16x32_f16 v[220:223], v[68:71], v[100:103], v[220:223]
    ds_read_b64_tr_b16 v[128:129], v14 offset:1312
    ds_read_b64_tr_b16 v[130:131], v14 offset:1280
    v_mfma_f32_16x16x32_f16 v[228:231], v[72:75], v[100:103], v[228:231]
    ds_read_b64_tr_b16 v[132:133], v14 offset:1440
    ds_read_b64_tr_b16 v[134:135], v14 offset:1408
    s_waitcnt lgkmcnt(14)
    v_mfma_f32_16x16x32_f16 v[216:219], v[64:67], v[104:107], v[216:219]
    ds_read_b64_tr_b16 v[136:137], v14 offset:1568
    ds_read_b64_tr_b16 v[138:139], v14 offset:1536
    v_mfma_f32_16x16x32_f16 v[224:227], v[68:71], v[104:107], v[224:227]
    ds_read_b64_tr_b16 v[140:141], v14 offset:1696
    ds_read_b64_tr_b16 v[142:143], v14 offset:1664
    s_waitcnt lgkmcnt(15)
    v_mfma_f32_16x16x32_f16 v[220:223], v[64:67], v[108:111], v[220:223]
    ds_read_b64_tr_b16 v[144:145], v14 offset:1824
    ds_read_b64_tr_b16 v[146:147], v14 offset:1792
    v_mfma_f32_16x16x32_f16 v[228:231], v[68:71], v[108:111], v[228:231]
    ds_read_b64_tr_b16 v[148:149], v14 offset:1952
    ds_read_b64_tr_b16 v[150:151], v14 offset:1920
    s_waitcnt lgkmcnt(15)
    v_mfma_f32_16x16x32_f16 v[216:219], v[60:63], v[112:115], v[216:219]
    ds_read_b64_tr_b16 v[152:153], v14 offset:2080
    ds_read_b64_tr_b16 v[154:155], v14 offset:2048
    v_mfma_f32_16x16x32_f16 v[224:227], v[64:67], v[112:115], v[224:227]
    ds_read_b64_tr_b16 v[156:157], v14 offset:2208
    ds_read_b64_tr_b16 v[158:159], v14 offset:2176
    v_mfma_f32_16x16x32_f16 v[220:223], v[60:63], v[116:119], v[220:223]
    ds_read_b64_tr_b16 v[160:161], v14 offset:2336
    ds_read_b64_tr_b16 v[162:163], v14 offset:2304
    v_mfma_f32_16x16x32_f16 v[228:231], v[64:67], v[116:119], v[228:231]
    ds_read_b64_tr_b16 v[164:165], v14 offset:2464
    ds_read_b64_tr_b16 v[166:167], v14 offset:2432
    s_waitcnt lgkmcnt(15)
    v_mfma_f32_16x16x32_f16 v[216:219], v[56:59], v[120:123], v[216:219]
    ds_read_b64_tr_b16 v[168:169], v14 offset:2592
    ds_read_b64_tr_b16 v[170:171], v14 offset:2560
    v_mfma_f32_16x16x32_f16 v[224:227], v[60:63], v[120:123], v[224:227]
    ds_read_b64_tr_b16 v[172:173], v14 offset:2720
    ds_read_b64_tr_b16 v[174:175], v14 offset:2688
    v_mfma_f32_16x16x32_f16 v[220:223], v[56:59], v[124:127], v[220:223]
    ds_read_b64_tr_b16 v[176:177], v14 offset:2848
    ds_read_b64_tr_b16 v[178:179], v14 offset:2816
    v_mfma_f32_16x16x32_f16 v[228:231], v[60:63], v[124:127], v[228:231]
    ds_read_u16 v244, v12 offset:3456
    v_mfma_f32_16x16x32_f16 v[216:219], v[52:55], v[128:131], v[216:219]
    ds_read_b64_tr_b16 v[180:181], v14 offset:2976
    ds_read_b64_tr_b16 v[182:183], v14 offset:2944
    v_mfma_f32_16x16x32_f16 v[224:227], v[56:59], v[128:131], v[224:227]
    ds_read_u16 v245, v12 offset:3584
    v_mfma_f32_16x16x32_f16 v[220:223], v[52:55], v[132:135], v[220:223]
    ds_read_b64_tr_b16 v[184:185], v14 offset:3104
    ds_read_b64_tr_b16 v[186:187], v14 offset:3072
    v_mfma_f32_16x16x32_f16 v[228:231], v[56:59], v[132:135], v[228:231]
    ds_read_u16 v246, v12 offset:3712
    s_waitcnt lgkmcnt(15)
    v_mfma_f32_16x16x32_f16 v[216:219], v[48:51], v[136:139], v[216:219]
    ds_read_b64_tr_b16 v[188:189], v14 offset:3232
    ds_read_b64_tr_b16 v[190:191], v14 offset:3200
    v_mfma_f32_16x16x32_f16 v[224:227], v[52:55], v[136:139], v[224:227]
    ds_read_u16 v247, v12 offset:3840
    v_mfma_f32_16x16x32_f16 v[220:223], v[48:51], v[140:143], v[220:223]
    ds_read_b64_tr_b16 v[192:193], v14 offset:3360
    ds_read_b64_tr_b16 v[194:195], v14 offset:3328
    v_mfma_f32_16x16x32_f16 v[228:231], v[52:55], v[140:143], v[228:231]
    ds_read_u16 v248, v12 offset:3968
    v_mfma_f32_16x16x32_f16 v[216:219], v[44:47], v[144:147], v[216:219]
    ds_read_b64_tr_b16 v[196:197], v14 offset:3488
    ds_read_b64_tr_b16 v[198:199], v14 offset:3456
    v_mfma_f32_16x16x32_f16 v[224:227], v[48:51], v[144:147], v[224:227]
    ds_read_u16 v249, v12 offset:4096
    v_mfma_f32_16x16x32_f16 v[220:223], v[44:47], v[148:151], v[220:223]
    ds_read_b64_tr_b16 v[200:201], v14 offset:3616
    ds_read_b64_tr_b16 v[202:203], v14 offset:3584
    v_mfma_f32_16x16x32_f16 v[228:231], v[48:51], v[148:151], v[228:231]
    ds_read_u16 v250, v12 offset:4224
    v_mfma_f32_16x16x32_f16 v[216:219], v[40:43], v[152:155], v[216:219]
    ds_read_b64_tr_b16 v[204:205], v14 offset:3744
    ds_read_b64_tr_b16 v[206:207], v14 offset:3712
    v_mfma_f32_16x16x32_f16 v[224:227], v[44:47], v[152:155], v[224:227]
    ds_read_b64_tr_b16 v[208:209], v14 offset:3872
    ds_read_b64_tr_b16 v[210:211], v14 offset:3840
    v_mfma_f32_16x16x32_f16 v[220:223], v[40:43], v[156:159], v[220:223]
    ds_read_b64_tr_b16 v[212:213], v14 offset:4000
    ds_read_b64_tr_b16 v[214:215], v14 offset:3968
    v_mfma_f32_16x16x32_f16 v[228:231], v[44:47], v[156:159], v[228:231]
    v_mfma_f32_16x16x32_f16 v[216:219], v[36:39], v[160:163], v[216:219]
    v_mfma_f32_16x16x32_f16 v[224:227], v[40:43], v[160:163], v[224:227]
    s_waitcnt lgkmcnt(15)
    v_mfma_f32_16x16x32_f16 v[220:223], v[36:39], v[164:167], v[220:223]
    v_mfma_f32_16x16x32_f16 v[228:231], v[40:43], v[164:167], v[228:231]
    v_mfma_f32_16x16x32_f16 v[216:219], v[32:35], v[168:171], v[216:219]
    v_mfma_f32_16x16x32_f16 v[224:227], v[36:39], v[168:171], v[224:227]
    v_mfma_f32_16x16x32_f16 v[220:223], v[32:35], v[172:175], v[220:223]
    v_mfma_f32_16x16x32_f16 v[228:231], v[36:39], v[172:175], v[228:231]
    v_mfma_f32_16x16x32_f16 v[216:219], v[28:31], v[176:179], v[216:219]
    v_mfma_f32_16x16x32_f16 v[224:227], v[32:35], v[176:179], v[224:227]
    v_mfma_f32_16x16x32_f16 v[220:223], v[28:31], v[180:183], v[220:223]
    v_mfma_f32_16x16x32_f16 v[228:231], v[32:35], v[180:183], v[228:231]
    v_mfma_f32_16x16x32_f16 v[216:219], v[24:27], v[184:187], v[216:219]
    v_mfma_f32_16x16x32_f16 v[224:227], v[28:31], v[184:187], v[224:227]
    v_mfma_f32_16x16x32_f16 v[220:223], v[24:27], v[188:191], v[220:223]
    v_mfma_f32_16x16x32_f16 v[228:231], v[28:31], v[188:191], v[228:231]
    s_waitcnt lgkmcnt(13)
    v_mfma_f32_16x16x32_f16 v[224:227], v[24:27], v[192:195], v[224:227]
    s_waitcnt lgkmcnt(10)
    v_mfma_f32_16x16x32_f16 v[228:231], v[24:27], v[196:199], v[228:231]
    v_mfma_f32_16x16x32_f16 v[232:235], v[80:83], v[88:91], 0
    v_add_f32_dpp v5, v219, v218 wave_shr:1 row_mask:0xf bank_mask:0xf bound_ctrl:0
    s_nop 0
    v_add_f32_dpp v13, v219, v222 wave_ror:1 row_mask:0xf bank_mask:0xf
    s_nop 1
    v_add_f32_dpp v13, v223, v222 wave_shr:1 row_mask:0xf bank_mask:0xf
    v_mfma_f32_16x16x32_f16 v[236:239], v[80:83], v[92:95], 0
    v_add_f32_dpp v4, v5, v217 wave_shr:1 row_mask:0xf bank_mask:0xf bound_ctrl:0
    v_add_f32_dpp v10, v5, v221 wave_ror:1 row_mask:0xf bank_mask:0xf
    s_nop 1
    v_add_f32_dpp v10, v13, v221 wave_shr:1 row_mask:0xf bank_mask:0xf
    v_mfma_f32_16x16x32_f16 v[232:235], v[76:79], v[96:99], v[232:235]
    v_add_f32_dpp v7, v4, v220 wave_ror:1 row_mask:0xf bank_mask:0xf
    s_nop 1
    v_add_f32_dpp v7, v10, v220 wave_shr:1 row_mask:0xf bank_mask:0xf
    v_mul_f32 v220, v2, v7
    v_mfma_f32_16x16x32_f16 v[236:239], v[76:79], v[100:103], v[236:239]
    v_add_f32_dpp v18, v223, v226 wave_ror:1 row_mask:0xf bank_mask:0xf
    v_add_f32_dpp v5, v227, v230 wave_ror:1 row_mask:0xf bank_mask:0xf
    s_nop 0
    v_add_f32_dpp v18, v227, v226 wave_shr:1 row_mask:0xf bank_mask:0xf
    v_mfma_f32_16x16x32_f16 v[232:235], v[72:75], v[104:107], v[232:235]
    v_add_f32_dpp v5, v231, v230 wave_shr:1 row_mask:0xf bank_mask:0xf
    v_add_f32_dpp v17, v13, v225 wave_ror:1 row_mask:0xf bank_mask:0xf
    v_add_f32_dpp v4, v18, v229 wave_ror:1 row_mask:0xf bank_mask:0xf
    v_mfma_f32_16x16x32_f16 v[236:239], v[72:75], v[108:111], v[236:239]
    v_add_f32_dpp v17, v18, v225 wave_shr:1 row_mask:0xf bank_mask:0xf
    v_add_f32_dpp v4, v5, v229 wave_shr:1 row_mask:0xf bank_mask:0xf
    v_add_f32_dpp v16, v10, v224 wave_ror:1 row_mask:0xf bank_mask:0xf
    v_mfma_f32_16x16x32_f16 v[232:235], v[68:71], v[112:115], v[232:235]
    v_add_f32_dpp v3, v17, v228 wave_ror:1 row_mask:0xf bank_mask:0xf
    v_add_f32_dpp v16, v17, v224 wave_shr:1 row_mask:0xf bank_mask:0xf
    s_nop 0
    v_add_f32_dpp v3, v4, v228 wave_shr:1 row_mask:0xf bank_mask:0xf
    v_mfma_f32_16x16x32_f16 v[236:239], v[68:71], v[116:119], v[236:239]
    v_mul_f32 v224, v2, v16
    v_mul_f32 v228, v2, v3
    v_fma_mix_f32 v244, v244, v8, 0 op_sel_hi:[1,0,0]
    v_mfma_f32_16x16x32_f16 v[232:235], v[64:67], v[120:123], v[232:235]
    v_fma_mix_f32 v245, v245, v8, 0 op_sel_hi:[1,0,0]
    v_cvt_pk_bf16_f32 v20, v220, v224
    v_cvt_pk_bf16_f32 v21, v244, v245
    v_mfma_f32_16x16x32_f16 v[236:239], v[64:67], v[124:127], v[236:239]
    v_lshlrev_b32 v22, 16, v20
    v_and_b32 v20, s52, v20
    v_lshlrev_b32 v23, 16, v21
    v_mfma_f32_16x16x32_f16 v[232:235], v[60:63], v[128:131], v[232:235]
    v_and_b32 v21, s52, v21
    v_add_f32 v22, v22, v23
    v_add_f32 v20, v20, v21
    v_mfma_f32_16x16x32_f16 v[236:239], v[60:63], v[132:135], v[236:239]
    v_cvt_pk_bf16_f32 v244, v22, v20
    ds_write_b16 v9, v244 offset:34944
    ds_write_b16_d16_hi v9, v244 offset:35968
    v_mfma_f32_16x16x32_f16 v[232:235], v[56:59], v[136:139], v[232:235]
    v_mfma_f32_16x16x32_f16 v[236:239], v[56:59], v[140:143], v[236:239]
    v_mfma_f32_16x16x32_f16 v[232:235], v[52:55], v[144:147], v[232:235]
    v_mfma_f32_16x16x32_f16 v[236:239], v[52:55], v[148:151], v[236:239]
    v_mfma_f32_16x16x32_f16 v[232:235], v[48:51], v[152:155], v[232:235]
    v_mfma_f32_16x16x32_f16 v[236:239], v[48:51], v[156:159], v[236:239]
    v_mfma_f32_16x16x32_f16 v[232:235], v[44:47], v[160:163], v[232:235]
    v_mfma_f32_16x16x32_f16 v[236:239], v[44:47], v[164:167], v[236:239]
    v_mfma_f32_16x16x32_f16 v[232:235], v[40:43], v[168:171], v[232:235]
    v_mfma_f32_16x16x32_f16 v[236:239], v[40:43], v[172:175], v[236:239]
    v_mfma_f32_16x16x32_f16 v[232:235], v[36:39], v[176:179], v[232:235]
    v_mfma_f32_16x16x32_f16 v[236:239], v[36:39], v[180:183], v[236:239]
    v_mfma_f32_16x16x32_f16 v[232:235], v[32:35], v[184:187], v[232:235]
    v_mfma_f32_16x16x32_f16 v[236:239], v[32:35], v[188:191], v[236:239]
    v_mfma_f32_16x16x32_f16 v[232:235], v[28:31], v[192:195], v[232:235]
    v_mfma_f32_16x16x32_f16 v[236:239], v[28:31], v[196:199], v[236:239]
    s_waitcnt lgkmcnt(9)
    v_mfma_f32_16x16x32_f16 v[232:235], v[24:27], v[200:203], v[232:235]
    s_waitcnt lgkmcnt(6)
    v_mfma_f32_16x16x32_f16 v[236:239], v[24:27], v[204:207], v[236:239]
    v_mfma_f32_16x16x32_f16 v[216:219], v[84:87], v[88:91], 0
    v_mfma_f32_16x16x32_f16 v[220:223], v[84:87], v[92:95], 0
    v_mfma_f32_16x16x32_f16 v[216:219], v[80:83], v[96:99], v[216:219]
    v_mfma_f32_16x16x32_f16 v[220:223], v[80:83], v[100:103], v[220:223]
    s_nop 1
    v_add_f32_dpp v13, v231, v234 wave_ror:1 row_mask:0xf bank_mask:0xf
    s_nop 0
    v_add_f32_dpp v18, v235, v238 wave_ror:1 row_mask:0xf bank_mask:0xf
    v_add_f32_dpp v13, v235, v234 wave_shr:1 row_mask:0xf bank_mask:0xf
    v_mfma_f32_16x16x32_f16 v[216:219], v[76:79], v[104:107], v[216:219]
    v_add_f32_dpp v18, v239, v238 wave_shr:1 row_mask:0xf bank_mask:0xf
    v_add_f32_dpp v10, v5, v233 wave_ror:1 row_mask:0xf bank_mask:0xf
    v_add_f32_dpp v17, v13, v237 wave_ror:1 row_mask:0xf bank_mask:0xf
    v_mfma_f32_16x16x32_f16 v[220:223], v[76:79], v[108:111], v[220:223]
    v_add_f32_dpp v10, v13, v233 wave_shr:1 row_mask:0xf bank_mask:0xf
    v_add_f32_dpp v17, v18, v237 wave_shr:1 row_mask:0xf bank_mask:0xf
    v_add_f32_dpp v7, v4, v232 wave_ror:1 row_mask:0xf bank_mask:0xf
    v_mfma_f32_16x16x32_f16 v[216:219], v[72:75], v[112:115], v[216:219]
    v_add_f32_dpp v16, v10, v236 wave_ror:1 row_mask:0xf bank_mask:0xf
    v_add_f32_dpp v7, v10, v232 wave_shr:1 row_mask:0xf bank_mask:0xf
    s_nop 0
    v_add_f32_dpp v16, v17, v236 wave_shr:1 row_mask:0xf bank_mask:0xf
    v_mfma_f32_16x16x32_f16 v[220:223], v[72:75], v[116:119], v[220:223]
    v_mul_f32 v232, v2, v7
    v_mul_f32 v236, v2, v16
    v_fma_mix_f32 v246, v246, v8, 0 op_sel_hi:[1,0,0]
    v_mfma_f32_16x16x32_f16 v[216:219], v[68:71], v[120:123], v[216:219]
    v_fma_mix_f32 v247, v247, v8, 0 op_sel_hi:[1,0,0]
    v_cvt_pk_bf16_f32 v20, v228, v232
    v_cvt_pk_bf16_f32 v21, v246, v247
    v_mfma_f32_16x16x32_f16 v[220:223], v[68:71], v[124:127], v[220:223]
    v_lshlrev_b32 v22, 16, v20
    v_and_b32 v20, s52, v20
    v_lshlrev_b32 v23, 16, v21
    v_mfma_f32_16x16x32_f16 v[216:219], v[64:67], v[128:131], v[216:219]
    v_and_b32 v21, s52, v21
    v_add_f32 v22, v22, v23
    v_add_f32 v20, v20, v21
    v_mfma_f32_16x16x32_f16 v[220:223], v[64:67], v[132:135], v[220:223]
    v_cvt_pk_bf16_f32 v246, v22, v20
    ds_write_b16 v9, v246 offset:36992
    ds_write_b16_d16_hi v9, v246 offset:38016
    v_mfma_f32_16x16x32_f16 v[216:219], v[60:63], v[136:139], v[216:219]
    v_mfma_f32_16x16x32_f16 v[220:223], v[60:63], v[140:143], v[220:223]
    v_mfma_f32_16x16x32_f16 v[216:219], v[56:59], v[144:147], v[216:219]
    v_mfma_f32_16x16x32_f16 v[220:223], v[56:59], v[148:151], v[220:223]
    v_mfma_f32_16x16x32_f16 v[216:219], v[52:55], v[152:155], v[216:219]
    v_mfma_f32_16x16x32_f16 v[220:223], v[52:55], v[156:159], v[220:223]
    v_mfma_f32_16x16x32_f16 v[216:219], v[48:51], v[160:163], v[216:219]
    v_mfma_f32_16x16x32_f16 v[220:223], v[48:51], v[164:167], v[220:223]
    v_mfma_f32_16x16x32_f16 v[216:219], v[44:47], v[168:171], v[216:219]
    v_mfma_f32_16x16x32_f16 v[220:223], v[44:47], v[172:175], v[220:223]
    v_mfma_f32_16x16x32_f16 v[216:219], v[40:43], v[176:179], v[216:219]
    v_mfma_f32_16x16x32_f16 v[220:223], v[40:43], v[180:183], v[220:223]
    v_mfma_f32_16x16x32_f16 v[216:219], v[36:39], v[184:187], v[216:219]
    v_mfma_f32_16x16x32_f16 v[220:223], v[36:39], v[188:191], v[220:223]
    v_mfma_f32_16x16x32_f16 v[216:219], v[32:35], v[192:195], v[216:219]
    v_mfma_f32_16x16x32_f16 v[220:223], v[32:35], v[196:199], v[220:223]
    v_mfma_f32_16x16x32_f16 v[216:219], v[28:31], v[200:203], v[216:219]
    v_mfma_f32_16x16x32_f16 v[220:223], v[28:31], v[204:207], v[220:223]
    s_waitcnt lgkmcnt(6)
    v_mfma_f32_16x16x32_f16 v[216:219], v[24:27], v[208:211], v[216:219]
    s_waitcnt lgkmcnt(4)
    v_mfma_f32_16x16x32_f16 v[220:223], v[24:27], v[212:215], v[220:223]
    s_nop 5
    v_add_f32_dpp v5, v239, v218 wave_ror:1 row_mask:0xf bank_mask:0xf
    s_nop 0
    v_add_f32_dpp v13, v219, v222 wave_ror:1 row_mask:0xf bank_mask:0xf
    v_add_f32_dpp v5, v219, v218 wave_shr:1 row_mask:0xf bank_mask:0xf
    s_nop 0
    v_add_f32_dpp v13, v223, v222 wave_shr:1 row_mask:0xf bank_mask:0xf
    v_add_f32_dpp v4, v18, v217 wave_ror:1 row_mask:0xf bank_mask:0xf
    v_add_f32_dpp v10, v5, v221 wave_ror:1 row_mask:0xf bank_mask:0xf
    s_nop 0
    v_add_f32_dpp v4, v5, v217 wave_shr:1 row_mask:0xf bank_mask:0xf
    v_add_f32_dpp v10, v13, v221 wave_shr:1 row_mask:0xf bank_mask:0xf
    v_add_f32_dpp v3, v17, v216 wave_ror:1 row_mask:0xf bank_mask:0xf
    v_add_f32_dpp v7, v4, v220 wave_ror:1 row_mask:0xf bank_mask:0xf
    s_nop 0
    v_add_f32_dpp v3, v4, v216 wave_shr:1 row_mask:0xf bank_mask:0xf
    v_add_f32_dpp v7, v10, v220 wave_shr:1 row_mask:0xf bank_mask:0xf
    v_mul_f32 v216, v2, v3
    v_mul_f32 v220, v2, v7
    v_fma_mix_f32 v248, v248, v8, 0 op_sel_hi:[1,0,0]
    v_fma_mix_f32 v249, v249, v8, 0 op_sel_hi:[1,0,0]
    v_cvt_pk_bf16_f32 v20, v236, v216
    v_cvt_pk_bf16_f32 v21, v248, v249
    v_lshlrev_b32 v22, 16, v20
    v_and_b32 v20, s52, v20
    v_lshlrev_b32 v23, 16, v21
    v_and_b32 v21, s52, v21
    v_add_f32 v22, v22, v23
    v_add_f32 v20, v20, v21
    v_cvt_pk_bf16_f32 v248, v22, v20
    ds_write_b16 v9, v248 offset:39040
    ds_write_b16_d16_hi v9, v248 offset:40064
    v_fma_mix_f32 v250, v250, v8, 0 op_sel_hi:[1,0,0]
    v_cvt_pk_bf16_f32 v20, v220, v220
    v_cvt_pk_bf16_f32 v21, v250, v250
    v_lshlrev_b32 v22, 16, v20
L_pad_k2_kernel_3:
    s_cbranch_execz k2_kernel_end
    v_and_b32 v20, s52, v20
    v_lshlrev_b32 v23, 16, v21
    v_and_b32 v21, s52, v21
    v_add_f32 v22, v22, v23
    v_add_f32 v20, v20, v21
    v_cvt_pk_bf16_f32 v250, v22, v20
    ds_write_b16 v9, v250 offset:41088
    v_lshlrev_b32 v7, 3, v1
    v_mov_b32 v5, 0x3f803f80
    s_lshl_b32 s41, s3, 10
    v_add_u32 v6, s41, v6
    s_mul_i32 s43, s40, 16512
    s_lshl_b32 s44, s3, 9
    s_add_u32 s43, s43, s44
    s_add_u32 s43, s43, 10498560
    s_nop 0
    s_waitcnt lgkmcnt(0)
    s_barrier
    ds_read_b128 v[24:27], v6 offset:34944
    s_waitcnt vmcnt(4)
    s_cmp_ge_u32 s3, 7
    s_cbranch_scc1 k2_kernel_e2
    v_lshlrev_b32 v40, 16, v240
    v_and_b32 v41, s52, v240
    v_lshlrev_b32 v42, 16, v241
    v_and_b32 v43, s52, v241
    v_lshlrev_b32 v44, 16, v242
    v_and_b32 v45, s52, v242
    v_lshlrev_b32 v46, 16, v243
    v_and_b32 v47, s52, v243
    v_mov_b32 v28, 0
    v_mov_b32 v29, 0
    s_waitcnt lgkmcnt(0)
    v_lshlrev_b32 v32, 16, v24
    v_and_b32 v33, s52, v24
    v_lshlrev_b32 v34, 16, v25
    v_and_b32 v35, s52, v25
    v_lshlrev_b32 v36, 16, v26
    v_and_b32 v37, s52, v26
    v_lshlrev_b32 v38, 16, v27
    v_and_b32 v39, s52, v27
    v_pk_add_f32 v[32:33], v[32:33], v[40:41]
    v_pk_add_f32 v[34:35], v[34:35], v[42:43]
    v_pk_add_f32 v[36:37], v[36:37], v[44:45]
    v_pk_add_f32 v[38:39], v[38:39], v[46:47]
    v_cvt_pk_bf16_f32 v24, v32, v33
    v_cvt_pk_bf16_f32 v25, v34, v35
    v_cvt_pk_bf16_f32 v26, v36, v37
    v_cvt_pk_bf16_f32 v27, v38, v39
    buffer_store_dwordx4 v[24:27], v11, s[24:27], s42 offen sc1
    v_dot2c_f32_bf16 v28, v24, v5
    v_dot2c_f32_bf16 v29, v24, v24
    v_dot2c_f32_bf16 v28, v25, v5
    v_dot2c_f32_bf16 v29, v25, v25
    v_dot2c_f32_bf16 v28, v26, v5
    v_dot2c_f32_bf16 v29, v26, v26
    v_dot2c_f32_bf16 v28, v27, v5
    v_dot2c_f32_bf16 v29, v27, v27
    s_nop 2
    buffer_store_dwordx2 v[28:29], v7, s[24:27], s43 offen sc1
k2_kernel_e2:
    s_cmp_ge_u32 s55, 1296
    s_cbranch_scc1 k2_kernel_nf2
    v_lshrrev_b32 v105, 4, v1
    v_lshlrev_b32 v108, 10, v105
    v_and_b32 v105, 1, v105
    v_lshlrev_b32 v105, 6, v105
    v_bfe_u32 v109, v1, 2, 2
    v_lshl_add_u32 v108, v109, 7, v108
    v_bfe_u32 v109, v1, 3, 1
    v_lshl_add_u32 v105, v109, 5, v105
    v_and_b32 v109, 3, v1
    v_lshl_add_u32 v108, v109, 3, v108
    v_add_u32 v108, v108, v105
    v_add_u32 v108, s54, v108
    v_xor_b32 v109, 32, v108
    v_xor_b32 v110, 64, v108
    v_xor_b32 v111, 96, v108
    v_mov_b32 v112, 0x3f803f80
    v_mov_b32 v113, 0x3f803f80
    v_mov_b32 v114, 0x3f803f80
    v_mov_b32 v115, 0x3f803f80
    v_lshlrev_b32 v104, 4, v1
    v_and_b32 v105, 15, v1
    v_and_b32 v106, 48, v1
    v_lshl_add_u32 v106, v105, 7, v106
    s_mul_i32 s58, s57, 147456
    s_lshl_b32 s59, s56, 11
    s_add_u32 s58, s58, s59
    s_lshl_b32 s59, s51, 10
    s_add_u32 s58, s58, s59
    s_add_u32 s58, s58, 16777216
    s_mul_i32 s56, s56, 36864
    s_lshl_b32 s59, s57, 9
    s_add_u32 s56, s56, s59
    s_lshl_b32 s59, s51, 6
    s_add_u32 s56, s56, s59
    s_add_u32 s56, s56, 12582912
    s_waitcnt vmcnt(0) lgkmcnt(0)
    ds_read_b64_tr_b16 v[116:117], v108
    ds_read_b64_tr_b16 v[118:119], v108 offset:512
    ds_read_b64_tr_b16 v[120:121], v109
    ds_read_b64_tr_b16 v[122:123], v109 offset:512
    ds_read_b64_tr_b16 v[124:125], v110
    ds_read_b64_tr_b16 v[126:127], v110 offset:512
    ds_read_b64_tr_b16 v[128:129], v111
    ds_read_b64_tr_b16 v[130:131], v111 offset:512
    s_waitcnt lgkmcnt(6)
    buffer_store_dwordx4 v[116:119], v104, s[24:27], s58 offen sc1
    v_mfma_f32_16x16x32_bf16 v[132:135], v[116:119], v[112:115], 0
    s_add_u32 s58, s58, 36864
    s_waitcnt lgkmcnt(4)
    buffer_store_dwordx4 v[120:123], v104, s[24:27], s58 offen sc1
    v_mfma_f32_16x16x32_bf16 v[136:139], v[120:123], v[112:115], 0
    s_add_u32 s58, s58, 36864
    s_waitcnt lgkmcnt(2)
    buffer_store_dwordx4 v[124:127], v104, s[24:27], s58 offen sc1
    v_mfma_f32_16x16x32_bf16 v[140:143], v[124:127], v[112:115], 0
    s_add_u32 s58, s58, 36864
    s_waitcnt lgkmcnt(0)
    buffer_store_dwordx4 v[128:131], v104, s[24:27], s58 offen sc1
    v_mfma_f32_16x16x32_bf16 v[144:147], v[128:131], v[112:115], 0
    v_cmp_eq_u32 vcc, 1, v105
    s_nop 1
    v_cndmask_b32 v132, v132, v136, vcc
    v_cndmask_b32 v133, v133, v137, vcc
    v_cndmask_b32 v134, v134, v138, vcc
    v_cndmask_b32 v135, v135, v139, vcc
    v_cmp_eq_u32 vcc, 2, v105
    s_nop 1
    v_cndmask_b32 v132, v132, v140, vcc
    v_cndmask_b32 v133, v133, v141, vcc
    v_cndmask_b32 v134, v134, v142, vcc
    v_cndmask_b32 v135, v135, v143, vcc
    v_cmp_eq_u32 vcc, 3, v105
    s_nop 1
    v_cndmask_b32 v132, v132, v144, vcc
    v_cndmask_b32 v133, v133, v145, vcc
    v_cndmask_b32 v134, v134, v146, vcc
    v_cndmask_b32 v135, v135, v147, vcc
    s_mov_b32 exec_lo, 0x000f000f
    s_mov_b32 exec_hi, 0x000f000f
    buffer_store_dwordx4 v[132:135], v106, s[24:27], s56 offen sc1
    s_mov_b64 exec, -1
k2_kernel_nf2:
    s_mov_b64 exec, 0
    s_cmp_eq_u32 s3, 0
    s_cbranch_scc1 L_pad_k3_kernel_0
    s_cmp_eq_u32 s3, 1
    s_cbranch_scc1 L_pad_k3_kernel_1
    s_cmp_eq_u32 s3, 2
    s_cbranch_scc1 L_pad_k3_kernel_2
    s_cmp_eq_u32 s3, 3
    s_cbranch_scc1 L_pad_k3_kernel_3
    s_cmp_eq_u32 s3, 4
    s_cbranch_scc1 L_pad_k3_kernel_4
    s_cmp_eq_u32 s3, 5
    s_cbranch_scc1 L_pad_k3_kernel_5
    s_cmp_eq_u32 s3, 6
    s_cbranch_scc1 L_pad_k3_kernel_6
    s_cmp_eq_u32 s3, 7
    s_cbranch_scc1 L_pad_k3_kernel_7
    s_endpgm
k2_kernel_sw:
    s_sub_u32 s36, s2, 216
    s_mul_i32 s36, s36, 8
    s_add_u32 s36, s36, s3
    s_add_u32 s36, s36, 192
    s_lshl_b32 s37, s3, 13
    s_cmp_ge_u32 s3, 8
    s_cbranch_scc1 k2_kernel_swx
    s_cmp_ge_u32 s36, 512
    s_cbranch_scc1 k2_kernel_swx
    s_mul_i32 s40, s36, 3641
    s_lshr_b32 s40, s40, 18
    s_mul_i32 s43, s40, 72
    s_sub_u32 s41, s36, s43
    v_lshrrev_b32 v10, 3, v1
    v_mul_u32_u24 v8, 9216, v10
    v_and_b32 v10, 2, v10
    v_and_b32 v9, 7, v1
    v_xor_b32 v9, v9, v10
    v_lshl_add_u32 v8, v9, 4, v8
    v_xor_b32 v9, 64, v8
    s_mul_i32 s42, s40, 294912
    s_lshl_b32 s43, s41, 7
    s_add_u32 s42, s42, s43
    s_add_u32 m0, s37, 0
    s_nop 0
    buffer_load_dwordx4 v8, s[60:63], s42 offen nt lds
    s_add_u32 m0, s37, 4096
    s_nop 0
    buffer_load_dwordx4 v8, s[64:67], s42 offen nt lds
    s_add_u32 s42, s42, 73728
    s_add_u32 m0, s37, 1024
    s_nop 0
    buffer_load_dwordx4 v9, s[60:63], s42 offen nt lds
    s_add_u32 m0, s37, 5120
    s_nop 0
    buffer_load_dwordx4 v9, s[64:67], s42 offen nt lds
    s_add_u32 s42, s42, 73728
    s_add_u32 m0, s37, 2048
    s_nop 0
    buffer_load_dwordx4 v8, s[60:63], s42 offen nt lds
    s_add_u32 m0, s37, 6144
    s_nop 0
    buffer_load_dwordx4 v8, s[64:67], s42 offen nt lds
    s_add_u32 s42, s42, 73728
    s_add_u32 m0, s37, 3072
    s_nop 0
    buffer_load_dwordx4 v9, s[60:63], s42 offen nt lds
    s_add_u32 m0, s37, 7168
    s_nop 0
    buffer_load_dwordx4 v9, s[64:67], s42 offen nt lds
    v_lshrrev_b32 v13, 4, v1
    v_lshlrev_b32 v16, 10, v13
    v_and_b32 v13, 1, v13
    v_lshlrev_b32 v13, 6, v13
    v_bfe_u32 v17, v1, 2, 2
    v_lshl_add_u32 v16, v17, 7, v16
    v_bfe_u32 v17, v1, 3, 1
    v_lshl_add_u32 v13, v17, 5, v13
    v_and_b32 v17, 3, v1
    v_lshl_add_u32 v16, v17, 3, v16
    v_add_u32 v16, v16, v13
    v_add_u32 v16, s37, v16
    v_xor_b32 v17, 32, v16
    v_xor_b32 v18, 64, v16
    v_xor_b32 v19, 96, v16
    s_waitcnt vmcnt(0) lgkmcnt(0)
    ds_read_b64_tr_b16 v[24:25], v16 offset:0
    ds_read_b64_tr_b16 v[26:27], v16 offset:512
    ds_read_b64_tr_b16 v[28:29], v16 offset:4096
    ds_read_b64_tr_b16 v[30:31], v16 offset:4608
    ds_read_b64_tr_b16 v[32:33], v17 offset:0
    ds_read_b64_tr_b16 v[34:35], v17 offset:512
    ds_read_b64_tr_b16 v[36:37], v17 offset:4096
    ds_read_b64_tr_b16 v[38:39], v17 offset:4608
    ds_read_b64_tr_b16 v[40:41], v18 offset:0
    ds_read_b64_tr_b16 v[42:43], v18 offset:512
    ds_read_b64_tr_b16 v[44:45], v18 offset:4096
    ds_read_b64_tr_b16 v[46:47], v18 offset:4608
    ds_read_b64_tr_b16 v[48:49], v19 offset:0
    ds_read_b64_tr_b16 v[50:51], v19 offset:512
    ds_read_b64_tr_b16 v[52:53], v19 offset:4096
    ds_read_b64_tr_b16 v[54:55], v19 offset:4608
    v_mov_b32 v20, 0x3f803f80
    v_mov_b32 v21, 0x3f803f80
    v_mov_b32 v22, 0x3f803f80
    v_mov_b32 v23, 0x3f803f80
    v_lshlrev_b32 v12, 4, v1
    s_mul_i32 s42, s41, 147456
    s_lshl_b32 s43, s40, 11
    s_add_u32 s42, s42, s43
    s_add_u32 s42, s42, 16777216
    s_waitcnt lgkmcnt(14)
    buffer_store_dwordx4 v[24:27], v12, s[24:27], s42 offen offset:0 sc1
    v_mfma_f32_16x16x32_bf16 v[56:59], v[24:27], v[20:23], 0
    s_waitcnt lgkmcnt(12)
    buffer_store_dwordx4 v[28:31], v12, s[24:27], s42 offen offset:1024 sc1
    v_mfma_f32_16x16x32_bf16 v[60:63], v[28:31], v[20:23], 0
    s_add_u32 s42, s42, 36864
    s_waitcnt lgkmcnt(10)
    buffer_store_dwordx4 v[32:35], v12, s[24:27], s42 offen offset:0 sc1
    v_mfma_f32_16x16x32_bf16 v[64:67], v[32:35], v[20:23], 0
    s_waitcnt lgkmcnt(8)
    buffer_store_dwordx4 v[36:39], v12, s[24:27], s42 offen offset:1024 sc1
    v_mfma_f32_16x16x32_bf16 v[68:71], v[36:39], v[20:23], 0
    s_add_u32 s42, s42, 36864
    s_waitcnt lgkmcnt(6)
    buffer_store_dwordx4 v[40:43], v12, s[24:27], s42 offen offset:0 sc1
    v_mfma_f32_16x16x32_bf16 v[72:75], v[40:43], v[20:23], 0
    s_waitcnt lgkmcnt(4)
    buffer_store_dwordx4 v[44:47], v12, s[24:27], s42 offen offset:1024 sc1
    v_mfma_f32_16x16x32_bf16 v[76:79], v[44:47], v[20:23], 0
    s_add_u32 s42, s42, 36864
    s_waitcnt lgkmcnt(2)
    buffer_store_dwordx4 v[48:51], v12, s[24:27], s42 offen offset:0 sc1
    v_mfma_f32_16x16x32_bf16 v[80:83], v[48:51], v[20:23], 0
    s_waitcnt lgkmcnt(0)
    buffer_store_dwordx4 v[52:55], v12, s[24:27], s42 offen offset:1024 sc1
    v_mfma_f32_16x16x32_bf16 v[84:87], v[52:55], v[20:23], 0
    v_and_b32 v13, 15, v1
    v_cmp_eq_u32 vcc, 1, v13
    s_nop 1
    v_cndmask_b32 v56, v56, v60, vcc
    v_cndmask_b32 v57, v57, v61, vcc
    v_cndmask_b32 v58, v58, v62, vcc
    v_cndmask_b32 v59, v59, v63, vcc
    v_cmp_eq_u32 vcc, 2, v13
    s_nop 1
    v_cndmask_b32 v56, v56, v64, vcc
    v_cndmask_b32 v57, v57, v65, vcc
    v_cndmask_b32 v58, v58, v66, vcc
    v_cndmask_b32 v59, v59, v67, vcc
    v_cmp_eq_u32 vcc, 3, v13
    s_nop 1
    v_cndmask_b32 v56, v56, v68, vcc
    v_cndmask_b32 v57, v57, v69, vcc
    v_cndmask_b32 v58, v58, v70, vcc
    v_cndmask_b32 v59, v59, v71, vcc
    v_cmp_eq_u32 vcc, 4, v13
    s_nop 1
    v_cndmask_b32 v56, v56, v72, vcc
    v_cndmask_b32 v57, v57, v73, vcc
    v_cndmask_b32 v58, v58, v74, vcc
    v_cndmask_b32 v59, v59, v75, vcc
    v_cmp_eq_u32 vcc, 5, v13
    s_nop 1
    v_cndmask_b32 v56, v56, v76, vcc
    v_cndmask_b32 v57, v57, v77, vcc
    v_cndmask_b32 v58, v58, v78, vcc
    v_cndmask_b32 v59, v59, v79, vcc
    v_cmp_eq_u32 vcc, 6, v13
    s_nop 1
    v_cndmask_b32 v56, v56, v80, vcc
    v_cndmask_b32 v57, v57, v81, vcc
    v_cndmask_b32 v58, v58, v82, vcc
    v_cndmask_b32 v59, v59, v83, vcc
    v_cmp_eq_u32 vcc, 7, v13
    s_nop 1
    v_cndmask_b32 v56, v56, v84, vcc
    v_cndmask_b32 v57, v57, v85, vcc
    v_cndmask_b32 v58, v58, v86, vcc
    v_cndmask_b32 v59, v59, v87, vcc
    v_and_b32 v14, 48, v1
    v_lshl_add_u32 v14, v13, 6, v14
    s_mul_i32 s42, s40, 36864
    s_lshl_b32 s43, s41, 9
    s_add_u32 s42, s42, s43
    s_add_u32 s42, s42, 12582912
    s_mov_b32 exec_lo, 0x00ff00ff
    s_mov_b32 exec_hi, 0x00ff00ff
    buffer_store_dwordx4 v[56:59], v14, s[24:27], s42 offen sc1
    s_mov_b64 exec, -1
k2_kernel_swx:
    s_mov_b64 exec, 0
    s_cmp_eq_u32 s3, 0
    s_cbranch_scc1 L_pad_k3_kernel_0
    s_cmp_eq_u32 s3, 1
    s_cbranch_scc1 L_pad_k3_kernel_1
    s_cmp_eq_u32 s3, 2
    s_cbranch_scc1 L_pad_k3_kernel_2
    s_cmp_eq_u32 s3, 3
    s_cbranch_scc1 L_pad_k3_kernel_3
    s_cmp_eq_u32 s3, 4
    s_cbranch_scc1 L_pad_k3_kernel_4
    s_cmp_eq_u32 s3, 5
    s_cbranch_scc1 L_pad_k3_kernel_5
    s_cmp_eq_u32 s3, 6
    s_cbranch_scc1 L_pad_k3_kernel_6
    s_cmp_eq_u32 s3, 7
    s_cbranch_scc1 L_pad_k3_kernel_7
k2_kernel_end:
    s_endpgm

.globl k3_kernel
.p2align 12
.type k3_kernel,@function
k3_kernel:
L_pad_k3_kernel_0:
    s_cbranch_execz L_pad_k3_kernel_8
    s_cmp_ge_u32 s2, 256
    s_cbranch_scc1 k3_kernel_end
    s_load_dwordx2 s[4:5], s[0:1], 104
    s_load_dwordx4 s[92:95], s[0:1], 80
    v_and_b32 v1, 63, v0
    v_lshrrev_b32 v2, 6, v0
    v_lshlrev_b32 v3, 4, v1
    v_readfirstlane_b32 s3, v2
    s_and_b32 s20, s2, 7
    s_lshr_b32 s21, s2, 3
    s_and_b32 s22, s21, 3
    s_lshl_b32 s20, s20, 2
    s_add_u32 s20, s20, s22
    s_lshr_b32 s21, s21, 2
    s_and_b32 s22, s20, 1
    s_mul_i32 s23, s20, 9
    s_lshl_b32 s24, s21, 4
    s_lshl_b32 s25, s3, 2
    s_add_u32 s24, s24, s25
    s_mul_i32 s26, s24, 18432
    s_add_u32 s26, s26, 7864320
    s_add_u32 s27, s26, 18432
    s_add_u32 s28, s26, 36864
    s_add_u32 s29, s26, 55296
    s_lshl_b32 s30, s3, 10
    s_add_u32 s31, s23, s22
    s_mul_i32 s31, s31, 36864
    s_add_u32 s31, s31, s30
    s_add_u32 s31, s31, 16777216
    s_mul_i32 s34, s22, 331776
    s_sub_u32 s34, s31, s34
    s_add_u32 s34, s34, 294912
    s_mul_i32 s99, s3, 36864
    s_sub_u32 s100, s31, s30
    s_add_u32 s100, s100, s99
    s_waitcnt lgkmcnt(0)
    s_mov_b32 s8, s4
    s_and_b32 s9, s5, 0xffff
    s_mov_b32 s10, 268435456
    s_mov_b32 s11, 0x20000
    s_mov_b32 s12, s4
    s_and_b32 s13, s5, 0xffff
    s_mov_b32 s14, 268435456
    s_mov_b32 s15, 0x20000
    s_mov_b32 s16, s92
    s_and_b32 s17, s93, 0xffff
    s_mov_b32 s18, 5308416
    s_mov_b32 s19, 0x20000
    s_mov_b32 s6, s94
    s_mov_b32 s7, s95
    s_add_u32 m0, s99, 0
    s_add_u32 s101, s100, 0
    buffer_load_dwordx4 v3, s[12:15], s101 offen offset:0 lds
    buffer_load_dwordx4 v3, s[12:15], s101 offen offset:1024 lds
    buffer_load_dwordx4 v3, s[12:15], s101 offen offset:2048 lds
    buffer_load_dwordx4 v3, s[12:15], s101 offen offset:3072 lds
    buffer_load_dwordx4 a[0:3], v3, s[8:11], s26 offen offset:0
    buffer_load_dwordx4 a[4:7], v3, s[8:11], s27 offen offset:0
    buffer_load_dwordx4 a[8:11], v3, s[8:11], s28 offen offset:0
    buffer_load_dwordx4 a[12:15], v3, s[8:11], s29 offen offset:0
    buffer_load_dwordx4 a[16:19], v3, s[8:11], s26 offen offset:1024
    buffer_load_dwordx4 a[20:23], v3, s[8:11], s27 offen offset:1024
    buffer_load_dwordx4 a[24:27], v3, s[8:11], s28 offen offset:1024
    buffer_load_dwordx4 a[28:31], v3, s[8:11], s29 offen offset:1024
    v_add_u32 v4, 36864, v3
    v_add_u32 v5, 73728, v3
    v_add_u32 v6, 110592, v3
    v_and_b32 v7, 48, v1
    v_add_u32 v7, 147456, v7
    s_add_u32 s36, s23, s22
    s_lshr_b32 s36, s36, 1
    s_lshl_b32 s36, s36, 10
    s_mul_i32 s37, s24, 147456
    s_add_u32 s36, s36, s37
    s_add_u32 s36, s36, 33554432
    s_add_u32 s37, s36, 147456
    s_add_u32 s38, s36, 294912
    s_add_u32 s39, s36, 442368
    s_cmp_eq_u32 s22, 0
    s_cselect_b32 s40, 0, 142336
    s_add_u32 m0, s99, 4096
    s_add_u32 s101, s100, 4096
    buffer_load_dwordx4 v3, s[12:15], s101 offen offset:0 lds
    buffer_load_dwordx4 v3, s[12:15], s101 offen offset:1024 lds
    buffer_load_dwordx4 v3, s[12:15], s101 offen offset:2048 lds
    buffer_load_dwordx4 v3, s[12:15], s101 offen offset:3072 lds
    buffer_load_dwordx4 a[32:35], v3, s[8:11], s26 offen offset:2048
    buffer_load_dwordx4 a[36:39], v3, s[8:11], s27 offen offset:2048
    buffer_load_dwordx4 a[40:43], v3, s[8:11], s28 offen offset:2048
    buffer_load_dwordx4 a[44:47], v3, s[8:11], s29 offen offset:2048
    buffer_load_dwordx4 a[48:51], v3, s[8:11], s26 offen offset:3072
    buffer_load_dwordx4 a[52:55], v3, s[8:11], s27 offen offset:3072
    buffer_load_dwordx4 a[56:59], v3, s[8:11], s28 offen offset:3072
    buffer_load_dwordx4 a[60:63], v3, s[8:11], s29 offen offset:3072
    s_lshl_b32 s42, s21, 11
    s_lshl_b32 s43, s20, 6
    s_add_u32 s42, s42, s43
    s_lshl_b32 s43, s3, 4
    s_add_u32 s42, s42, s43
    s_add_u32 s43, s42, 10485760
    v_mul_u32_u24 v244, 16512, v1
    v_add_u32 v245, 1056768, v244
    v_mov_b32 v240, 0
    v_mov_b32 v241, 0
    v_mov_b32 v242, 0
    v_mov_b32 v243, 0
    s_waitcnt vmcnt(20)
    s_barrier
    ds_read_b128 v[168:171], v3 offset:0
    ds_read_b128 v[172:175], v3 offset:1024
    ds_read_b128 v[176:179], v4 offset:0
    ds_read_b128 v[180:183], v4 offset:1024
    ds_read_b128 v[184:187], v5 offset:0
    ds_read_b128 v[188:191], v5 offset:1024
    s_waitcnt vmcnt(16)
    s_waitcnt lgkmcnt(4)
    v_mfma_f32_16x16x32_bf16 v[40:43], v[168:171], a[0:3], 0
    ds_read_b128 v[192:195], v6 offset:0
    ds_read_b128 v[196:199], v6 offset:1024
    v_mfma_f32_16x16x32_bf16 v[44:47], v[172:175], a[0:3], 0
    v_min_u32 v201, 215, v0
    v_mul_u32_u24 v200, 911, v201
    v_mfma_f32_16x16x32_bf16 v[48:51], v[168:171], a[4:7], 0
    v_lshrrev_b32 v200, 16, v200
    v_mul_u32_u24 v202, 72, v200
    v_mfma_f32_16x16x32_bf16 v[52:55], v[172:175], a[4:7], 0
    v_sub_u32 v202, v201, v202
    v_lshlrev_b32 v202, 4, v202
    v_mfma_f32_16x16x32_bf16 v[56:59], v[168:171], a[8:11], 0
    buffer_load_dwordx4 v[236:239], v244, s[8:11], s43 offen
    v_mfma_f32_16x16x32_bf16 v[60:63], v[172:175], a[8:11], 0
    v_mul_u32_u24 v2, 221184, v200
    v_add_u32 v2, v2, v202
    v_mfma_f32_16x16x32_bf16 v[64:67], v[168:171], a[12:15], 0
    s_mul_i32 s41, s20, 1152
    s_add_u32 s41, s41, 12582912
    v_mfma_f32_16x16x32_bf16 v[68:71], v[172:175], a[12:15], 0
    v_lshlrev_b32 v234, 4, v201
    v_add_u32 v234, 148736, v234
    s_waitcnt lgkmcnt(4)
    v_mfma_f32_16x16x32_bf16 v[72:75], v[176:179], a[0:3], 0
    ds_read_b128 v[168:171], v3 offset:2048
    ds_read_b128 v[172:175], v3 offset:3072
    v_mfma_f32_16x16x32_bf16 v[76:79], v[180:183], a[0:3], 0
    s_mov_b64 exec, 0xff
    buffer_load_dwordx4 v[240:243], v245, s[8:11], s43 offen
    s_mov_b64 exec, -1
    v_mfma_f32_16x16x32_bf16 v[80:83], v[176:179], a[4:7], 0
    v_add_u32 v233, 148736, v202
    s_lshl_b32 s45, s22, 7
    v_mfma_f32_16x16x32_bf16 v[84:87], v[180:183], a[4:7], 0
    v_subrev_u32 v202, s45, v202
    v_add_u32 v203, 1152, v202
    v_mfma_f32_16x16x32_bf16 v[88:91], v[176:179], a[8:11], 0
    v_min_u32 v202, v202, v203
    v_add_u32 v235, 147456, v202
    v_mfma_f32_16x16x32_bf16 v[92:95], v[180:183], a[8:11], 0
    s_add_u32 m0, s99, 8192
    s_add_u32 s101, s100, 8192
    buffer_load_dwordx4 v3, s[12:15], s101 offen offset:0 lds
    v_mfma_f32_16x16x32_bf16 v[96:99], v[176:179], a[12:15], 0
    s_lshl_b32 s67, s21, 2
    s_lshr_b32 s47, s20, 3
    v_mfma_f32_16x16x32_bf16 v[100:103], v[180:183], a[12:15], 0
    s_add_u32 s67, s67, s47
    s_lshl_b32 s67, s67, 7
    s_waitcnt lgkmcnt(4)
    v_mfma_f32_16x16x32_bf16 v[104:107], v[184:187], a[0:3], 0
    ds_read_b128 v[176:179], v4 offset:2048
    ds_read_b128 v[180:183], v4 offset:3072
    v_mfma_f32_16x16x32_bf16 v[108:111], v[188:191], a[0:3], 0
    s_add_u32 s67, s67, 13787136
    v_mov_b32 v246, 0
    v_mfma_f32_16x16x32_bf16 v[112:115], v[184:187], a[4:7], 0
    buffer_load_dwordx4 v3, s[12:15], s101 offen offset:1024 lds
    v_mfma_f32_16x16x32_bf16 v[116:119], v[188:191], a[4:7], 0
    v_mfma_f32_16x16x32_bf16 v[120:123], v[184:187], a[8:11], 0
    v_mfma_f32_16x16x32_bf16 v[124:127], v[188:191], a[8:11], 0
    v_mfma_f32_16x16x32_bf16 v[128:131], v[184:187], a[12:15], 0
    buffer_load_dwordx4 v3, s[12:15], s101 offen offset:2048 lds
    v_mfma_f32_16x16x32_bf16 v[132:135], v[188:191], a[12:15], 0
    s_waitcnt lgkmcnt(4)
    v_mfma_f32_16x16x32_bf16 v[136:139], v[192:195], a[0:3], 0
    ds_read_b128 v[184:187], v5 offset:2048
    ds_read_b128 v[188:191], v5 offset:3072
    v_mfma_f32_16x16x32_bf16 v[140:143], v[196:199], a[0:3], 0
    v_mfma_f32_16x16x32_bf16 v[144:147], v[192:195], a[4:7], 0
    v_mfma_f32_16x16x32_bf16 v[148:151], v[196:199], a[4:7], 0
    buffer_load_dwordx4 v3, s[12:15], s101 offen offset:3072 lds
    v_mfma_f32_16x16x32_bf16 v[152:155], v[192:195], a[8:11], 0
    v_mfma_f32_16x16x32_bf16 v[156:159], v[196:199], a[8:11], 0
    v_mfma_f32_16x16x32_bf16 v[160:163], v[192:195], a[12:15], 0
    v_mfma_f32_16x16x32_bf16 v[164:167], v[196:199], a[12:15], 0
    s_add_u32 s26, s26, 4096
    buffer_load_dwordx4 a[64:67], v3, s[8:11], s26 offen offset:0
    s_waitcnt vmcnt(19)
    s_waitcnt lgkmcnt(4)
    v_mfma_f32_16x16x32_bf16 v[40:43], v[168:171], a[16:19], v[40:43]
    ds_read_b128 v[192:195], v6 offset:2048
    ds_read_b128 v[196:199], v6 offset:3072
    v_mfma_f32_16x16x32_bf16 v[44:47], v[172:175], a[16:19], v[44:47]
    v_mfma_f32_16x16x32_bf16 v[48:51], v[168:171], a[20:23], v[48:51]
    v_mfma_f32_16x16x32_bf16 v[52:55], v[172:175], a[20:23], v[52:55]
    v_mfma_f32_16x16x32_bf16 v[56:59], v[168:171], a[24:27], v[56:59]
    s_add_u32 s27, s27, 4096
    buffer_load_dwordx4 a[68:71], v3, s[8:11], s27 offen offset:0
    v_mfma_f32_16x16x32_bf16 v[60:63], v[172:175], a[24:27], v[60:63]
    v_mfma_f32_16x16x32_bf16 v[64:67], v[168:171], a[28:31], v[64:67]
    v_mfma_f32_16x16x32_bf16 v[68:71], v[172:175], a[28:31], v[68:71]
    s_waitcnt vmcnt(16)
    s_barrier
    s_waitcnt lgkmcnt(4)
    v_mfma_f32_16x16x32_bf16 v[72:75], v[176:179], a[16:19], v[72:75]
    ds_read_b128 v[168:171], v3 offset:4096
    ds_read_b128 v[172:175], v3 offset:5120
    v_mfma_f32_16x16x32_bf16 v[76:79], v[180:183], a[16:19], v[76:79]
    s_add_u32 s28, s28, 4096
    buffer_load_dwordx4 a[72:75], v3, s[8:11], s28 offen offset:0
    v_mfma_f32_16x16x32_bf16 v[80:83], v[176:179], a[20:23], v[80:83]
    s_bfe_u32 s52, s2, 0x20001
    s_and_b32 s53, s2, 1
    v_mfma_f32_16x16x32_bf16 v[84:87], v[180:183], a[20:23], v[84:87]
    s_lshl_b32 s53, s53, 3
    s_lshr_b32 s54, s2, 5
    v_mfma_f32_16x16x32_bf16 v[88:91], v[176:179], a[24:27], v[88:91]
    s_add_u32 s53, s53, s54
    s_bfe_u32 s54, s2, 0x20003
    v_mfma_f32_16x16x32_bf16 v[92:95], v[180:183], a[24:27], v[92:95]
    s_add_u32 s29, s29, 4096
    buffer_load_dwordx4 a[76:79], v3, s[8:11], s29 offen offset:0
    v_mfma_f32_16x16x32_bf16 v[96:99], v[176:179], a[28:31], v[96:99]
    s_lshl_b32 s56, s54, 2
    s_add_u32 s56, s56, s52
    v_mfma_f32_16x16x32_bf16 v[100:103], v[180:183], a[28:31], v[100:103]
    s_mul_i32 s56, s56, 331776
    s_add_u32 s56, s56, s30
    s_waitcnt lgkmcnt(4)
    v_mfma_f32_16x16x32_bf16 v[104:107], v[184:187], a[16:19], v[104:107]
    ds_read_b128 v[176:179], v4 offset:4096
    ds_read_b128 v[180:183], v4 offset:5120
    v_mfma_f32_16x16x32_bf16 v[108:111], v[188:191], a[16:19], v[108:111]
    s_add_u32 s56, s56, 67108864
    s_lshl_b32 s55, s53, 2
    v_mfma_f32_16x16x32_bf16 v[112:115], v[184:187], a[20:23], v[112:115]
    buffer_load_dwordx4 a[80:83], v3, s[8:11], s26 offen offset:1024
    v_mfma_f32_16x16x32_bf16 v[116:119], v[188:191], a[20:23], v[116:119]
    s_add_u32 s55, s55, s3
    s_mul_i32 s57, s55, 294912
    v_mfma_f32_16x16x32_bf16 v[120:123], v[184:187], a[24:27], v[120:123]
    s_mul_i32 s63, s52, 36864
    s_add_u32 s57, s57, s63
    v_mfma_f32_16x16x32_bf16 v[124:127], v[188:191], a[24:27], v[124:127]
    s_add_u32 s57, s57, 33554432
    s_lshl_b32 s63, s55, 2
    v_mfma_f32_16x16x32_bf16 v[128:131], v[184:187], a[28:31], v[128:131]
    buffer_load_dwordx4 a[84:87], v3, s[8:11], s27 offen offset:1024
    v_mfma_f32_16x16x32_bf16 v[132:135], v[188:191], a[28:31], v[132:135]
    s_add_u32 s63, s63, s54
    s_mul_i32 s64, s63, 24576
    s_waitcnt lgkmcnt(4)
    v_mfma_f32_16x16x32_bf16 v[136:139], v[192:195], a[16:19], v[136:139]
    ds_read_b128 v[184:187], v5 offset:4096
    ds_read_b128 v[188:191], v5 offset:5120
    v_mfma_f32_16x16x32_bf16 v[140:143], v[196:199], a[16:19], v[140:143]
    s_add_u32 s64, s64, 54525952
    s_add_u32 s65, s52, 1
    v_mfma_f32_16x16x32_bf16 v[144:147], v[192:195], a[20:23], v[144:147]
    s_and_b32 s65, s65, 3
    s_mul_i32 s65, s65, 6144
    v_mfma_f32_16x16x32_bf16 v[148:151], v[196:199], a[20:23], v[148:151]
    buffer_load_dwordx4 a[88:91], v3, s[8:11], s28 offen offset:1024
    v_mfma_f32_16x16x32_bf16 v[152:155], v[192:195], a[24:27], v[152:155]
    s_add_u32 s58, s65, s64
    s_add_u32 s65, s52, 2
    v_mfma_f32_16x16x32_bf16 v[156:159], v[196:199], a[24:27], v[156:159]
    s_and_b32 s65, s65, 3
    s_mul_i32 s65, s65, 6144
    v_mfma_f32_16x16x32_bf16 v[160:163], v[192:195], a[28:31], v[160:163]
    s_add_u32 s59, s65, s64
    s_add_u32 s65, s52, 3
    v_mfma_f32_16x16x32_bf16 v[164:167], v[196:199], a[28:31], v[164:167]
    buffer_load_dwordx4 a[92:95], v3, s[8:11], s29 offen offset:1024
    s_waitcnt vmcnt(18)
    s_waitcnt lgkmcnt(4)
    v_mfma_f32_16x16x32_bf16 v[40:43], v[168:171], a[32:35], v[40:43]
    ds_read_b128 v[192:195], v6 offset:4096
    ds_read_b128 v[196:199], v6 offset:5120
    v_mfma_f32_16x16x32_bf16 v[44:47], v[172:175], a[32:35], v[44:47]
    s_and_b32 s65, s65, 3
    s_mul_i32 s65, s65, 6144
    v_mfma_f32_16x16x32_bf16 v[48:51], v[168:171], a[36:39], v[48:51]
    s_add_u32 s60, s65, s64
    s_lshr_b32 s63, s20, 3
    v_mfma_f32_16x16x32_bf16 v[52:55], v[172:175], a[36:39], v[52:55]
    s_add_u32 s61, s24, s63
    s_lshl_b32 s61, s61, 9
    v_mfma_f32_16x16x32_bf16 v[56:59], v[168:171], a[40:43], v[56:59]
    buffer_load_dwordx4 v[200:203], v2, s[8:11], s41 offen
    s_add_u32 s41, s41, 36864
    v_mfma_f32_16x16x32_bf16 v[60:63], v[172:175], a[40:43], v[60:63]
    s_add_u32 s61, s61, 13828096
    s_lshr_b32 s62, s55, 1
    v_mfma_f32_16x16x32_bf16 v[64:67], v[168:171], a[44:47], v[64:67]
    s_lshl_b32 s62, s62, 2
    s_add_u32 s62, s62, s52
    v_mfma_f32_16x16x32_bf16 v[68:71], v[172:175], a[44:47], v[68:71]
    s_lshl_b32 s62, s62, 9
    s_add_u32 s62, s62, 13828096
    s_waitcnt lgkmcnt(4)
    v_mfma_f32_16x16x32_bf16 v[72:75], v[176:179], a[32:35], v[72:75]
    ds_read_b128 v[168:171], v3 offset:6144
    ds_read_b128 v[172:175], v3 offset:7168
    v_mfma_f32_16x16x32_bf16 v[76:79], v[180:183], a[32:35], v[76:79]
    buffer_load_dwordx4 v[204:207], v2, s[8:11], s41 offen
    s_add_u32 s41, s41, 36864
    v_mfma_f32_16x16x32_bf16 v[80:83], v[176:179], a[36:39], v[80:83]
    s_mul_i32 s66, s52, 9
    s_lshl_b32 s63, s54, 1
    v_mfma_f32_16x16x32_bf16 v[84:87], v[180:183], a[36:39], v[84:87]
    s_add_u32 s66, s66, s63
    s_lshl_b32 s66, s66, 7
    v_mfma_f32_16x16x32_bf16 v[88:91], v[176:179], a[40:43], v[88:91]
    s_add_u32 s66, s66, 13778944
    v_mfma_f32_16x16x32_bf16 v[92:95], v[180:183], a[40:43], v[92:95]
    buffer_load_dwordx4 v[208:211], v2, s[8:11], s41 offen
    s_add_u32 s41, s41, 36864
    v_mfma_f32_16x16x32_bf16 v[96:99], v[176:179], a[44:47], v[96:99]
    s_lshl_b32 s47, s2, 2
    s_add_u32 s47, s47, s3
    v_mfma_f32_16x16x32_bf16 v[100:103], v[180:183], a[44:47], v[100:103]
    s_cmp_lt_u32 s47, 648
    s_cselect_b32 s18, 5308416, 0
    s_cselect_b32 s70, 268435456, 0
    s_waitcnt lgkmcnt(4)
    v_mfma_f32_16x16x32_bf16 v[104:107], v[184:187], a[32:35], v[104:107]
    ds_read_b128 v[176:179], v4 offset:6144
    ds_read_b128 v[180:183], v4 offset:7168
    v_mfma_f32_16x16x32_bf16 v[108:111], v[188:191], a[32:35], v[108:111]
    s_mov_b32 s68, s8
    s_mov_b32 s69, s9
    v_mfma_f32_16x16x32_bf16 v[112:115], v[184:187], a[36:39], v[112:115]
    buffer_load_dwordx4 v[212:215], v2, s[8:11], s41 offen
    s_add_u32 s41, s41, 36864
    v_mfma_f32_16x16x32_bf16 v[116:119], v[188:191], a[36:39], v[116:119]
    s_mov_b32 s71, 0x20000
    s_mul_i32 s48, s47, 1821
    v_mfma_f32_16x16x32_bf16 v[120:123], v[184:187], a[40:43], v[120:123]
    s_lshr_b32 s48, s48, 14
    s_mul_i32 s49, s48, 9
    v_mfma_f32_16x16x32_bf16 v[124:127], v[188:191], a[40:43], v[124:127]
    s_sub_u32 s49, s47, s49
    s_mul_i32 s73, s48, 73728
    v_mfma_f32_16x16x32_bf16 v[128:131], v[184:187], a[44:47], v[128:131]
    buffer_load_dwordx4 v[216:219], v2, s[8:11], s41 offen
    s_add_u32 s41, s41, 36864
    v_mfma_f32_16x16x32_bf16 v[132:135], v[188:191], a[44:47], v[132:135]
    s_lshl_b32 s47, s49, 7
    s_add_u32 s73, s73, s47
    s_waitcnt lgkmcnt(4)
    v_mfma_f32_16x16x32_bf16 v[136:139], v[192:195], a[32:35], v[136:139]
    ds_read_b128 v[184:187], v5 offset:6144
    ds_read_b128 v[188:191], v5 offset:7168
    v_mfma_f32_16x16x32_bf16 v[140:143], v[196:199], a[32:35], v[140:143]
    s_lshr_b32 s72, s3, 1
    s_mul_i32 s72, s72, 20480
    v_mfma_f32_16x16x32_bf16 v[144:147], v[192:195], a[36:39], v[144:147]
    s_lshl_b32 s47, s3, 13
    s_add_u32 s72, s72, s47
    v_mfma_f32_16x16x32_bf16 v[148:151], v[196:199], a[36:39], v[148:151]
    buffer_load_dwordx4 v[220:223], v2, s[8:11], s41 offen
    s_add_u32 s41, s41, 36864
    v_mfma_f32_16x16x32_bf16 v[152:155], v[192:195], a[40:43], v[152:155]
    s_add_u32 s72, s72, 73728
    v_mfma_f32_16x16x32_bf16 v[156:159], v[196:199], a[40:43], v[156:159]
    s_lshl_b32 s47, s48, 1
    s_add_u32 s47, s47, 0
    v_mfma_f32_16x16x32_bf16 v[160:163], v[192:195], a[44:47], v[160:163]
    s_mul_i32 s50, s47, 57
    s_lshr_b32 s50, s50, 9
    v_mfma_f32_16x16x32_bf16 v[164:167], v[196:199], a[44:47], v[164:167]
    s_add_u32 m0, s99, 12288
    s_add_u32 s101, s100, 12288
    buffer_load_dwordx4 v3, s[12:15], s101 offen offset:0 lds
    s_waitcnt vmcnt(21)
    s_waitcnt lgkmcnt(4)
    v_mfma_f32_16x16x32_bf16 v[40:43], v[168:171], a[48:51], v[40:43]
    ds_read_b128 v[192:195], v6 offset:6144
    ds_read_b128 v[196:199], v6 offset:7168
    v_mfma_f32_16x16x32_bf16 v[44:47], v[172:175], a[48:51], v[44:47]
    s_mul_i32 s63, s50, 9
    s_sub_u32 s47, s47, s63
    v_mfma_f32_16x16x32_bf16 v[48:51], v[168:171], a[52:55], v[48:51]
    s_lshl_b32 s63, s47, 1
    s_lshr_b32 s76, s50, 2
    v_mfma_f32_16x16x32_bf16 v[52:55], v[172:175], a[52:55], v[52:55]
    s_cmp_gt_u32 s47, 4
    s_cselect_b32 s47, 9, 0
    v_mfma_f32_16x16x32_bf16 v[56:59], v[168:171], a[56:59], v[56:59]
    buffer_load_dwordx4 v3, s[12:15], s101 offen offset:1024 lds
    v_mfma_f32_16x16x32_bf16 v[60:63], v[172:175], a[56:59], v[60:63]
    s_sub_u32 s63, s63, s47
    s_lshl_b32 s63, s63, 2
    v_mfma_f32_16x16x32_bf16 v[64:67], v[168:171], a[60:63], v[64:67]
    s_and_b32 s47, s50, 3
    s_add_u32 s63, s63, s47
    v_mfma_f32_16x16x32_bf16 v[68:71], v[172:175], a[60:63], v[68:71]
    s_lshl_b32 s47, s48, 1
    s_add_u32 s47, s47, 1
    s_waitcnt vmcnt(16)
    s_barrier
    s_waitcnt lgkmcnt(4)
    v_mfma_f32_16x16x32_bf16 v[72:75], v[176:179], a[48:51], v[72:75]
    ds_read_b128 v[168:171], v3 offset:8192
    ds_read_b128 v[172:175], v3 offset:9216
    v_mfma_f32_16x16x32_bf16 v[76:79], v[180:183], a[48:51], v[76:79]
    buffer_load_dwordx4 v3, s[12:15], s101 offen offset:2048 lds
    v_mfma_f32_16x16x32_bf16 v[80:83], v[176:179], a[52:55], v[80:83]
    v_add_f32 v236, v236, v240
    v_mfma_f32_16x16x32_bf16 v[84:87], v[180:183], a[52:55], v[84:87]
    v_add_f32 v237, v237, v241
    v_mfma_f32_16x16x32_bf16 v[88:91], v[176:179], a[56:59], v[88:91]
    v_add_f32 v238, v238, v242
    v_mfma_f32_16x16x32_bf16 v[92:95], v[180:183], a[56:59], v[92:95]
    buffer_load_dwordx4 v3, s[12:15], s101 offen offset:3072 lds
    v_mfma_f32_16x16x32_bf16 v[96:99], v[176:179], a[60:63], v[96:99]
    v_add_f32 v239, v239, v243
    v_mfma_f32_16x16x32_bf16 v[100:103], v[180:183], a[60:63], v[100:103]
    v_add_f32_dpp v236, v236, v236 row_shr:1 row_mask:0xf bank_mask:0xf bound_ctrl:0
    s_waitcnt lgkmcnt(4)
    v_mfma_f32_16x16x32_bf16 v[104:107], v[184:187], a[48:51], v[104:107]
    ds_read_b128 v[176:179], v4 offset:8192
    ds_read_b128 v[180:183], v4 offset:9216
    v_mfma_f32_16x16x32_bf16 v[108:111], v[188:191], a[48:51], v[108:111]
    v_add_f32_dpp v237, v237, v237 row_shr:1 row_mask:0xf bank_mask:0xf bound_ctrl:0
    v_mfma_f32_16x16x32_bf16 v[112:115], v[184:187], a[52:55], v[112:115]
    buffer_load_dwordx4 a[96:99], v3, s[8:11], s26 offen offset:2048
    v_mfma_f32_16x16x32_bf16 v[116:119], v[188:191], a[52:55], v[116:119]
    v_add_f32_dpp v238, v238, v238 row_shr:1 row_mask:0xf bank_mask:0xf bound_ctrl:0
    v_mfma_f32_16x16x32_bf16 v[120:123], v[184:187], a[56:59], v[120:123]
    v_add_f32_dpp v239, v239, v239 row_shr:1 row_mask:0xf bank_mask:0xf bound_ctrl:0
    v_mfma_f32_16x16x32_bf16 v[124:127], v[188:191], a[56:59], v[124:127]
    v_add_f32_dpp v236, v236, v236 row_shr:2 row_mask:0xf bank_mask:0xf bound_ctrl:0
    v_mfma_f32_16x16x32_bf16 v[128:131], v[184:187], a[60:63], v[128:131]
    buffer_load_dwordx4 a[100:103], v3, s[8:11], s27 offen offset:2048
    v_mfma_f32_16x16x32_bf16 v[132:135], v[188:191], a[60:63], v[132:135]
    v_add_f32_dpp v237, v237, v237 row_shr:2 row_mask:0xf bank_mask:0xf bound_ctrl:0
    s_waitcnt lgkmcnt(4)
    v_mfma_f32_16x16x32_bf16 v[136:139], v[192:195], a[48:51], v[136:139]
    ds_read_b128 v[184:187], v5 offset:8192
    ds_read_b128 v[188:191], v5 offset:9216
    v_mfma_f32_16x16x32_bf16 v[140:143], v[196:199], a[48:51], v[140:143]
    v_add_f32_dpp v238, v238, v238 row_shr:2 row_mask:0xf bank_mask:0xf bound_ctrl:0
    v_mfma_f32_16x16x32_bf16 v[144:147], v[192:195], a[52:55], v[144:147]
    v_add_f32_dpp v239, v239, v239 row_shr:2 row_mask:0xf bank_mask:0xf bound_ctrl:0
    v_mfma_f32_16x16x32_bf16 v[148:151], v[196:199], a[52:55], v[148:151]
    buffer_load_dwordx4 a[104:107], v3, s[8:11], s28 offen offset:2048
    v_mfma_f32_16x16x32_bf16 v[152:155], v[192:195], a[56:59], v[152:155]
    v_add_f32_dpp v236, v236, v236 row_shr:4 row_mask:0xf bank_mask:0xf bound_ctrl:0
    v_mfma_f32_16x16x32_bf16 v[156:159], v[196:199], a[56:59], v[156:159]
    v_add_f32_dpp v237, v237, v237 row_shr:4 row_mask:0xf bank_mask:0xf bound_ctrl:0
    v_mfma_f32_16x16x32_bf16 v[160:163], v[192:195], a[60:63], v[160:163]
    v_add_f32_dpp v238, v238, v238 row_shr:4 row_mask:0xf bank_mask:0xf bound_ctrl:0
    v_mfma_f32_16x16x32_bf16 v[164:167], v[196:199], a[60:63], v[164:167]
    buffer_load_dwordx4 a[108:111], v3, s[8:11], s29 offen offset:2048
    s_waitcnt vmcnt(18)
    s_waitcnt lgkmcnt(4)
    v_mfma_f32_16x16x32_bf16 v[40:43], v[168:171], a[64:67], v[40:43]
    ds_read_b128 v[192:195], v6 offset:8192
    ds_read_b128 v[196:199], v6 offset:9216
    v_mfma_f32_16x16x32_bf16 v[44:47], v[172:175], a[64:67], v[44:47]
    v_add_f32_dpp v239, v239, v239 row_shr:4 row_mask:0xf bank_mask:0xf bound_ctrl:0
    v_mfma_f32_16x16x32_bf16 v[48:51], v[168:171], a[68:71], v[48:51]
    v_add_f32_dpp v236, v236, v236 row_shr:8 row_mask:0xf bank_mask:0xf bound_ctrl:0
    v_mfma_f32_16x16x32_bf16 v[52:55], v[172:175], a[68:71], v[52:55]
    v_add_f32_dpp v237, v237, v237 row_shr:8 row_mask:0xf bank_mask:0xf bound_ctrl:0
    v_mfma_f32_16x16x32_bf16 v[56:59], v[168:171], a[72:75], v[56:59]
    buffer_load_dwordx4 a[112:115], v3, s[8:11], s26 offen offset:3072
    v_mfma_f32_16x16x32_bf16 v[60:63], v[172:175], a[72:75], v[60:63]
    v_add_f32_dpp v238, v238, v238 row_shr:8 row_mask:0xf bank_mask:0xf bound_ctrl:0
    v_mfma_f32_16x16x32_bf16 v[64:67], v[168:171], a[76:79], v[64:67]
    v_add_f32_dpp v239, v239, v239 row_shr:8 row_mask:0xf bank_mask:0xf bound_ctrl:0
    v_mfma_f32_16x16x32_bf16 v[68:71], v[172:175], a[76:79], v[68:71]
    v_add_f32_dpp v236, v236, v236 row_bcast:15 row_mask:0xa bank_mask:0xf
    s_waitcnt lgkmcnt(4)
    v_mfma_f32_16x16x32_bf16 v[72:75], v[176:179], a[64:67], v[72:75]
    ds_read_b128 v[168:171], v3 offset:10240
    ds_read_b128 v[172:175], v3 offset:11264
    v_mfma_f32_16x16x32_bf16 v[76:79], v[180:183], a[64:67], v[76:79]
    buffer_load_dwordx4 a[116:119], v3, s[8:11], s27 offen offset:3072
    v_mfma_f32_16x16x32_bf16 v[80:83], v[176:179], a[68:71], v[80:83]
    v_add_f32_dpp v237, v237, v237 row_bcast:15 row_mask:0xa bank_mask:0xf
    v_mfma_f32_16x16x32_bf16 v[84:87], v[180:183], a[68:71], v[84:87]
    v_add_f32_dpp v238, v238, v238 row_bcast:15 row_mask:0xa bank_mask:0xf
    v_mfma_f32_16x16x32_bf16 v[88:91], v[176:179], a[72:75], v[88:91]
    v_add_f32_dpp v239, v239, v239 row_bcast:15 row_mask:0xa bank_mask:0xf
    v_mfma_f32_16x16x32_bf16 v[92:95], v[180:183], a[72:75], v[92:95]
    buffer_load_dwordx4 a[120:123], v3, s[8:11], s28 offen offset:3072
    v_mfma_f32_16x16x32_bf16 v[96:99], v[176:179], a[76:79], v[96:99]
    v_add_f32_dpp v236, v236, v236 row_bcast:31 row_mask:0xc bank_mask:0xf
    v_mfma_f32_16x16x32_bf16 v[100:103], v[180:183], a[76:79], v[100:103]
    v_add_f32_dpp v237, v237, v237 row_bcast:31 row_mask:0xc bank_mask:0xf
    s_waitcnt lgkmcnt(4)
    v_mfma_f32_16x16x32_bf16 v[104:107], v[184:187], a[64:67], v[104:107]
    ds_read_b128 v[176:179], v4 offset:10240
    ds_read_b128 v[180:183], v4 offset:11264
    v_mfma_f32_16x16x32_bf16 v[108:111], v[188:191], a[64:67], v[108:111]
    v_add_f32_dpp v238, v238, v238 row_bcast:31 row_mask:0xc bank_mask:0xf
    v_mfma_f32_16x16x32_bf16 v[112:115], v[184:187], a[68:71], v[112:115]
    buffer_load_dwordx4 a[124:127], v3, s[8:11], s29 offen offset:3072
    v_mfma_f32_16x16x32_bf16 v[116:119], v[188:191], a[68:71], v[116:119]
    v_add_f32_dpp v239, v239, v239 row_bcast:31 row_mask:0xc bank_mask:0xf
    v_mfma_f32_16x16x32_bf16 v[120:123], v[184:187], a[72:75], v[120:123]
    v_mul_f32 v236, 0xbae38e39, v236
    v_mul_f32 v238, 0xbae38e39, v238
    v_mfma_f32_16x16x32_bf16 v[124:127], v[188:191], a[72:75], v[124:127]
    v_mul_f32 v237, 0x3ae38e39, v237
    v_mul_f32 v239, 0x3ae38e39, v239
    v_mfma_f32_16x16x32_bf16 v[128:131], v[184:187], a[76:79], v[128:131]
    s_add_u32 m0, s99, 16384
    s_add_u32 s101, s100, 16384
    buffer_load_dwordx4 v3, s[12:15], s101 offen offset:0 lds
    v_mfma_f32_16x16x32_bf16 v[132:135], v[188:191], a[76:79], v[132:135]
    v_cvt_pk_bf16_f32 v240, v236, v236
    v_cvt_pk_bf16_f32 v242, v238, v238
    s_waitcnt lgkmcnt(4)
    v_mfma_f32_16x16x32_bf16 v[136:139], v[192:195], a[64:67], v[136:139]
    ds_read_b128 v[184:187], v5 offset:10240
    ds_read_b128 v[188:191], v5 offset:11264
    v_mfma_f32_16x16x32_bf16 v[140:143], v[196:199], a[64:67], v[140:143]
    v_fma_f32 v236, -v236, v236, v237
    v_fma_f32 v238, -v238, v238, v239
    v_mfma_f32_16x16x32_bf16 v[144:147], v[192:195], a[68:71], v[144:147]
    v_lshlrev_b32 v240, 16, v240
    v_lshlrev_b32 v242, 16, v242
    v_mfma_f32_16x16x32_bf16 v[148:151], v[196:199], a[68:71], v[148:151]
    buffer_load_dwordx4 v3, s[12:15], s101 offen offset:1024 lds
    v_mfma_f32_16x16x32_bf16 v[152:155], v[192:195], a[72:75], v[152:155]
    v_max_f32 v236, 0, v236
    v_max_f32 v238, 0, v238
    v_mfma_f32_16x16x32_bf16 v[156:159], v[196:199], a[72:75], v[156:159]
    v_cvt_pk_bf16_f32 v236, v236, v236
    v_cvt_pk_bf16_f32 v238, v238, v238
    v_mfma_f32_16x16x32_bf16 v[160:163], v[192:195], a[76:79], v[160:163]
    v_lshlrev_b32 v236, 16, v236
    v_lshlrev_b32 v238, 16, v238
    v_mfma_f32_16x16x32_bf16 v[164:167], v[196:199], a[76:79], v[164:167]
    buffer_load_dwordx4 v3, s[12:15], s101 offen offset:2048 lds
    s_waitcnt vmcnt(21)
    s_waitcnt lgkmcnt(4)
    v_mfma_f32_16x16x32_bf16 v[40:43], v[168:171], a[80:83], v[40:43]
    ds_read_b128 v[192:195], v6 offset:10240
    ds_read_b128 v[196:199], v6 offset:11264
    v_mfma_f32_16x16x32_bf16 v[44:47], v[172:175], a[80:83], v[44:47]
    v_add_f32 v236, 0x3727c5ac, v236
    v_add_f32 v238, 0x3727c5ac, v238
    v_mfma_f32_16x16x32_bf16 v[48:51], v[168:171], a[84:87], v[48:51]
    v_cvt_pk_bf16_f32 v236, v236, v236
    v_cvt_pk_bf16_f32 v238, v238, v238
    v_mfma_f32_16x16x32_bf16 v[52:55], v[172:175], a[84:87], v[52:55]
    v_lshlrev_b32 v236, 16, v236
    v_lshlrev_b32 v238, 16, v238
    v_mfma_f32_16x16x32_bf16 v[56:59], v[168:171], a[88:91], v[56:59]
    buffer_load_dwordx4 v3, s[12:15], s101 offen offset:3072 lds
    v_mfma_f32_16x16x32_bf16 v[60:63], v[172:175], a[88:91], v[60:63]
    v_sqrt_f32 v236, v236
    v_sqrt_f32 v238, v238
    v_mfma_f32_16x16x32_bf16 v[64:67], v[168:171], a[92:95], v[64:67]
    v_cvt_pk_bf16_f32 v236, v236, v236
    v_cvt_pk_bf16_f32 v238, v238, v238
    v_mfma_f32_16x16x32_bf16 v[68:71], v[172:175], a[92:95], v[68:71]
    v_lshlrev_b32 v236, 16, v236
    v_lshlrev_b32 v238, 16, v238
    s_waitcnt vmcnt(12)
    s_barrier
    s_waitcnt lgkmcnt(4)
    v_mfma_f32_16x16x32_bf16 v[72:75], v[176:179], a[80:83], v[72:75]
    ds_read_b128 v[168:171], v3 offset:12288
    ds_read_b128 v[172:175], v3 offset:13312
    v_mfma_f32_16x16x32_bf16 v[76:79], v[180:183], a[80:83], v[76:79]
    s_add_u32 s26, s26, 4096
    buffer_load_dwordx4 a[128:131], v3, s[8:11], s26 offen offset:0
    v_mfma_f32_16x16x32_bf16 v[80:83], v[176:179], a[84:87], v[80:83]
    v_mul_f32 v236, v236, v236
    v_mul_f32 v238, v238, v238
    v_mfma_f32_16x16x32_bf16 v[84:87], v[180:183], a[84:87], v[84:87]
    v_rcp_f32 v241, v236
    v_rcp_f32 v243, v238
    v_mfma_f32_16x16x32_bf16 v[88:91], v[176:179], a[88:91], v[88:91]
    s_add_u32 s42, s42, 13631488
    v_mfma_f32_16x16x32_bf16 v[92:95], v[180:183], a[88:91], v[92:95]
    s_add_u32 s27, s27, 4096
    buffer_load_dwordx4 a[132:135], v3, s[8:11], s27 offen offset:0
    v_mfma_f32_16x16x32_bf16 v[96:99], v[176:179], a[92:95], v[96:99]
    s_mov_b32 exec_lo, 0
    s_mov_b32 exec_hi, 0x80000000
    buffer_store_dwordx4 v[240:243], v246, s[8:11], s42 offen sc1
    s_mov_b64 exec, -1
    v_mfma_f32_16x16x32_bf16 v[100:103], v[180:183], a[92:95], v[100:103]
    v_add_f32 v200, v200, v204
    s_waitcnt lgkmcnt(4)
    v_mfma_f32_16x16x32_bf16 v[104:107], v[184:187], a[80:83], v[104:107]
L_pad_k3_kernel_1:
    s_cbranch_execz k3_kernel_end
    ds_read_b128 v[176:179], v4 offset:12288
    ds_read_b128 v[180:183], v4 offset:13312
    v_mfma_f32_16x16x32_bf16 v[108:111], v[188:191], a[80:83], v[108:111]
    v_add_f32 v201, v201, v205
    v_mfma_f32_16x16x32_bf16 v[112:115], v[184:187], a[84:87], v[112:115]
    s_add_u32 s28, s28, 4096
    buffer_load_dwordx4 a[136:139], v3, s[8:11], s28 offen offset:0
    v_mfma_f32_16x16x32_bf16 v[116:119], v[188:191], a[84:87], v[116:119]
    v_add_f32 v202, v202, v206
    v_mfma_f32_16x16x32_bf16 v[120:123], v[184:187], a[88:91], v[120:123]
    v_add_f32 v203, v203, v207
    v_mfma_f32_16x16x32_bf16 v[124:127], v[188:191], a[88:91], v[124:127]
    v_add_f32 v200, v200, v208
    v_mfma_f32_16x16x32_bf16 v[128:131], v[184:187], a[92:95], v[128:131]
    s_add_u32 s29, s29, 4096
    buffer_load_dwordx4 a[140:143], v3, s[8:11], s29 offen offset:0
    v_mfma_f32_16x16x32_bf16 v[132:135], v[188:191], a[92:95], v[132:135]
    v_add_f32 v201, v201, v209
    s_waitcnt lgkmcnt(4)
    v_mfma_f32_16x16x32_bf16 v[136:139], v[192:195], a[80:83], v[136:139]
    ds_read_b128 v[184:187], v5 offset:12288
    ds_read_b128 v[188:191], v5 offset:13312
    v_mfma_f32_16x16x32_bf16 v[140:143], v[196:199], a[80:83], v[140:143]
    v_add_f32 v202, v202, v210
    v_mfma_f32_16x16x32_bf16 v[144:147], v[192:195], a[84:87], v[144:147]
    v_add_f32 v203, v203, v211
    v_mfma_f32_16x16x32_bf16 v[148:151], v[196:199], a[84:87], v[148:151]
    buffer_load_dwordx4 a[144:147], v3, s[8:11], s26 offen offset:1024
    v_mfma_f32_16x16x32_bf16 v[152:155], v[192:195], a[88:91], v[152:155]
    v_add_f32 v200, v200, v212
    v_mfma_f32_16x16x32_bf16 v[156:159], v[196:199], a[88:91], v[156:159]
    v_add_f32 v201, v201, v213
    v_mfma_f32_16x16x32_bf16 v[160:163], v[192:195], a[92:95], v[160:163]
    v_add_f32 v202, v202, v214
    v_mfma_f32_16x16x32_bf16 v[164:167], v[196:199], a[92:95], v[164:167]
    buffer_load_dwordx4 a[148:151], v3, s[8:11], s27 offen offset:1024
    s_waitcnt vmcnt(15)
    s_waitcnt lgkmcnt(4)
    v_mfma_f32_16x16x32_bf16 v[40:43], v[168:171], a[96:99], v[40:43]
    ds_read_b128 v[192:195], v6 offset:12288
    ds_read_b128 v[196:199], v6 offset:13312
    v_mfma_f32_16x16x32_bf16 v[44:47], v[172:175], a[96:99], v[44:47]
    v_add_f32 v203, v203, v215
    v_mfma_f32_16x16x32_bf16 v[48:51], v[168:171], a[100:103], v[48:51]
    v_add_f32 v200, v200, v216
    v_mfma_f32_16x16x32_bf16 v[52:55], v[172:175], a[100:103], v[52:55]
    v_add_f32 v201, v201, v217
    v_mfma_f32_16x16x32_bf16 v[56:59], v[168:171], a[104:107], v[56:59]
    buffer_load_dwordx4 a[152:155], v3, s[8:11], s28 offen offset:1024
    v_mfma_f32_16x16x32_bf16 v[60:63], v[172:175], a[104:107], v[60:63]
    v_add_f32 v202, v202, v218
    v_mfma_f32_16x16x32_bf16 v[64:67], v[168:171], a[108:111], v[64:67]
    v_add_f32 v203, v203, v219
    v_mfma_f32_16x16x32_bf16 v[68:71], v[172:175], a[108:111], v[68:71]
    v_add_f32 v200, v200, v220
    s_waitcnt lgkmcnt(4)
    v_mfma_f32_16x16x32_bf16 v[72:75], v[176:179], a[96:99], v[72:75]
    ds_read_b128 v[168:171], v3 offset:14336
    ds_read_b128 v[172:175], v3 offset:15360
    v_mfma_f32_16x16x32_bf16 v[76:79], v[180:183], a[96:99], v[76:79]
    buffer_load_dwordx4 a[156:159], v3, s[8:11], s29 offen offset:1024
    v_mfma_f32_16x16x32_bf16 v[80:83], v[176:179], a[100:103], v[80:83]
    v_add_f32 v201, v201, v221
    v_mfma_f32_16x16x32_bf16 v[84:87], v[180:183], a[100:103], v[84:87]
    v_add_f32 v202, v202, v222
    v_mfma_f32_16x16x32_bf16 v[88:91], v[176:179], a[104:107], v[88:91]
    v_add_f32 v203, v203, v223
    v_mfma_f32_16x16x32_bf16 v[92:95], v[180:183], a[104:107], v[92:95]
    s_add_u32 m0, s99, 20480
    s_add_u32 s101, s100, 20480
    buffer_load_dwordx4 v3, s[12:15], s101 offen offset:0 lds
    v_mfma_f32_16x16x32_bf16 v[96:99], v[176:179], a[108:111], v[96:99]
    ds_write_b128 v234, v[200:203]
    v_mfma_f32_16x16x32_bf16 v[100:103], v[180:183], a[108:111], v[100:103]
    s_mul_i32 s50, s47, 57
    s_lshr_b32 s50, s50, 9
    s_waitcnt lgkmcnt(5)
    v_mfma_f32_16x16x32_bf16 v[104:107], v[184:187], a[96:99], v[104:107]
    ds_read_b128 v[176:179], v4 offset:14336
    ds_read_b128 v[180:183], v4 offset:15360
    v_mfma_f32_16x16x32_bf16 v[108:111], v[188:191], a[96:99], v[108:111]
    s_mul_i32 s64, s50, 9
    s_sub_u32 s47, s47, s64
    v_mfma_f32_16x16x32_bf16 v[112:115], v[184:187], a[100:103], v[112:115]
    buffer_load_dwordx4 v3, s[12:15], s101 offen offset:1024 lds
    v_mfma_f32_16x16x32_bf16 v[116:119], v[188:191], a[100:103], v[116:119]
    s_lshl_b32 s64, s47, 1
    s_lshr_b32 s76, s50, 2
    v_mfma_f32_16x16x32_bf16 v[120:123], v[184:187], a[104:107], v[120:123]
    s_cmp_gt_u32 s47, 4
    s_cselect_b32 s47, 9, 0
    v_mfma_f32_16x16x32_bf16 v[124:127], v[188:191], a[104:107], v[124:127]
    s_sub_u32 s64, s64, s47
    s_lshl_b32 s64, s64, 2
    v_mfma_f32_16x16x32_bf16 v[128:131], v[184:187], a[108:111], v[128:131]
    buffer_load_dwordx4 v3, s[12:15], s101 offen offset:2048 lds
    v_mfma_f32_16x16x32_bf16 v[132:135], v[188:191], a[108:111], v[132:135]
    s_and_b32 s47, s50, 3
    s_add_u32 s64, s64, s47
    s_waitcnt lgkmcnt(5)
    v_mfma_f32_16x16x32_bf16 v[136:139], v[192:195], a[96:99], v[136:139]
    ds_read_b128 v[184:187], v5 offset:14336
    ds_read_b128 v[188:191], v5 offset:15360
    v_mfma_f32_16x16x32_bf16 v[140:143], v[196:199], a[96:99], v[140:143]
    s_lshl_b32 s47, s49, 2
    s_add_u32 s47, s47, 0
    v_mfma_f32_16x16x32_bf16 v[144:147], v[192:195], a[100:103], v[144:147]
    s_mul_i32 s50, s47, 57
    s_lshr_b32 s50, s50, 9
    v_mfma_f32_16x16x32_bf16 v[148:151], v[196:199], a[100:103], v[148:151]
    buffer_load_dwordx4 v3, s[12:15], s101 offen offset:3072 lds
    v_mfma_f32_16x16x32_bf16 v[152:155], v[192:195], a[104:107], v[152:155]
    s_mul_i32 s65, s50, 9
    s_sub_u32 s47, s47, s65
    v_mfma_f32_16x16x32_bf16 v[156:159], v[196:199], a[104:107], v[156:159]
    s_and_b32 s65, s50, 1
    s_sub_u32 s47, s47, s65
    v_mfma_f32_16x16x32_bf16 v[160:163], v[192:195], a[108:111], v[160:163]
    s_lshl_b32 s65, s76, 1
    s_sub_u32 s65, s47, s65
    v_mfma_f32_16x16x32_bf16 v[164:167], v[196:199], a[108:111], v[164:167]
    buffer_load_dwordx4 a[160:163], v3, s[8:11], s26 offen offset:2048
    s_waitcnt vmcnt(18)
    s_waitcnt lgkmcnt(5)
    v_mfma_f32_16x16x32_bf16 v[40:43], v[168:171], a[112:115], v[40:43]
    ds_read_b128 v[192:195], v6 offset:14336
    ds_read_b128 v[196:199], v6 offset:15360
    v_mfma_f32_16x16x32_bf16 v[44:47], v[172:175], a[112:115], v[44:47]
    s_and_b32 s65, s65, 7
    s_cmp_lt_u32 s47, 8
    s_cselect_b32 s65, s65, 8
    v_mfma_f32_16x16x32_bf16 v[48:51], v[168:171], a[116:119], v[48:51]
    s_cmp_lt_u32 s65, 2
    s_cselect_b32 s47, 2, 7
    s_cselect_b32 s44, 254, 0
    v_mfma_f32_16x16x32_bf16 v[52:55], v[172:175], a[116:119], v[52:55]
    s_add_u32 s65, s65, s44
    s_lshl_b32 s50, s50, 2
    v_mfma_f32_16x16x32_bf16 v[56:59], v[168:171], a[120:123], v[56:59]
    buffer_load_dwordx4 a[164:167], v3, s[8:11], s27 offen offset:2048
    v_mfma_f32_16x16x32_bf16 v[60:63], v[172:175], a[120:123], v[60:63]
    s_add_u32 s50, s50, s76
    s_mul_i32 s50, s50, 324
    v_mfma_f32_16x16x32_bf16 v[64:67], v[168:171], a[124:127], v[64:67]
    s_add_u32 s65, s65, s50
    s_mul_i32 s50, s63, s47
    v_mfma_f32_16x16x32_bf16 v[68:71], v[172:175], a[124:127], v[68:71]
    s_add_u32 s50, s50, s65
    s_lshl_b32 s50, s50, 10
    s_waitcnt vmcnt(15)
    s_barrier
    s_waitcnt lgkmcnt(4)
    v_mfma_f32_16x16x32_bf16 v[72:75], v[176:179], a[112:115], v[72:75]
    ds_read_b128 v[168:171], v3 offset:16384
    ds_read_b128 v[172:175], v3 offset:17408
    v_mfma_f32_16x16x32_bf16 v[76:79], v[180:183], a[112:115], v[76:79]
    buffer_load_dwordx4 a[168:171], v3, s[8:11], s28 offen offset:2048
    v_mfma_f32_16x16x32_bf16 v[80:83], v[176:179], a[116:119], v[80:83]
    s_waitcnt vmcnt(13)
    s_mov_b64 exec, 1
    v_mov_b32 v247, 1
    buffer_atomic_add v247, v246, s[8:11], s67 offen offset:0
    s_mov_b64 exec, -1
    v_mfma_f32_16x16x32_bf16 v[84:87], v[180:183], a[116:119], v[84:87]
    s_add_u32 s74, s50, 67106816
    s_mul_i32 s50, s64, s47
    v_mfma_f32_16x16x32_bf16 v[88:91], v[176:179], a[120:123], v[88:91]
    s_add_u32 s50, s50, s65
    s_lshl_b32 s50, s50, 10
    v_mfma_f32_16x16x32_bf16 v[92:95], v[180:183], a[120:123], v[92:95]
    buffer_load_dwordx4 a[172:175], v3, s[8:11], s29 offen offset:2048
    v_mfma_f32_16x16x32_bf16 v[96:99], v[176:179], a[124:127], v[96:99]
    s_add_u32 s75, s50, 67106816
    v_mfma_f32_16x16x32_bf16 v[100:103], v[180:183], a[124:127], v[100:103]
    s_lshl_b32 s47, s49, 2
    s_add_u32 s47, s47, 1
    s_waitcnt lgkmcnt(4)
    v_mfma_f32_16x16x32_bf16 v[104:107], v[184:187], a[112:115], v[104:107]
    ds_read_b128 v[176:179], v4 offset:16384
    ds_read_b128 v[180:183], v4 offset:17408
    v_mfma_f32_16x16x32_bf16 v[108:111], v[188:191], a[112:115], v[108:111]
    s_mul_i32 s50, s47, 57
    s_lshr_b32 s50, s50, 9
    v_mfma_f32_16x16x32_bf16 v[112:115], v[184:187], a[116:119], v[112:115]
    buffer_load_dwordx4 a[176:179], v3, s[8:11], s26 offen offset:3072
    v_mfma_f32_16x16x32_bf16 v[116:119], v[188:191], a[116:119], v[116:119]
    s_mul_i32 s65, s50, 9
    s_sub_u32 s47, s47, s65
    v_mfma_f32_16x16x32_bf16 v[120:123], v[184:187], a[120:123], v[120:123]
    s_and_b32 s65, s50, 1
    s_sub_u32 s47, s47, s65
    v_mfma_f32_16x16x32_bf16 v[124:127], v[188:191], a[120:123], v[124:127]
    s_lshl_b32 s65, s76, 1
    s_sub_u32 s65, s47, s65
    v_mfma_f32_16x16x32_bf16 v[128:131], v[184:187], a[124:127], v[128:131]
    buffer_load_dwordx4 a[180:183], v3, s[8:11], s27 offen offset:3072
    v_mfma_f32_16x16x32_bf16 v[132:135], v[188:191], a[124:127], v[132:135]
    s_and_b32 s65, s65, 7
    s_cmp_lt_u32 s47, 8
    s_cselect_b32 s65, s65, 8
    s_waitcnt lgkmcnt(4)
    v_mfma_f32_16x16x32_bf16 v[136:139], v[192:195], a[112:115], v[136:139]
    ds_read_b128 v[184:187], v5 offset:16384
    ds_read_b128 v[188:191], v5 offset:17408
    v_mfma_f32_16x16x32_bf16 v[140:143], v[196:199], a[112:115], v[140:143]
    s_cmp_lt_u32 s65, 2
    s_cselect_b32 s47, 2, 7
    s_cselect_b32 s44, 254, 0
    v_mfma_f32_16x16x32_bf16 v[144:147], v[192:195], a[116:119], v[144:147]
    s_add_u32 s65, s65, s44
    s_lshl_b32 s50, s50, 2
    v_mfma_f32_16x16x32_bf16 v[148:151], v[196:199], a[116:119], v[148:151]
    buffer_load_dwordx4 a[184:187], v3, s[8:11], s28 offen offset:3072
    v_mfma_f32_16x16x32_bf16 v[152:155], v[192:195], a[120:123], v[152:155]
    s_add_u32 s50, s50, s76
    s_mul_i32 s50, s50, 324
    v_mfma_f32_16x16x32_bf16 v[156:159], v[196:199], a[120:123], v[156:159]
    s_add_u32 s65, s65, s50
    s_mul_i32 s50, s63, s47
    v_mfma_f32_16x16x32_bf16 v[160:163], v[192:195], a[124:127], v[160:163]
    s_add_u32 s50, s50, s65
    s_lshl_b32 s50, s50, 10
    v_mfma_f32_16x16x32_bf16 v[164:167], v[196:199], a[124:127], v[164:167]
    buffer_load_dwordx4 a[188:191], v3, s[8:11], s29 offen offset:3072
    s_waitcnt vmcnt(17)
    s_waitcnt lgkmcnt(4)
    v_mfma_f32_16x16x32_bf16 v[40:43], v[168:171], a[128:131], v[40:43]
    ds_read_b128 v[192:195], v6 offset:16384
    ds_read_b128 v[196:199], v6 offset:17408
    v_mfma_f32_16x16x32_bf16 v[44:47], v[172:175], a[128:131], v[44:47]
    s_add_u32 s77, s50, 67106816
    s_mul_i32 s50, s64, s47
    v_mfma_f32_16x16x32_bf16 v[48:51], v[168:171], a[132:135], v[48:51]
    s_add_u32 s50, s50, s65
    s_lshl_b32 s50, s50, 10
    v_mfma_f32_16x16x32_bf16 v[52:55], v[172:175], a[132:135], v[52:55]
    s_add_u32 s78, s50, 67106816
    v_mfma_f32_16x16x32_bf16 v[56:59], v[168:171], a[136:139], v[56:59]
    s_add_u32 m0, s99, 24576
    s_add_u32 s101, s100, 24576
    buffer_load_dwordx4 v3, s[12:15], s101 offen offset:0 lds
    v_mfma_f32_16x16x32_bf16 v[60:63], v[172:175], a[136:139], v[60:63]
    s_lshl_b32 s47, s49, 2
    s_add_u32 s47, s47, 2
    v_mfma_f32_16x16x32_bf16 v[64:67], v[168:171], a[140:143], v[64:67]
    s_mul_i32 s50, s47, 57
    s_lshr_b32 s50, s50, 9
    v_mfma_f32_16x16x32_bf16 v[68:71], v[172:175], a[140:143], v[68:71]
    s_mul_i32 s65, s50, 9
    s_sub_u32 s47, s47, s65
    s_waitcnt lgkmcnt(4)
    v_mfma_f32_16x16x32_bf16 v[72:75], v[176:179], a[128:131], v[72:75]
    ds_read_b128 v[168:171], v3 offset:18432
    ds_read_b128 v[172:175], v3 offset:19456
    v_mfma_f32_16x16x32_bf16 v[76:79], v[180:183], a[128:131], v[76:79]
    buffer_load_dwordx4 v3, s[12:15], s101 offen offset:1024 lds
    v_mfma_f32_16x16x32_bf16 v[80:83], v[176:179], a[132:135], v[80:83]
    s_and_b32 s65, s50, 1
    s_sub_u32 s47, s47, s65
    v_mfma_f32_16x16x32_bf16 v[84:87], v[180:183], a[132:135], v[84:87]
    s_lshl_b32 s65, s76, 1
    s_sub_u32 s65, s47, s65
    v_mfma_f32_16x16x32_bf16 v[88:91], v[176:179], a[136:139], v[88:91]
    s_and_b32 s65, s65, 7
    s_cmp_lt_u32 s47, 8
    s_cselect_b32 s65, s65, 8
    v_mfma_f32_16x16x32_bf16 v[92:95], v[180:183], a[136:139], v[92:95]
    buffer_load_dwordx4 v3, s[12:15], s101 offen offset:2048 lds
    v_mfma_f32_16x16x32_bf16 v[96:99], v[176:179], a[140:143], v[96:99]
    s_cmp_lt_u32 s65, 2
    s_cselect_b32 s47, 2, 7
    s_cselect_b32 s44, 254, 0
    v_mfma_f32_16x16x32_bf16 v[100:103], v[180:183], a[140:143], v[100:103]
    s_add_u32 s65, s65, s44
    s_lshl_b32 s50, s50, 2
    s_waitcnt lgkmcnt(4)
    v_mfma_f32_16x16x32_bf16 v[104:107], v[184:187], a[128:131], v[104:107]
    ds_read_b128 v[176:179], v4 offset:18432
    ds_read_b128 v[180:183], v4 offset:19456
    v_mfma_f32_16x16x32_bf16 v[108:111], v[188:191], a[128:131], v[108:111]
    s_add_u32 s50, s50, s76
    s_mul_i32 s50, s50, 324
    v_mfma_f32_16x16x32_bf16 v[112:115], v[184:187], a[132:135], v[112:115]
    buffer_load_dwordx4 v3, s[12:15], s101 offen offset:3072 lds
    v_mfma_f32_16x16x32_bf16 v[116:119], v[188:191], a[132:135], v[116:119]
    s_add_u32 s65, s65, s50
    s_mul_i32 s50, s63, s47
    v_mfma_f32_16x16x32_bf16 v[120:123], v[184:187], a[136:139], v[120:123]
    s_add_u32 s50, s50, s65
    s_lshl_b32 s50, s50, 10
    v_mfma_f32_16x16x32_bf16 v[124:127], v[188:191], a[136:139], v[124:127]
    s_add_u32 s79, s50, 67106816
    s_mul_i32 s50, s64, s47
    v_mfma_f32_16x16x32_bf16 v[128:131], v[184:187], a[140:143], v[128:131]
    s_add_u32 s26, s26, 4096
    buffer_load_dwordx4 a[192:195], v3, s[8:11], s26 offen offset:0
    v_mfma_f32_16x16x32_bf16 v[132:135], v[188:191], a[140:143], v[132:135]
    s_add_u32 s50, s50, s65
    s_lshl_b32 s50, s50, 10
    s_waitcnt lgkmcnt(4)
    v_mfma_f32_16x16x32_bf16 v[136:139], v[192:195], a[128:131], v[136:139]
    ds_read_b128 v[184:187], v5 offset:18432
    ds_read_b128 v[188:191], v5 offset:19456
    v_mfma_f32_16x16x32_bf16 v[140:143], v[196:199], a[128:131], v[140:143]
    s_add_u32 s80, s50, 67106816
    v_mfma_f32_16x16x32_bf16 v[144:147], v[192:195], a[132:135], v[144:147]
    s_lshl_b32 s47, s49, 2
    s_add_u32 s47, s47, 3
    v_mfma_f32_16x16x32_bf16 v[148:151], v[196:199], a[132:135], v[148:151]
    s_add_u32 s27, s27, 4096
    buffer_load_dwordx4 a[196:199], v3, s[8:11], s27 offen offset:0
    v_mfma_f32_16x16x32_bf16 v[152:155], v[192:195], a[136:139], v[152:155]
    s_mul_i32 s50, s47, 57
    s_lshr_b32 s50, s50, 9
    v_mfma_f32_16x16x32_bf16 v[156:159], v[196:199], a[136:139], v[156:159]
    s_mul_i32 s65, s50, 9
    s_sub_u32 s47, s47, s65
    v_mfma_f32_16x16x32_bf16 v[160:163], v[192:195], a[140:143], v[160:163]
    s_and_b32 s65, s50, 1
    s_sub_u32 s47, s47, s65
    v_mfma_f32_16x16x32_bf16 v[164:167], v[196:199], a[140:143], v[164:167]
    s_add_u32 s28, s28, 4096
    buffer_load_dwordx4 a[200:203], v3, s[8:11], s28 offen offset:0
    s_waitcnt vmcnt(20)
    s_waitcnt lgkmcnt(4)
    v_mfma_f32_16x16x32_bf16 v[40:43], v[168:171], a[144:147], v[40:43]
    ds_read_b128 v[192:195], v6 offset:18432
    ds_read_b128 v[196:199], v6 offset:19456
    v_mfma_f32_16x16x32_bf16 v[44:47], v[172:175], a[144:147], v[44:47]
    s_lshl_b32 s65, s76, 1
    s_sub_u32 s65, s47, s65
    v_mfma_f32_16x16x32_bf16 v[48:51], v[168:171], a[148:151], v[48:51]
    s_and_b32 s65, s65, 7
    s_cmp_lt_u32 s47, 8
    s_cselect_b32 s65, s65, 8
    v_mfma_f32_16x16x32_bf16 v[52:55], v[172:175], a[148:151], v[52:55]
    s_cmp_lt_u32 s65, 2
    s_cselect_b32 s47, 2, 7
    s_cselect_b32 s44, 254, 0
    v_mfma_f32_16x16x32_bf16 v[56:59], v[168:171], a[152:155], v[56:59]
    s_add_u32 s29, s29, 4096
    buffer_load_dwordx4 a[204:207], v3, s[8:11], s29 offen offset:0
    v_mfma_f32_16x16x32_bf16 v[60:63], v[172:175], a[152:155], v[60:63]
    s_add_u32 s65, s65, s44
    s_lshl_b32 s50, s50, 2
    v_mfma_f32_16x16x32_bf16 v[64:67], v[168:171], a[156:159], v[64:67]
    s_add_u32 s50, s50, s76
    s_mul_i32 s50, s50, 324
    v_mfma_f32_16x16x32_bf16 v[68:71], v[172:175], a[156:159], v[68:71]
    s_add_u32 s65, s65, s50
    s_mul_i32 s50, s63, s47
    s_waitcnt vmcnt(17)
    s_barrier
    s_waitcnt lgkmcnt(4)
    v_mfma_f32_16x16x32_bf16 v[72:75], v[176:179], a[144:147], v[72:75]
    ds_read_b128 v[168:171], v3 offset:20480
    ds_read_b128 v[172:175], v3 offset:21504
    v_mfma_f32_16x16x32_bf16 v[76:79], v[180:183], a[144:147], v[76:79]
    buffer_load_dwordx4 a[208:211], v3, s[8:11], s26 offen offset:1024
    v_mfma_f32_16x16x32_bf16 v[80:83], v[176:179], a[148:151], v[80:83]
    s_add_u32 s50, s50, s65
    s_lshl_b32 s50, s50, 10
    v_mfma_f32_16x16x32_bf16 v[84:87], v[180:183], a[148:151], v[84:87]
    s_add_u32 s45, s50, 67106816
    s_mul_i32 s50, s64, s47
    v_mfma_f32_16x16x32_bf16 v[88:91], v[176:179], a[152:155], v[88:91]
    s_add_u32 s50, s50, s65
    s_lshl_b32 s50, s50, 10
    v_mfma_f32_16x16x32_bf16 v[92:95], v[180:183], a[152:155], v[92:95]
    buffer_load_dwordx4 a[212:215], v3, s[8:11], s27 offen offset:1024
    v_mfma_f32_16x16x32_bf16 v[96:99], v[176:179], a[156:159], v[96:99]
    s_add_u32 s46, s50, 67106816
    v_mfma_f32_16x16x32_bf16 v[100:103], v[180:183], a[156:159], v[100:103]
    s_mul_i32 s76, s76, 9
    s_add_u32 s76, s76, s49
    s_waitcnt lgkmcnt(4)
    v_mfma_f32_16x16x32_bf16 v[104:107], v[184:187], a[144:147], v[104:107]
    ds_read_b128 v[176:179], v4 offset:20480
    ds_read_b128 v[180:183], v4 offset:21504
    v_mfma_f32_16x16x32_bf16 v[108:111], v[188:191], a[144:147], v[108:111]
    s_lshl_b32 s76, s76, 7
    s_add_u32 s76, s76, 13778944
    v_mfma_f32_16x16x32_bf16 v[112:115], v[184:187], a[148:151], v[112:115]
    buffer_load_dwordx4 a[216:219], v3, s[8:11], s28 offen offset:1024
    v_mfma_f32_16x16x32_bf16 v[116:119], v[188:191], a[148:151], v[116:119]
    s_lshr_b32 s81, s55, 1
    s_lshl_b32 s81, s81, 7
    v_mfma_f32_16x16x32_bf16 v[120:123], v[184:187], a[152:155], v[120:123]
    s_add_u32 s81, s81, 13787136
    s_lshl_b32 s32, s24, 5
    v_mfma_f32_16x16x32_bf16 v[124:127], v[188:191], a[152:155], v[124:127]
    s_add_u32 s32, s32, 13787136
    s_lshl_b32 s33, s24, 7
    v_mfma_f32_16x16x32_bf16 v[128:131], v[184:187], a[156:159], v[128:131]
    buffer_load_dwordx4 a[220:223], v3, s[8:11], s29 offen offset:1024
    v_mfma_f32_16x16x32_bf16 v[132:135], v[188:191], a[156:159], v[132:135]
    s_add_u32 s33, s33, 13631488
    s_waitcnt lgkmcnt(4)
    v_mfma_f32_16x16x32_bf16 v[136:139], v[192:195], a[144:147], v[136:139]
    ds_read_b128 v[184:187], v5 offset:20480
    ds_read_b128 v[188:191], v5 offset:21504
    v_mfma_f32_16x16x32_bf16 v[140:143], v[196:199], a[144:147], v[140:143]
    s_lshl_b32 s51, s55, 2
    s_add_u32 s51, s51, s54
    v_mfma_f32_16x16x32_bf16 v[144:147], v[192:195], a[148:151], v[144:147]
    s_lshl_b32 s51, s51, 7
    s_add_u32 s51, s51, 13795328
    v_mfma_f32_16x16x32_bf16 v[148:151], v[196:199], a[148:151], v[148:151]
    s_add_u32 m0, s99, 28672
    s_add_u32 s101, s100, 28672
    buffer_load_dwordx4 v3, s[12:15], s101 offen offset:0 lds
    v_mfma_f32_16x16x32_bf16 v[152:155], v[192:195], a[152:155], v[152:155]
    v_lshrrev_b32 v229, 3, v1
    v_mul_u32_u24 v228, 1152, v229
    v_mfma_f32_16x16x32_bf16 v[156:159], v[196:199], a[152:155], v[156:159]
    v_and_b32 v230, 7, v1
    v_and_b32 v229, 6, v229
    v_mfma_f32_16x16x32_bf16 v[160:163], v[192:195], a[156:159], v[160:163]
    v_xor_b32 v230, v230, v229
    v_lshl_add_u32 v245, v230, 4, v228
    v_mfma_f32_16x16x32_bf16 v[164:167], v[196:199], a[156:159], v[164:167]
    buffer_load_dwordx4 v3, s[12:15], s101 offen offset:1024 lds
    s_waitcnt vmcnt(18)
    s_waitcnt lgkmcnt(4)
    v_mfma_f32_16x16x32_bf16 v[40:43], v[168:171], a[160:163], v[40:43]
    ds_read_b128 v[192:195], v6 offset:20480
    ds_read_b128 v[196:199], v6 offset:21504
    v_mfma_f32_16x16x32_bf16 v[44:47], v[172:175], a[160:163], v[44:47]
    v_and_b32 v244, 15, v1
    v_lshlrev_b32 v244, 3, v244
    v_mfma_f32_16x16x32_bf16 v[48:51], v[168:171], a[164:167], v[48:51]
    ds_read_b128 v[204:207], v233 offset:0
    v_mfma_f32_16x16x32_bf16 v[52:55], v[172:175], a[164:167], v[52:55]
    ds_read_b128 v[208:211], v233 offset:1152
    v_mfma_f32_16x16x32_bf16 v[56:59], v[168:171], a[168:171], v[56:59]
    buffer_load_dwordx4 v3, s[12:15], s101 offen offset:2048 lds
    v_mfma_f32_16x16x32_bf16 v[60:63], v[172:175], a[168:171], v[60:63]
    ds_read_b128 v[212:215], v233 offset:2304
    v_mfma_f32_16x16x32_bf16 v[64:67], v[168:171], a[172:175], v[64:67]
    v_mfma_f32_16x16x32_bf16 v[68:71], v[172:175], a[172:175], v[68:71]
    s_waitcnt lgkmcnt(7)
    v_mfma_f32_16x16x32_bf16 v[72:75], v[176:179], a[160:163], v[72:75]
    ds_read_b128 v[168:171], v3 offset:22528
    ds_read_b128 v[172:175], v3 offset:23552
    v_mfma_f32_16x16x32_bf16 v[76:79], v[180:183], a[160:163], v[76:79]
    buffer_load_dwordx4 v3, s[12:15], s101 offen offset:3072 lds
    v_mfma_f32_16x16x32_bf16 v[80:83], v[176:179], a[164:167], v[80:83]
    v_mfma_f32_16x16x32_bf16 v[84:87], v[180:183], a[164:167], v[84:87]
    v_mfma_f32_16x16x32_bf16 v[88:91], v[176:179], a[168:171], v[88:91]
    v_mfma_f32_16x16x32_bf16 v[92:95], v[180:183], a[168:171], v[92:95]
    buffer_load_dwordx4 a[224:227], v3, s[8:11], s26 offen offset:2048
    v_mfma_f32_16x16x32_bf16 v[96:99], v[176:179], a[172:175], v[96:99]
    v_mfma_f32_16x16x32_bf16 v[100:103], v[180:183], a[172:175], v[100:103]
    s_waitcnt lgkmcnt(2)
    v_add_f32 v204, v204, v208
    v_mfma_f32_16x16x32_bf16 v[104:107], v[184:187], a[160:163], v[104:107]
    ds_read_b128 v[176:179], v4 offset:22528
    ds_read_b128 v[180:183], v4 offset:23552
    v_mfma_f32_16x16x32_bf16 v[108:111], v[188:191], a[160:163], v[108:111]
    v_add_f32 v205, v205, v209
    v_mfma_f32_16x16x32_bf16 v[112:115], v[184:187], a[164:167], v[112:115]
    buffer_load_dwordx4 a[228:231], v3, s[8:11], s27 offen offset:2048
    v_mfma_f32_16x16x32_bf16 v[116:119], v[188:191], a[164:167], v[116:119]
    v_add_f32 v206, v206, v210
    v_mfma_f32_16x16x32_bf16 v[120:123], v[184:187], a[168:171], v[120:123]
    v_add_f32 v207, v207, v211
    v_mfma_f32_16x16x32_bf16 v[124:127], v[188:191], a[168:171], v[124:127]
    v_add_f32 v204, v204, v212
    v_mfma_f32_16x16x32_bf16 v[128:131], v[184:187], a[172:175], v[128:131]
    buffer_load_dwordx4 a[232:235], v3, s[8:11], s28 offen offset:2048
    v_mfma_f32_16x16x32_bf16 v[132:135], v[188:191], a[172:175], v[132:135]
    v_add_f32 v205, v205, v213
    v_mfma_f32_16x16x32_bf16 v[136:139], v[192:195], a[160:163], v[136:139]
    ds_read_b128 v[184:187], v5 offset:22528
    ds_read_b128 v[188:191], v5 offset:23552
    v_mfma_f32_16x16x32_bf16 v[140:143], v[196:199], a[160:163], v[140:143]
    v_add_f32 v206, v206, v214
    v_mfma_f32_16x16x32_bf16 v[144:147], v[192:195], a[164:167], v[144:147]
    v_add_f32 v207, v207, v215
    v_mfma_f32_16x16x32_bf16 v[148:151], v[196:199], a[164:167], v[148:151]
    buffer_load_dwordx4 a[236:239], v3, s[8:11], s29 offen offset:2048
    v_mfma_f32_16x16x32_bf16 v[152:155], v[192:195], a[168:171], v[152:155]
    ds_write_b128 v235, v[204:207]
    v_mfma_f32_16x16x32_bf16 v[156:159], v[196:199], a[168:171], v[156:159]
    v_mfma_f32_16x16x32_bf16 v[160:163], v[192:195], a[172:175], v[160:163]
    v_mfma_f32_16x16x32_bf16 v[164:167], v[196:199], a[172:175], v[164:167]
    buffer_load_dwordx4 a[240:243], v3, s[8:11], s26 offen offset:3072
    s_waitcnt vmcnt(21)
    s_waitcnt lgkmcnt(5)
    v_mfma_f32_16x16x32_bf16 v[40:43], v[168:171], a[176:179], v[40:43]
    ds_read_b128 v[192:195], v6 offset:22528
    ds_read_b128 v[196:199], v6 offset:23552
    v_mfma_f32_16x16x32_bf16 v[44:47], v[172:175], a[176:179], v[44:47]
    v_mfma_f32_16x16x32_bf16 v[48:51], v[168:171], a[180:183], v[48:51]
    v_mfma_f32_16x16x32_bf16 v[52:55], v[172:175], a[180:183], v[52:55]
    v_mfma_f32_16x16x32_bf16 v[56:59], v[168:171], a[184:187], v[56:59]
    buffer_load_dwordx4 a[244:247], v3, s[8:11], s27 offen offset:3072
    v_mfma_f32_16x16x32_bf16 v[60:63], v[172:175], a[184:187], v[60:63]
    v_mfma_f32_16x16x32_bf16 v[64:67], v[168:171], a[188:191], v[64:67]
    v_mfma_f32_16x16x32_bf16 v[68:71], v[172:175], a[188:191], v[68:71]
    s_waitcnt vmcnt(18)
    s_barrier
    s_waitcnt lgkmcnt(5)
    v_mfma_f32_16x16x32_bf16 v[72:75], v[176:179], a[176:179], v[72:75]
    ds_read_b128 v[168:171], v3 offset:24576
    ds_read_b128 v[172:175], v3 offset:25600
    v_mfma_f32_16x16x32_bf16 v[76:79], v[180:183], a[176:179], v[76:79]
    buffer_load_dwordx4 a[248:251], v3, s[8:11], s28 offen offset:3072
    v_mfma_f32_16x16x32_bf16 v[80:83], v[176:179], a[180:183], v[80:83]
    v_mfma_f32_16x16x32_bf16 v[84:87], v[180:183], a[180:183], v[84:87]
    v_mfma_f32_16x16x32_bf16 v[88:91], v[176:179], a[184:187], v[88:91]
    v_mfma_f32_16x16x32_bf16 v[92:95], v[180:183], a[184:187], v[92:95]
    buffer_load_dwordx4 a[252:255], v3, s[8:11], s29 offen offset:3072
    v_mfma_f32_16x16x32_bf16 v[96:99], v[176:179], a[188:191], v[96:99]
    v_mfma_f32_16x16x32_bf16 v[100:103], v[180:183], a[188:191], v[100:103]
    s_waitcnt lgkmcnt(5)
    v_mfma_f32_16x16x32_bf16 v[104:107], v[184:187], a[176:179], v[104:107]
    ds_read_b128 v[176:179], v4 offset:24576
    ds_read_b128 v[180:183], v4 offset:25600
    v_mfma_f32_16x16x32_bf16 v[108:111], v[188:191], a[176:179], v[108:111]
    v_mfma_f32_16x16x32_bf16 v[112:115], v[184:187], a[180:183], v[112:115]
    buffer_load_dword v248, v246, s[8:11], s32 offen offset:0 sc1
    v_mfma_f32_16x16x32_bf16 v[116:119], v[188:191], a[180:183], v[116:119]
    v_mfma_f32_16x16x32_bf16 v[120:123], v[184:187], a[184:187], v[120:123]
    v_mfma_f32_16x16x32_bf16 v[124:127], v[188:191], a[184:187], v[124:127]
    v_mfma_f32_16x16x32_bf16 v[128:131], v[184:187], a[188:191], v[128:131]
    s_add_u32 m0, s99, 32768
    s_add_u32 s101, s100, 32768
    buffer_load_dwordx4 v3, s[12:15], s101 offen offset:0 lds
    v_mfma_f32_16x16x32_bf16 v[132:135], v[188:191], a[188:191], v[132:135]
    s_waitcnt lgkmcnt(4)
    v_mfma_f32_16x16x32_bf16 v[136:139], v[192:195], a[176:179], v[136:139]
    ds_read_b128 v[184:187], v5 offset:24576
    ds_read_b128 v[188:191], v5 offset:25600
    v_mfma_f32_16x16x32_bf16 v[140:143], v[196:199], a[176:179], v[140:143]
    v_mfma_f32_16x16x32_bf16 v[144:147], v[192:195], a[180:183], v[144:147]
    v_mfma_f32_16x16x32_bf16 v[148:151], v[196:199], a[180:183], v[148:151]
    buffer_load_dwordx4 v3, s[12:15], s101 offen offset:1024 lds
    v_mfma_f32_16x16x32_bf16 v[152:155], v[192:195], a[184:187], v[152:155]
    v_mfma_f32_16x16x32_bf16 v[156:159], v[196:199], a[184:187], v[156:159]
    v_mfma_f32_16x16x32_bf16 v[160:163], v[192:195], a[188:191], v[160:163]
    v_mfma_f32_16x16x32_bf16 v[164:167], v[196:199], a[188:191], v[164:167]
    buffer_load_dwordx4 v3, s[12:15], s101 offen offset:2048 lds
    s_waitcnt vmcnt(20)
    s_waitcnt lgkmcnt(4)
    v_mfma_f32_16x16x32_bf16 v[40:43], v[168:171], a[192:195], v[40:43]
    ds_read_b128 v[192:195], v6 offset:24576
    ds_read_b128 v[196:199], v6 offset:25600
    v_mfma_f32_16x16x32_bf16 v[44:47], v[172:175], a[192:195], v[44:47]
    v_mfma_f32_16x16x32_bf16 v[48:51], v[168:171], a[196:199], v[48:51]
    v_mfma_f32_16x16x32_bf16 v[52:55], v[172:175], a[196:199], v[52:55]
    v_mfma_f32_16x16x32_bf16 v[56:59], v[168:171], a[200:203], v[56:59]
    buffer_load_dwordx4 v3, s[12:15], s101 offen offset:3072 lds
    v_mfma_f32_16x16x32_bf16 v[60:63], v[172:175], a[200:203], v[60:63]
    v_mfma_f32_16x16x32_bf16 v[64:67], v[168:171], a[204:207], v[64:67]
    v_mfma_f32_16x16x32_bf16 v[68:71], v[172:175], a[204:207], v[68:71]
    s_waitcnt lgkmcnt(4)
    v_mfma_f32_16x16x32_bf16 v[72:75], v[176:179], a[192:195], v[72:75]
    ds_read_b128 v[168:171], v3 offset:26624
    ds_read_b128 v[172:175], v3 offset:27648
    v_mfma_f32_16x16x32_bf16 v[76:79], v[180:183], a[192:195], v[76:79]
    s_add_u32 s26, s26, 4096
    buffer_load_dwordx4 v[8:11], v3, s[8:11], s26 offen offset:0
    v_mfma_f32_16x16x32_bf16 v[80:83], v[176:179], a[196:199], v[80:83]
    v_mfma_f32_16x16x32_bf16 v[84:87], v[180:183], a[196:199], v[84:87]
    v_mfma_f32_16x16x32_bf16 v[88:91], v[176:179], a[200:203], v[88:91]
    v_mfma_f32_16x16x32_bf16 v[92:95], v[180:183], a[200:203], v[92:95]
    s_add_u32 s27, s27, 4096
    buffer_load_dwordx4 v[12:15], v3, s[8:11], s27 offen offset:0
    v_mfma_f32_16x16x32_bf16 v[96:99], v[176:179], a[204:207], v[96:99]
    v_mfma_f32_16x16x32_bf16 v[100:103], v[180:183], a[204:207], v[100:103]
    s_waitcnt lgkmcnt(4)
    v_mfma_f32_16x16x32_bf16 v[104:107], v[184:187], a[192:195], v[104:107]
    ds_read_b128 v[176:179], v4 offset:26624
    ds_read_b128 v[180:183], v4 offset:27648
    v_mfma_f32_16x16x32_bf16 v[108:111], v[188:191], a[192:195], v[108:111]
    v_mfma_f32_16x16x32_bf16 v[112:115], v[184:187], a[196:199], v[112:115]
    s_add_u32 s28, s28, 4096
    buffer_load_dwordx4 v[16:19], v3, s[8:11], s28 offen offset:0
    v_mfma_f32_16x16x32_bf16 v[116:119], v[188:191], a[196:199], v[116:119]
    v_mfma_f32_16x16x32_bf16 v[120:123], v[184:187], a[200:203], v[120:123]
    v_mfma_f32_16x16x32_bf16 v[124:127], v[188:191], a[200:203], v[124:127]
    v_mfma_f32_16x16x32_bf16 v[128:131], v[184:187], a[204:207], v[128:131]
    s_add_u32 s29, s29, 4096
    buffer_load_dwordx4 v[20:23], v3, s[8:11], s29 offen offset:0
    v_mfma_f32_16x16x32_bf16 v[132:135], v[188:191], a[204:207], v[132:135]
    s_waitcnt lgkmcnt(4)
    v_mfma_f32_16x16x32_bf16 v[136:139], v[192:195], a[192:195], v[136:139]
    ds_read_b128 v[184:187], v5 offset:26624
    ds_read_b128 v[188:191], v5 offset:27648
    v_mfma_f32_16x16x32_bf16 v[140:143], v[196:199], a[192:195], v[140:143]
    v_mfma_f32_16x16x32_bf16 v[144:147], v[192:195], a[196:199], v[144:147]
    v_mfma_f32_16x16x32_bf16 v[148:151], v[196:199], a[196:199], v[148:151]
    buffer_load_dwordx4 v[24:27], v3, s[8:11], s26 offen offset:1024
    v_mfma_f32_16x16x32_bf16 v[152:155], v[192:195], a[200:203], v[152:155]
    v_mfma_f32_16x16x32_bf16 v[156:159], v[196:199], a[200:203], v[156:159]
    v_mfma_f32_16x16x32_bf16 v[160:163], v[192:195], a[204:207], v[160:163]
    v_mfma_f32_16x16x32_bf16 v[164:167], v[196:199], a[204:207], v[164:167]
    buffer_load_dwordx4 v[28:31], v3, s[8:11], s27 offen offset:1024
    s_waitcnt vmcnt(23)
    s_waitcnt lgkmcnt(4)
    v_mfma_f32_16x16x32_bf16 v[40:43], v[168:171], a[208:211], v[40:43]
    ds_read_b128 v[192:195], v6 offset:26624
    ds_read_b128 v[196:199], v6 offset:27648
    v_mfma_f32_16x16x32_bf16 v[44:47], v[172:175], a[208:211], v[44:47]
    v_mfma_f32_16x16x32_bf16 v[48:51], v[168:171], a[212:215], v[48:51]
    v_mfma_f32_16x16x32_bf16 v[52:55], v[172:175], a[212:215], v[52:55]
    v_mfma_f32_16x16x32_bf16 v[56:59], v[168:171], a[216:219], v[56:59]
    buffer_load_dwordx4 v[32:35], v3, s[8:11], s28 offen offset:1024
    v_mfma_f32_16x16x32_bf16 v[60:63], v[172:175], a[216:219], v[60:63]
    v_mfma_f32_16x16x32_bf16 v[64:67], v[168:171], a[220:223], v[64:67]
    v_mfma_f32_16x16x32_bf16 v[68:71], v[172:175], a[220:223], v[68:71]
    s_waitcnt vmcnt(20)
L_pad_k3_kernel_2:
    s_cbranch_execz k3_kernel_end
    s_barrier
    s_waitcnt vmcnt(11)
    v_readfirstlane_b32 s64, v248
    s_nop 0
    s_cmp_ge_u32 s64, 32
    s_cbranch_scc0 k3_kernel_slowM
k3_kernel_backM:
    s_waitcnt lgkmcnt(4)
    v_mfma_f32_16x16x32_bf16 v[72:75], v[176:179], a[208:211], v[72:75]
    ds_read_b128 v[168:171], v3 offset:28672
    ds_read_b128 v[172:175], v3 offset:29696
    v_mfma_f32_16x16x32_bf16 v[76:79], v[180:183], a[208:211], v[76:79]
    buffer_load_dword v252, v244, s[8:11], s33 offen offset:0 sc1
    v_mfma_f32_16x16x32_bf16 v[80:83], v[176:179], a[212:215], v[80:83]
    v_mfma_f32_16x16x32_bf16 v[84:87], v[180:183], a[212:215], v[84:87]
    v_mfma_f32_16x16x32_bf16 v[88:91], v[176:179], a[216:219], v[88:91]
    v_mfma_f32_16x16x32_bf16 v[92:95], v[180:183], a[216:219], v[92:95]
    buffer_load_dword v253, v244, s[8:11], s33 offen offset:128 sc1
    v_mfma_f32_16x16x32_bf16 v[96:99], v[176:179], a[220:223], v[96:99]
    v_mfma_f32_16x16x32_bf16 v[100:103], v[180:183], a[220:223], v[100:103]
    s_waitcnt lgkmcnt(4)
    v_mfma_f32_16x16x32_bf16 v[104:107], v[184:187], a[208:211], v[104:107]
    ds_read_b128 v[176:179], v3 offset:30720
    ds_read_b128 v[180:183], v3 offset:31744
    v_mfma_f32_16x16x32_bf16 v[108:111], v[188:191], a[208:211], v[108:111]
    v_mfma_f32_16x16x32_bf16 v[112:115], v[184:187], a[212:215], v[112:115]
    buffer_load_dword v254, v244, s[8:11], s33 offen offset:256 sc1
    v_mfma_f32_16x16x32_bf16 v[116:119], v[188:191], a[212:215], v[116:119]
    v_mfma_f32_16x16x32_bf16 v[120:123], v[184:187], a[216:219], v[120:123]
    v_mfma_f32_16x16x32_bf16 v[124:127], v[188:191], a[216:219], v[124:127]
    v_mfma_f32_16x16x32_bf16 v[128:131], v[184:187], a[220:223], v[128:131]
    buffer_load_dword v255, v244, s[8:11], s33 offen offset:384 sc1
    v_mfma_f32_16x16x32_bf16 v[132:135], v[188:191], a[220:223], v[132:135]
    buffer_load_dwordx4 v[36:39], v3, s[8:11], s29 offen offset:1024
    s_waitcnt vmcnt(12)
    s_barrier
    s_waitcnt lgkmcnt(4)
    v_mfma_f32_16x16x32_bf16 v[136:139], v[192:195], a[208:211], v[136:139]
    ds_read_b128 v[184:187], v3 offset:32768
    ds_read_b128 v[188:191], v3 offset:33792
    v_mfma_f32_16x16x32_bf16 v[140:143], v[196:199], a[208:211], v[140:143]
    v_mfma_f32_16x16x32_bf16 v[144:147], v[192:195], a[212:215], v[144:147]
    v_mfma_f32_16x16x32_bf16 v[148:151], v[196:199], a[212:215], v[148:151]
    s_add_u32 m0, s72, 0
    s_add_u32 s35, s73, 0
    buffer_load_dwordx4 v245, s[16:19], s35 offen nt lds
    v_mfma_f32_16x16x32_bf16 v[152:155], v[192:195], a[216:219], v[152:155]
    v_mfma_f32_16x16x32_bf16 v[156:159], v[196:199], a[216:219], v[156:159]
    v_mfma_f32_16x16x32_bf16 v[160:163], v[192:195], a[220:223], v[160:163]
    v_mfma_f32_16x16x32_bf16 v[164:167], v[196:199], a[220:223], v[164:167]
    s_add_u32 m0, s72, 1024
    s_add_u32 s35, s73, 9216
    buffer_load_dwordx4 v245, s[16:19], s35 offen nt lds
    s_waitcnt lgkmcnt(4)
    v_mfma_f32_16x16x32_bf16 v[40:43], v[168:171], a[224:227], v[40:43]
    ds_read_b128 v[192:195], v3 offset:34816
    ds_read_b128 v[196:199], v3 offset:35840
    v_mfma_f32_16x16x32_bf16 v[44:47], v[172:175], a[224:227], v[44:47]
    v_mfma_f32_16x16x32_bf16 v[48:51], v[168:171], a[228:231], v[48:51]
    v_mfma_f32_16x16x32_bf16 v[52:55], v[172:175], a[228:231], v[52:55]
    v_mfma_f32_16x16x32_bf16 v[56:59], v[168:171], a[232:235], v[56:59]
    s_add_u32 m0, s72, 2048
    s_add_u32 s35, s73, 18432
    buffer_load_dwordx4 v245, s[16:19], s35 offen nt lds
    v_mfma_f32_16x16x32_bf16 v[60:63], v[172:175], a[232:235], v[60:63]
    v_mfma_f32_16x16x32_bf16 v[64:67], v[168:171], a[236:239], v[64:67]
    v_mfma_f32_16x16x32_bf16 v[68:71], v[172:175], a[236:239], v[68:71]
    s_waitcnt lgkmcnt(0)
    s_barrier
    v_mfma_f32_16x16x32_bf16 v[40:43], v[176:179], a[240:243], v[40:43]
    ds_read_b128 v[168:171], v4 offset:28672
    ds_read_b128 v[172:175], v4 offset:29696
    v_mfma_f32_16x16x32_bf16 v[44:47], v[180:183], a[240:243], v[44:47]
    s_add_u32 m0, s72, 3072
    s_add_u32 s35, s73, 27648
    buffer_load_dwordx4 v245, s[16:19], s35 offen nt lds
    v_mfma_f32_16x16x32_bf16 v[48:51], v[176:179], a[244:247], v[48:51]
    v_mfma_f32_16x16x32_bf16 v[52:55], v[180:183], a[244:247], v[52:55]
    v_mfma_f32_16x16x32_bf16 v[56:59], v[176:179], a[248:251], v[56:59]
    v_mfma_f32_16x16x32_bf16 v[60:63], v[180:183], a[248:251], v[60:63]
    s_add_u32 m0, s72, 4096
    s_add_u32 s35, s73, 36864
    buffer_load_dwordx4 v245, s[16:19], s35 offen nt lds
    v_mfma_f32_16x16x32_bf16 v[64:67], v[176:179], a[252:255], v[64:67]
    v_mfma_f32_16x16x32_bf16 v[68:71], v[180:183], a[252:255], v[68:71]
    s_waitcnt vmcnt(13)
    v_mfma_f32_16x16x32_bf16 v[40:43], v[184:187], v[8:11], v[40:43]
    ds_read_b128 v[176:179], v4 offset:30720
    ds_read_b128 v[180:183], v4 offset:31744
    v_mfma_f32_16x16x32_bf16 v[44:47], v[188:191], v[8:11], v[44:47]
    v_mfma_f32_16x16x32_bf16 v[48:51], v[184:187], v[12:15], v[48:51]
    s_add_u32 m0, s72, 5120
    s_add_u32 s35, s73, 46080
    buffer_load_dwordx4 v245, s[16:19], s35 offen nt lds
    v_mfma_f32_16x16x32_bf16 v[52:55], v[188:191], v[12:15], v[52:55]
    v_mfma_f32_16x16x32_bf16 v[56:59], v[184:187], v[16:19], v[56:59]
    v_mfma_f32_16x16x32_bf16 v[60:63], v[188:191], v[16:19], v[60:63]
    v_mfma_f32_16x16x32_bf16 v[64:67], v[184:187], v[20:23], v[64:67]
    s_add_u32 m0, s72, 6144
    s_add_u32 s35, s73, 55296
    buffer_load_dwordx4 v245, s[16:19], s35 offen nt lds
    v_mfma_f32_16x16x32_bf16 v[68:71], v[188:191], v[20:23], v[68:71]
    s_waitcnt vmcnt(7)
    v_mfma_f32_16x16x32_bf16 v[40:43], v[192:195], v[24:27], v[40:43]
    ds_read_b128 v[184:187], v4 offset:32768
    ds_read_b128 v[188:191], v4 offset:33792
    v_mfma_f32_16x16x32_bf16 v[44:47], v[196:199], v[24:27], v[44:47]
    v_mfma_f32_16x16x32_bf16 v[48:51], v[192:195], v[28:31], v[48:51]
    v_mfma_f32_16x16x32_bf16 v[52:55], v[196:199], v[28:31], v[52:55]
    s_add_u32 m0, s72, 7168
    s_add_u32 s35, s73, 64512
    buffer_load_dwordx4 v245, s[16:19], s35 offen nt lds
    v_mfma_f32_16x16x32_bf16 v[56:59], v[192:195], v[32:35], v[56:59]
    v_mfma_f32_16x16x32_bf16 v[60:63], v[196:199], v[32:35], v[60:63]
    v_mfma_f32_16x16x32_bf16 v[64:67], v[192:195], v[36:39], v[64:67]
    v_mfma_f32_16x16x32_bf16 v[68:71], v[196:199], v[36:39], v[68:71]
    s_add_u32 m0, s30, 0
    s_add_u32 s35, s31, 147456
    buffer_load_dwordx4 v3, s[12:15], s35 offen lds
    s_waitcnt lgkmcnt(4)
    v_mfma_f32_16x16x32_bf16 v[72:75], v[168:171], a[224:227], v[72:75]
    ds_read_b128 v[192:195], v4 offset:34816
    ds_read_b128 v[196:199], v4 offset:35840
    v_mfma_f32_16x16x32_bf16 v[76:79], v[172:175], a[224:227], v[76:79]
    ds_read_b128 v[228:231], v7 offset:0
    ds_read_b128 v[232:235], v7 offset:64
    v_mfma_f32_16x16x32_bf16 v[80:83], v[168:171], a[228:231], v[80:83]
    v_mfma_f32_16x16x32_bf16 v[84:87], v[172:175], a[228:231], v[84:87]
    v_mfma_f32_16x16x32_bf16 v[88:91], v[168:171], a[232:235], v[88:91]
    s_add_u32 m0, s30, 4096
    s_add_u32 s35, s31, 151552
    buffer_load_dwordx4 v3, s[12:15], s35 offen lds
    v_mfma_f32_16x16x32_bf16 v[92:95], v[172:175], a[232:235], v[92:95]
    s_waitcnt lgkmcnt(0)
    v_fma_f32 v216, v252, v228, v40
    v_mfma_f32_16x16x32_bf16 v[96:99], v[168:171], a[236:239], v[96:99]
    v_fma_f32 v217, v252, v229, v41
    v_fma_f32 v218, v252, v230, v42
    v_mfma_f32_16x16x32_bf16 v[100:103], v[172:175], a[236:239], v[100:103]
    v_fma_f32 v219, v252, v231, v43
    v_fma_f32 v220, v252, v232, v44
    v_mfma_f32_16x16x32_bf16 v[72:75], v[176:179], a[240:243], v[72:75]
    ds_read_b128 v[168:171], v5 offset:28672
    ds_read_b128 v[172:175], v5 offset:29696
    v_mfma_f32_16x16x32_bf16 v[76:79], v[180:183], a[240:243], v[76:79]
    s_add_u32 m0, s30, 8192
    s_add_u32 s35, s31, 155648
    buffer_load_dwordx4 v3, s[12:15], s35 offen lds
    v_mfma_f32_16x16x32_bf16 v[80:83], v[176:179], a[244:247], v[80:83]
    v_fma_f32 v221, v252, v233, v45
    v_fma_f32 v222, v252, v234, v46
    v_mfma_f32_16x16x32_bf16 v[84:87], v[180:183], a[244:247], v[84:87]
    v_fma_f32 v223, v252, v235, v47
    v_mul_f32 v224, v216, v220
    v_mfma_f32_16x16x32_bf16 v[88:91], v[176:179], a[248:251], v[88:91]
    v_mul_f32 v225, v217, v221
    v_mul_f32 v226, v218, v222
    v_mfma_f32_16x16x32_bf16 v[92:95], v[180:183], a[248:251], v[92:95]
    s_add_u32 m0, s30, 12288
    s_add_u32 s35, s31, 159744
    buffer_load_dwordx4 v3, s[12:15], s35 offen lds
    v_mfma_f32_16x16x32_bf16 v[96:99], v[176:179], a[252:255], v[96:99]
    v_mul_f32 v227, v219, v223
    v_cvt_pk_bf16_f32 v200, v224, v225
    v_mfma_f32_16x16x32_bf16 v[100:103], v[180:183], a[252:255], v[100:103]
    v_cvt_pk_bf16_f32 v201, v226, v227
    v_fma_f32 v216, v253, v228, v48
    v_mfma_f32_16x16x32_bf16 v[72:75], v[184:187], v[8:11], v[72:75]
    ds_read_b128 v[176:179], v5 offset:30720
    ds_read_b128 v[180:183], v5 offset:31744
    v_mfma_f32_16x16x32_bf16 v[76:79], v[188:191], v[8:11], v[76:79]
    v_fma_f32 v217, v253, v229, v49
    v_fma_f32 v218, v253, v230, v50
    v_mfma_f32_16x16x32_bf16 v[80:83], v[184:187], v[12:15], v[80:83]
    s_add_u32 m0, s30, 16384
    s_add_u32 s35, s31, 163840
    buffer_load_dwordx4 v3, s[12:15], s35 offen lds
    v_mfma_f32_16x16x32_bf16 v[84:87], v[188:191], v[12:15], v[84:87]
    v_fma_f32 v219, v253, v231, v51
    v_fma_f32 v220, v253, v232, v52
    v_mfma_f32_16x16x32_bf16 v[88:91], v[184:187], v[16:19], v[88:91]
    v_fma_f32 v221, v253, v233, v53
    v_fma_f32 v222, v253, v234, v54
    v_mfma_f32_16x16x32_bf16 v[92:95], v[188:191], v[16:19], v[92:95]
    v_fma_f32 v223, v253, v235, v55
    v_mul_f32 v224, v216, v220
    v_mfma_f32_16x16x32_bf16 v[96:99], v[184:187], v[20:23], v[96:99]
    s_add_u32 m0, s30, 20480
    s_add_u32 s35, s31, 167936
    buffer_load_dwordx4 v3, s[12:15], s35 offen lds
    v_mfma_f32_16x16x32_bf16 v[100:103], v[188:191], v[20:23], v[100:103]
    v_mul_f32 v225, v217, v221
    v_mul_f32 v226, v218, v222
    v_mfma_f32_16x16x32_bf16 v[72:75], v[192:195], v[24:27], v[72:75]
    ds_read_b128 v[184:187], v5 offset:32768
    ds_read_b128 v[188:191], v5 offset:33792
    v_mfma_f32_16x16x32_bf16 v[76:79], v[196:199], v[24:27], v[76:79]
    v_mul_f32 v227, v219, v223
    v_cvt_pk_bf16_f32 v204, v224, v225
    v_mfma_f32_16x16x32_bf16 v[80:83], v[192:195], v[28:31], v[80:83]
    v_cvt_pk_bf16_f32 v205, v226, v227
    v_fma_f32 v216, v254, v228, v56
    v_mfma_f32_16x16x32_bf16 v[84:87], v[196:199], v[28:31], v[84:87]
    s_add_u32 m0, s30, 24576
    s_add_u32 s35, s31, 172032
    buffer_load_dwordx4 v3, s[12:15], s35 offen lds
    v_mfma_f32_16x16x32_bf16 v[88:91], v[192:195], v[32:35], v[88:91]
    v_fma_f32 v217, v254, v229, v57
    v_fma_f32 v218, v254, v230, v58
    v_mfma_f32_16x16x32_bf16 v[92:95], v[196:199], v[32:35], v[92:95]
    v_fma_f32 v219, v254, v231, v59
    v_fma_f32 v220, v254, v232, v60
    v_mfma_f32_16x16x32_bf16 v[96:99], v[192:195], v[36:39], v[96:99]
    v_fma_f32 v221, v254, v233, v61
    v_fma_f32 v222, v254, v234, v62
    v_mfma_f32_16x16x32_bf16 v[100:103], v[196:199], v[36:39], v[100:103]
    s_add_u32 m0, s30, 28672
    s_add_u32 s35, s31, 176128
    buffer_load_dwordx4 v3, s[12:15], s35 offen lds
    s_waitcnt lgkmcnt(4)
    v_mfma_f32_16x16x32_bf16 v[104:107], v[168:171], a[224:227], v[104:107]
    ds_read_b128 v[192:195], v5 offset:34816
    ds_read_b128 v[196:199], v5 offset:35840
    v_mfma_f32_16x16x32_bf16 v[108:111], v[172:175], a[224:227], v[108:111]
    v_fma_f32 v223, v254, v235, v63
    v_mul_f32 v224, v216, v220
    v_mfma_f32_16x16x32_bf16 v[112:115], v[168:171], a[228:231], v[112:115]
    v_mul_f32 v225, v217, v221
    v_mul_f32 v226, v218, v222
    v_mfma_f32_16x16x32_bf16 v[116:119], v[172:175], a[228:231], v[116:119]
    v_mul_f32 v227, v219, v223
    v_cvt_pk_bf16_f32 v208, v224, v225
    v_mfma_f32_16x16x32_bf16 v[120:123], v[168:171], a[232:235], v[120:123]
    s_add_u32 m0, s30, 32768
    s_add_u32 s35, s31, 180224
    buffer_load_dwordx4 v3, s[12:15], s35 offen lds
    v_mfma_f32_16x16x32_bf16 v[124:127], v[172:175], a[232:235], v[124:127]
    v_cvt_pk_bf16_f32 v209, v226, v227
    v_fma_f32 v216, v255, v228, v64
    v_mfma_f32_16x16x32_bf16 v[128:131], v[168:171], a[236:239], v[128:131]
    v_fma_f32 v217, v255, v229, v65
    v_fma_f32 v218, v255, v230, v66
    v_mfma_f32_16x16x32_bf16 v[132:135], v[172:175], a[236:239], v[132:135]
    v_fma_f32 v219, v255, v231, v67
    v_fma_f32 v220, v255, v232, v68
    s_waitcnt lgkmcnt(4)
    v_mfma_f32_16x16x32_bf16 v[104:107], v[176:179], a[240:243], v[104:107]
    ds_read_b128 v[168:171], v6 offset:28672
    ds_read_b128 v[172:175], v6 offset:29696
    v_mfma_f32_16x16x32_bf16 v[108:111], v[180:183], a[240:243], v[108:111]
    s_add_u32 m0, s30, 36864
    s_add_u32 s35, s31, 184320
    buffer_load_dwordx4 v3, s[12:15], s35 offen lds
    v_mfma_f32_16x16x32_bf16 v[112:115], v[176:179], a[244:247], v[112:115]
    v_fma_f32 v221, v255, v233, v69
    v_fma_f32 v222, v255, v234, v70
    v_mfma_f32_16x16x32_bf16 v[116:119], v[180:183], a[244:247], v[116:119]
    v_fma_f32 v223, v255, v235, v71
    v_mul_f32 v224, v216, v220
    v_mfma_f32_16x16x32_bf16 v[120:123], v[176:179], a[248:251], v[120:123]
    v_mul_f32 v225, v217, v221
    v_mul_f32 v226, v218, v222
    v_mfma_f32_16x16x32_bf16 v[124:127], v[180:183], a[248:251], v[124:127]
    s_add_u32 m0, s30, 40960
    s_add_u32 s35, s31, 188416
    buffer_load_dwordx4 v3, s[12:15], s35 offen lds
    v_mfma_f32_16x16x32_bf16 v[128:131], v[176:179], a[252:255], v[128:131]
    v_mul_f32 v227, v219, v223
    v_cvt_pk_bf16_f32 v212, v224, v225
    v_mfma_f32_16x16x32_bf16 v[132:135], v[180:183], a[252:255], v[132:135]
    v_cvt_pk_bf16_f32 v213, v226, v227
    ds_read_b128 v[228:231], v7 offset:128
    s_waitcnt lgkmcnt(5)
    v_mfma_f32_16x16x32_bf16 v[104:107], v[184:187], v[8:11], v[104:107]
    ds_read_b128 v[176:179], v6 offset:30720
    ds_read_b128 v[180:183], v6 offset:31744
    v_mfma_f32_16x16x32_bf16 v[108:111], v[188:191], v[8:11], v[108:111]
    ds_read_b128 v[232:235], v7 offset:192
    v_mfma_f32_16x16x32_bf16 v[112:115], v[184:187], v[12:15], v[112:115]
    s_add_u32 m0, s30, 45056
    s_add_u32 s35, s31, 192512
    buffer_load_dwordx4 v3, s[12:15], s35 offen lds
    v_mfma_f32_16x16x32_bf16 v[116:119], v[188:191], v[12:15], v[116:119]
    v_mfma_f32_16x16x32_bf16 v[120:123], v[184:187], v[16:19], v[120:123]
    s_waitcnt lgkmcnt(0)
    v_fma_f32 v216, v252, v228, v72
    v_mfma_f32_16x16x32_bf16 v[124:127], v[188:191], v[16:19], v[124:127]
    v_fma_f32 v217, v252, v229, v73
    v_fma_f32 v218, v252, v230, v74
    v_mfma_f32_16x16x32_bf16 v[128:131], v[184:187], v[20:23], v[128:131]
    s_add_u32 m0, s30, 49152
    s_add_u32 s35, s31, 196608
    buffer_load_dwordx4 v3, s[12:15], s35 offen lds
    v_mfma_f32_16x16x32_bf16 v[132:135], v[188:191], v[20:23], v[132:135]
    v_fma_f32 v219, v252, v231, v75
    v_fma_f32 v220, v252, v232, v76
    v_mfma_f32_16x16x32_bf16 v[104:107], v[192:195], v[24:27], v[104:107]
    ds_read_b128 v[184:187], v6 offset:32768
    ds_read_b128 v[188:191], v6 offset:33792
    v_mfma_f32_16x16x32_bf16 v[108:111], v[196:199], v[24:27], v[108:111]
    v_fma_f32 v221, v252, v233, v77
    v_fma_f32 v222, v252, v234, v78
    v_mfma_f32_16x16x32_bf16 v[112:115], v[192:195], v[28:31], v[112:115]
    v_fma_f32 v223, v252, v235, v79
    v_mul_f32 v224, v216, v220
    v_mfma_f32_16x16x32_bf16 v[116:119], v[196:199], v[28:31], v[116:119]
    s_add_u32 m0, s30, 53248
    s_add_u32 s35, s31, 200704
    buffer_load_dwordx4 v3, s[12:15], s35 offen lds
    v_mfma_f32_16x16x32_bf16 v[120:123], v[192:195], v[32:35], v[120:123]
    v_mul_f32 v225, v217, v221
    v_mul_f32 v226, v218, v222
    v_mfma_f32_16x16x32_bf16 v[124:127], v[196:199], v[32:35], v[124:127]
    v_mul_f32 v227, v219, v223
    v_cvt_pk_bf16_f32 v202, v224, v225
    v_mfma_f32_16x16x32_bf16 v[128:131], v[192:195], v[36:39], v[128:131]
    v_cvt_pk_bf16_f32 v203, v226, v227
    v_fma_f32 v216, v253, v228, v80
    v_mfma_f32_16x16x32_bf16 v[132:135], v[196:199], v[36:39], v[132:135]
    s_add_u32 m0, s30, 57344
    s_add_u32 s35, s31, 204800
    buffer_load_dwordx4 v3, s[12:15], s35 offen lds
    v_mfma_f32_16x16x32_bf16 v[136:139], v[168:171], a[224:227], v[136:139]
    ds_read_b128 v[192:195], v6 offset:34816
    ds_read_b128 v[196:199], v6 offset:35840
    v_mfma_f32_16x16x32_bf16 v[140:143], v[172:175], a[224:227], v[140:143]
    v_fma_f32 v217, v253, v229, v81
    v_fma_f32 v218, v253, v230, v82
    v_mfma_f32_16x16x32_bf16 v[144:147], v[168:171], a[228:231], v[144:147]
    v_fma_f32 v219, v253, v231, v83
    v_fma_f32 v220, v253, v232, v84
    v_mfma_f32_16x16x32_bf16 v[148:151], v[172:175], a[228:231], v[148:151]
    v_fma_f32 v221, v253, v233, v85
    v_fma_f32 v222, v253, v234, v86
    v_mfma_f32_16x16x32_bf16 v[152:155], v[168:171], a[232:235], v[152:155]
    s_add_u32 m0, s30, 61440
    s_add_u32 s35, s31, 208896
    buffer_load_dwordx4 v3, s[12:15], s35 offen lds
    v_mfma_f32_16x16x32_bf16 v[156:159], v[172:175], a[232:235], v[156:159]
    v_fma_f32 v223, v253, v235, v87
    v_mul_f32 v224, v216, v220
    v_mfma_f32_16x16x32_bf16 v[160:163], v[168:171], a[236:239], v[160:163]
    v_mul_f32 v225, v217, v221
    v_mul_f32 v226, v218, v222
    v_mfma_f32_16x16x32_bf16 v[164:167], v[172:175], a[236:239], v[164:167]
    v_mul_f32 v227, v219, v223
    v_cvt_pk_bf16_f32 v206, v224, v225
    s_waitcnt lgkmcnt(0)
    s_waitcnt vmcnt(7)
    s_barrier
    v_mfma_f32_16x16x32_bf16 v[136:139], v[176:179], a[240:243], v[136:139]
    ds_read_b128 v[168:171], v3 offset:0
    ds_read_b128 v[172:175], v3 offset:1024
    v_mfma_f32_16x16x32_bf16 v[140:143], v[180:183], a[240:243], v[140:143]
    s_add_u32 m0, s30, 65536
    s_add_u32 s35, s31, 212992
    buffer_load_dwordx4 v3, s[12:15], s35 offen lds
    v_mfma_f32_16x16x32_bf16 v[144:147], v[176:179], a[244:247], v[144:147]
    v_cvt_pk_bf16_f32 v207, v226, v227
    v_fma_f32 v216, v254, v228, v88
    v_mfma_f32_16x16x32_bf16 v[148:151], v[180:183], a[244:247], v[148:151]
    v_fma_f32 v217, v254, v229, v89
    v_fma_f32 v218, v254, v230, v90
    v_mfma_f32_16x16x32_bf16 v[152:155], v[176:179], a[248:251], v[152:155]
    v_fma_f32 v219, v254, v231, v91
    v_fma_f32 v220, v254, v232, v92
    v_mfma_f32_16x16x32_bf16 v[156:159], v[180:183], a[248:251], v[156:159]
    s_add_u32 m0, s30, 69632
    s_add_u32 s35, s31, 217088
    buffer_load_dwordx4 v3, s[12:15], s35 offen lds
    v_mfma_f32_16x16x32_bf16 v[160:163], v[176:179], a[252:255], v[160:163]
    v_fma_f32 v221, v254, v233, v93
    v_fma_f32 v222, v254, v234, v94
    v_mfma_f32_16x16x32_bf16 v[164:167], v[180:183], a[252:255], v[164:167]
    v_fma_f32 v223, v254, v235, v95
    v_mul_f32 v224, v216, v220
    v_mfma_f32_16x16x32_bf16 v[136:139], v[184:187], v[8:11], v[136:139]
    ds_read_b128 v[176:179], v3 offset:2048
    ds_read_b128 v[180:183], v3 offset:3072
    v_mfma_f32_16x16x32_bf16 v[140:143], v[188:191], v[8:11], v[140:143]
    v_mul_f32 v225, v217, v221
    v_mul_f32 v226, v218, v222
    v_mfma_f32_16x16x32_bf16 v[144:147], v[184:187], v[12:15], v[144:147]
    v_mul_f32 v227, v219, v223
    v_cvt_pk_bf16_f32 v210, v224, v225
    v_mfma_f32_16x16x32_bf16 v[148:151], v[188:191], v[12:15], v[148:151]
    v_cvt_pk_bf16_f32 v211, v226, v227
    v_fma_f32 v216, v255, v228, v96
    v_mfma_f32_16x16x32_bf16 v[152:155], v[184:187], v[16:19], v[152:155]
    v_fma_f32 v217, v255, v229, v97
    v_fma_f32 v218, v255, v230, v98
    v_mfma_f32_16x16x32_bf16 v[156:159], v[188:191], v[16:19], v[156:159]
    v_fma_f32 v219, v255, v231, v99
    v_fma_f32 v220, v255, v232, v100
    v_mfma_f32_16x16x32_bf16 v[160:163], v[184:187], v[20:23], v[160:163]
    v_fma_f32 v221, v255, v233, v101
    v_fma_f32 v222, v255, v234, v102
    v_mfma_f32_16x16x32_bf16 v[164:167], v[188:191], v[20:23], v[164:167]
    v_fma_f32 v223, v255, v235, v103
    v_mul_f32 v224, v216, v220
    v_mfma_f32_16x16x32_bf16 v[136:139], v[192:195], v[24:27], v[136:139]
    ds_read_b128 v[184:187], v3 offset:4096
    ds_read_b128 v[188:191], v3 offset:5120
    v_mfma_f32_16x16x32_bf16 v[140:143], v[196:199], v[24:27], v[140:143]
    v_mul_f32 v225, v217, v221
    v_mul_f32 v226, v218, v222
    v_mfma_f32_16x16x32_bf16 v[144:147], v[192:195], v[28:31], v[144:147]
    v_mul_f32 v227, v219, v223
    v_cvt_pk_bf16_f32 v214, v224, v225
    v_mfma_f32_16x16x32_bf16 v[148:151], v[196:199], v[28:31], v[148:151]
    v_cvt_pk_bf16_f32 v215, v226, v227
    buffer_store_dwordx4 v[200:203], v3, s[8:11], s36 offen sc1
    s_add_u32 s36, s36, 1024
    v_mfma_f32_16x16x32_bf16 v[152:155], v[192:195], v[32:35], v[152:155]
    buffer_store_dwordx4 v[204:207], v3, s[8:11], s37 offen sc1
    s_add_u32 s37, s37, 1024
    buffer_store_dwordx4 v[208:211], v3, s[8:11], s38 offen sc1
    s_add_u32 s38, s38, 1024
    v_mfma_f32_16x16x32_bf16 v[156:159], v[196:199], v[32:35], v[156:159]
    buffer_store_dwordx4 v[212:215], v3, s[8:11], s39 offen sc1
    s_add_u32 s39, s39, 1024
    ds_read_b128 v[228:231], v7 offset:256
    v_mfma_f32_16x16x32_bf16 v[160:163], v[192:195], v[36:39], v[160:163]
    ds_read_b128 v[232:235], v7 offset:320
    v_mfma_f32_16x16x32_bf16 v[164:167], v[196:199], v[36:39], v[164:167]
    s_waitcnt lgkmcnt(6)
    v_mfma_f32_16x16x32_bf16 v[40:43], v[168:171], a[0:3], 0
    ds_read_b128 v[192:195], v3 offset:6144
    ds_read_b128 v[196:199], v3 offset:7168
    v_mfma_f32_16x16x32_bf16 v[44:47], v[172:175], a[0:3], 0
    v_lshrrev_b32 v237, 2, v1
    v_bfe_u32 v238, v1, 3, 2
    v_mfma_f32_16x16x32_bf16 v[48:51], v[168:171], a[4:7], 0
    v_lshlrev_b32 v238, 5, v238
    v_lshl_add_u32 v238, v237, 7, v238
    v_mfma_f32_16x16x32_bf16 v[52:55], v[172:175], a[4:7], 0
    v_and_b32 v237, 3, v1
    v_lshl_add_u32 v238, v237, 3, v238
    v_mfma_f32_16x16x32_bf16 v[56:59], v[168:171], a[8:11], 0
    v_add_u32 v238, s72, v238
    v_xor_b32 v239, 32, v238
    v_mfma_f32_16x16x32_bf16 v[60:63], v[172:175], a[8:11], 0
    v_xor_b32 v240, 64, v238
    v_xor_b32 v241, 96, v238
    v_mfma_f32_16x16x32_bf16 v[64:67], v[168:171], a[12:15], 0
    ds_read_b64_tr_b16 v[72:73], v238 offset:0
    v_mfma_f32_16x16x32_bf16 v[68:71], v[172:175], a[12:15], 0
    ds_read_b64_tr_b16 v[74:75], v238 offset:2048
    s_waitcnt lgkmcnt(8)
    v_mfma_f32_16x16x32_bf16 v[40:43], v[176:179], a[16:19], v[40:43]
    ds_read_b128 v[168:171], v3 offset:8192
    ds_read_b128 v[172:175], v3 offset:9216
    v_mfma_f32_16x16x32_bf16 v[44:47], v[180:183], a[16:19], v[44:47]
    ds_read_b64_tr_b16 v[76:77], v238 offset:4096
    v_mfma_f32_16x16x32_bf16 v[48:51], v[176:179], a[20:23], v[48:51]
    ds_read_b64_tr_b16 v[78:79], v238 offset:6144
    v_mfma_f32_16x16x32_bf16 v[52:55], v[180:183], a[20:23], v[52:55]
    ds_read_b64_tr_b16 v[80:81], v239 offset:0
    v_mfma_f32_16x16x32_bf16 v[56:59], v[176:179], a[24:27], v[56:59]
    ds_read_b64_tr_b16 v[82:83], v239 offset:2048
    v_mfma_f32_16x16x32_bf16 v[60:63], v[180:183], a[24:27], v[60:63]
    ds_read_b64_tr_b16 v[84:85], v239 offset:4096
    v_mfma_f32_16x16x32_bf16 v[64:67], v[176:179], a[28:31], v[64:67]
    ds_read_b64_tr_b16 v[86:87], v239 offset:6144
    v_mfma_f32_16x16x32_bf16 v[68:71], v[180:183], a[28:31], v[68:71]
    ds_read_b64_tr_b16 v[88:89], v240 offset:0
    s_waitcnt lgkmcnt(15)
    v_mfma_f32_16x16x32_bf16 v[40:43], v[184:187], a[32:35], v[40:43]
    ds_read_b128 v[176:179], v3 offset:10240
    ds_read_b128 v[180:183], v3 offset:11264
    v_mfma_f32_16x16x32_bf16 v[44:47], v[188:191], a[32:35], v[44:47]
    ds_read_b64_tr_b16 v[90:91], v240 offset:2048
    v_mfma_f32_16x16x32_bf16 v[48:51], v[184:187], a[36:39], v[48:51]
    ds_read_b64_tr_b16 v[92:93], v240 offset:4096
    v_mfma_f32_16x16x32_bf16 v[52:55], v[188:191], a[36:39], v[52:55]
    ds_read_b64_tr_b16 v[94:95], v240 offset:6144
    v_mfma_f32_16x16x32_bf16 v[56:59], v[184:187], a[40:43], v[56:59]
    ds_read_b64_tr_b16 v[96:97], v241 offset:0
    v_mfma_f32_16x16x32_bf16 v[60:63], v[188:191], a[40:43], v[60:63]
    ds_read_b64_tr_b16 v[98:99], v241 offset:2048
    v_mfma_f32_16x16x32_bf16 v[64:67], v[184:187], a[44:47], v[64:67]
    ds_read_b64_tr_b16 v[100:101], v241 offset:4096
    v_mfma_f32_16x16x32_bf16 v[68:71], v[188:191], a[44:47], v[68:71]
    ds_read_b64_tr_b16 v[102:103], v241 offset:6144
    s_waitcnt lgkmcnt(15)
    v_mfma_f32_16x16x32_bf16 v[40:43], v[192:195], a[48:51], v[40:43]
    ds_read_b128 v[184:187], v3 offset:12288
    ds_read_b128 v[188:191], v3 offset:13312
    v_mfma_f32_16x16x32_bf16 v[44:47], v[196:199], a[48:51], v[44:47]
    v_mfma_f32_16x16x32_bf16 v[48:51], v[192:195], a[52:55], v[48:51]
    s_waitcnt lgkmcnt(15)
    buffer_store_dwordx4 v[72:75], v3, s[68:71], s74 offen sc1
    v_mfma_f32_16x16x32_bf16 v[52:55], v[196:199], a[52:55], v[52:55]
    v_fma_f32 v216, v252, v228, v104
    v_mfma_f32_16x16x32_bf16 v[56:59], v[192:195], a[56:59], v[56:59]
    v_fma_f32 v217, v252, v229, v105
    v_mfma_f32_16x16x32_bf16 v[60:63], v[196:199], a[56:59], v[60:63]
    v_fma_f32 v218, v252, v230, v106
    v_mfma_f32_16x16x32_bf16 v[64:67], v[192:195], a[60:63], v[64:67]
    v_fma_f32 v219, v252, v231, v107
    v_mfma_f32_16x16x32_bf16 v[68:71], v[196:199], a[60:63], v[68:71]
    v_fma_f32 v220, v252, v232, v108
    v_mfma_f32_16x16x32_bf16 v[40:43], v[168:171], a[64:67], v[40:43]
    ds_read_b128 v[192:195], v3 offset:14336
    ds_read_b128 v[196:199], v3 offset:15360
    v_mfma_f32_16x16x32_bf16 v[44:47], v[172:175], a[64:67], v[44:47]
    buffer_store_dwordx4 v[76:79], v3, s[68:71], s75 offen sc1
    v_mfma_f32_16x16x32_bf16 v[48:51], v[168:171], a[68:71], v[48:51]
    v_fma_f32 v221, v252, v233, v109
    v_mfma_f32_16x16x32_bf16 v[52:55], v[172:175], a[68:71], v[52:55]
    v_fma_f32 v222, v252, v234, v110
    v_mfma_f32_16x16x32_bf16 v[56:59], v[168:171], a[72:75], v[56:59]
    v_fma_f32 v223, v252, v235, v111
    v_mfma_f32_16x16x32_bf16 v[60:63], v[172:175], a[72:75], v[60:63]
    v_mul_f32 v224, v216, v220
    v_mfma_f32_16x16x32_bf16 v[64:67], v[168:171], a[76:79], v[64:67]
    v_mul_f32 v225, v217, v221
    v_mfma_f32_16x16x32_bf16 v[68:71], v[172:175], a[76:79], v[68:71]
    s_waitcnt lgkmcnt(14)
    buffer_store_dwordx4 v[80:83], v3, s[68:71], s77 offen sc1
    s_waitcnt lgkmcnt(11)
    v_mfma_f32_16x16x32_bf16 v[40:43], v[176:179], a[80:83], v[40:43]
    ds_read_b128 v[168:171], v3 offset:16384
    ds_read_b128 v[172:175], v3 offset:17408
    v_mfma_f32_16x16x32_bf16 v[44:47], v[180:183], a[80:83], v[44:47]
    v_mul_f32 v226, v218, v222
    v_mfma_f32_16x16x32_bf16 v[48:51], v[176:179], a[84:87], v[48:51]
    v_mul_f32 v227, v219, v223
    v_mfma_f32_16x16x32_bf16 v[52:55], v[180:183], a[84:87], v[52:55]
    v_cvt_pk_bf16_f32 v200, v224, v225
    v_mfma_f32_16x16x32_bf16 v[56:59], v[176:179], a[88:91], v[56:59]
    v_cvt_pk_bf16_f32 v201, v226, v227
    v_mfma_f32_16x16x32_bf16 v[60:63], v[180:183], a[88:91], v[60:63]
    buffer_store_dwordx4 v[84:87], v3, s[68:71], s78 offen sc1
    v_mfma_f32_16x16x32_bf16 v[64:67], v[176:179], a[92:95], v[64:67]
    v_fma_f32 v216, v253, v228, v112
    v_mfma_f32_16x16x32_bf16 v[68:71], v[180:183], a[92:95], v[68:71]
    v_fma_f32 v217, v253, v229, v113
    s_waitcnt lgkmcnt(4)
    v_mfma_f32_16x16x32_bf16 v[40:43], v[184:187], a[96:99], v[40:43]
    ds_read_b128 v[176:179], v3 offset:18432
    ds_read_b128 v[180:183], v3 offset:19456
    v_mfma_f32_16x16x32_bf16 v[44:47], v[188:191], a[96:99], v[44:47]
    v_fma_f32 v218, v253, v230, v114
    v_mfma_f32_16x16x32_bf16 v[48:51], v[184:187], a[100:103], v[48:51]
    v_fma_f32 v219, v253, v231, v115
    v_mfma_f32_16x16x32_bf16 v[52:55], v[188:191], a[100:103], v[52:55]
    buffer_store_dwordx4 v[88:91], v3, s[68:71], s79 offen sc1
    v_mfma_f32_16x16x32_bf16 v[56:59], v[184:187], a[104:107], v[56:59]
    v_fma_f32 v220, v253, v232, v116
    v_mfma_f32_16x16x32_bf16 v[60:63], v[188:191], a[104:107], v[60:63]
    v_fma_f32 v221, v253, v233, v117
L_pad_k3_kernel_3:
    s_cbranch_execz k3_kernel_end
    v_mfma_f32_16x16x32_bf16 v[64:67], v[184:187], a[108:111], v[64:67]
    v_fma_f32 v222, v253, v234, v118
    v_mfma_f32_16x16x32_bf16 v[68:71], v[188:191], a[108:111], v[68:71]
    v_fma_f32 v223, v253, v235, v119
    s_waitcnt lgkmcnt(4)
    v_mfma_f32_16x16x32_bf16 v[40:43], v[192:195], a[112:115], v[40:43]
    ds_read_b128 v[184:187], v3 offset:20480
    ds_read_b128 v[188:191], v3 offset:21504
    v_mfma_f32_16x16x32_bf16 v[44:47], v[196:199], a[112:115], v[44:47]
    buffer_store_dwordx4 v[92:95], v3, s[68:71], s80 offen sc1
    v_mfma_f32_16x16x32_bf16 v[48:51], v[192:195], a[116:119], v[48:51]
    v_mul_f32 v224, v216, v220
    v_mfma_f32_16x16x32_bf16 v[52:55], v[196:199], a[116:119], v[52:55]
    v_mul_f32 v225, v217, v221
    v_mfma_f32_16x16x32_bf16 v[56:59], v[192:195], a[120:123], v[56:59]
    v_mul_f32 v226, v218, v222
    v_mfma_f32_16x16x32_bf16 v[60:63], v[196:199], a[120:123], v[60:63]
    v_mul_f32 v227, v219, v223
    v_mfma_f32_16x16x32_bf16 v[64:67], v[192:195], a[124:127], v[64:67]
    v_cvt_pk_bf16_f32 v204, v224, v225
    v_mfma_f32_16x16x32_bf16 v[68:71], v[196:199], a[124:127], v[68:71]
    buffer_store_dwordx4 v[96:99], v3, s[68:71], s45 offen sc1
    s_waitcnt lgkmcnt(4)
    v_mfma_f32_16x16x32_bf16 v[40:43], v[168:171], a[128:131], v[40:43]
    ds_read_b128 v[192:195], v3 offset:22528
    ds_read_b128 v[196:199], v3 offset:23552
    v_mfma_f32_16x16x32_bf16 v[44:47], v[172:175], a[128:131], v[44:47]
    v_cvt_pk_bf16_f32 v205, v226, v227
    v_mfma_f32_16x16x32_bf16 v[48:51], v[168:171], a[132:135], v[48:51]
    v_fma_f32 v216, v254, v228, v120
    v_mfma_f32_16x16x32_bf16 v[52:55], v[172:175], a[132:135], v[52:55]
    v_fma_f32 v217, v254, v229, v121
    v_mfma_f32_16x16x32_bf16 v[56:59], v[168:171], a[136:139], v[56:59]
    v_fma_f32 v218, v254, v230, v122
    v_mfma_f32_16x16x32_bf16 v[60:63], v[172:175], a[136:139], v[60:63]
    buffer_store_dwordx4 v[100:103], v3, s[68:71], s46 offen sc1
    v_mfma_f32_16x16x32_bf16 v[64:67], v[168:171], a[140:143], v[64:67]
    v_fma_f32 v219, v254, v231, v123
    v_mfma_f32_16x16x32_bf16 v[68:71], v[172:175], a[140:143], v[68:71]
    v_fma_f32 v220, v254, v232, v124
    s_waitcnt lgkmcnt(4)
    v_mfma_f32_16x16x32_bf16 v[40:43], v[176:179], a[144:147], v[40:43]
    ds_read_b128 v[168:171], v3 offset:24576
    ds_read_b128 v[172:175], v3 offset:25600
    v_mfma_f32_16x16x32_bf16 v[44:47], v[180:183], a[144:147], v[44:47]
    v_fma_f32 v221, v254, v233, v125
    v_mfma_f32_16x16x32_bf16 v[48:51], v[176:179], a[148:151], v[48:51]
    v_fma_f32 v222, v254, v234, v126
    v_mfma_f32_16x16x32_bf16 v[52:55], v[180:183], a[148:151], v[52:55]
    s_add_u32 m0, s30, 90112
    s_add_u32 s35, s31, 237568
    buffer_load_dwordx4 v3, s[12:15], s35 offen lds
    v_mfma_f32_16x16x32_bf16 v[56:59], v[176:179], a[152:155], v[56:59]
    v_fma_f32 v223, v254, v235, v127
    v_mfma_f32_16x16x32_bf16 v[60:63], v[180:183], a[152:155], v[60:63]
    v_mul_f32 v224, v216, v220
    v_mfma_f32_16x16x32_bf16 v[64:67], v[176:179], a[156:159], v[64:67]
    v_mul_f32 v225, v217, v221
    v_mfma_f32_16x16x32_bf16 v[68:71], v[180:183], a[156:159], v[68:71]
    v_mul_f32 v226, v218, v222
    s_waitcnt lgkmcnt(4)
    v_mfma_f32_16x16x32_bf16 v[40:43], v[184:187], a[160:163], v[40:43]
    ds_read_b128 v[176:179], v3 offset:26624
    ds_read_b128 v[180:183], v3 offset:27648
    v_mfma_f32_16x16x32_bf16 v[44:47], v[188:191], a[160:163], v[44:47]
    s_add_u32 m0, s30, 94208
    s_add_u32 s35, s31, 241664
    buffer_load_dwordx4 v3, s[12:15], s35 offen lds
    v_mfma_f32_16x16x32_bf16 v[48:51], v[184:187], a[164:167], v[48:51]
    v_mul_f32 v227, v219, v223
    v_mfma_f32_16x16x32_bf16 v[52:55], v[188:191], a[164:167], v[52:55]
    v_cvt_pk_bf16_f32 v208, v224, v225
    v_mfma_f32_16x16x32_bf16 v[56:59], v[184:187], a[168:171], v[56:59]
    v_cvt_pk_bf16_f32 v209, v226, v227
    v_mfma_f32_16x16x32_bf16 v[60:63], v[188:191], a[168:171], v[60:63]
    v_fma_f32 v216, v255, v228, v128
    v_mfma_f32_16x16x32_bf16 v[64:67], v[184:187], a[172:175], v[64:67]
    v_fma_f32 v217, v255, v229, v129
    v_mfma_f32_16x16x32_bf16 v[68:71], v[188:191], a[172:175], v[68:71]
    s_add_u32 m0, s30, 98304
    s_add_u32 s35, s31, 245760
    buffer_load_dwordx4 v3, s[12:15], s35 offen lds
    s_waitcnt lgkmcnt(4)
    v_mfma_f32_16x16x32_bf16 v[40:43], v[192:195], a[176:179], v[40:43]
    ds_read_b128 v[184:187], v3 offset:28672
    ds_read_b128 v[188:191], v3 offset:29696
    v_mfma_f32_16x16x32_bf16 v[44:47], v[196:199], a[176:179], v[44:47]
    v_fma_f32 v218, v255, v230, v130
    v_mfma_f32_16x16x32_bf16 v[48:51], v[192:195], a[180:183], v[48:51]
    v_fma_f32 v219, v255, v231, v131
    v_mfma_f32_16x16x32_bf16 v[52:55], v[196:199], a[180:183], v[52:55]
    v_fma_f32 v220, v255, v232, v132
    v_mfma_f32_16x16x32_bf16 v[56:59], v[192:195], a[184:187], v[56:59]
    v_fma_f32 v221, v255, v233, v133
    v_mfma_f32_16x16x32_bf16 v[60:63], v[196:199], a[184:187], v[60:63]
    s_add_u32 m0, s30, 102400
    s_add_u32 s35, s31, 249856
    buffer_load_dwordx4 v3, s[12:15], s35 offen lds
    v_mfma_f32_16x16x32_bf16 v[64:67], v[192:195], a[188:191], v[64:67]
    v_fma_f32 v222, v255, v234, v134
    v_mfma_f32_16x16x32_bf16 v[68:71], v[196:199], a[188:191], v[68:71]
    v_fma_f32 v223, v255, v235, v135
    s_waitcnt lgkmcnt(4)
    v_mfma_f32_16x16x32_bf16 v[40:43], v[168:171], a[192:195], v[40:43]
    ds_read_b128 v[192:195], v3 offset:30720
    ds_read_b128 v[196:199], v3 offset:31744
    v_mfma_f32_16x16x32_bf16 v[44:47], v[172:175], a[192:195], v[44:47]
    v_mul_f32 v224, v216, v220
    v_mfma_f32_16x16x32_bf16 v[48:51], v[168:171], a[196:199], v[48:51]
    v_mul_f32 v225, v217, v221
    v_mfma_f32_16x16x32_bf16 v[52:55], v[172:175], a[196:199], v[52:55]
    s_add_u32 m0, s30, 106496
    s_add_u32 s35, s31, 253952
    buffer_load_dwordx4 v3, s[12:15], s35 offen lds
    v_mfma_f32_16x16x32_bf16 v[56:59], v[168:171], a[200:203], v[56:59]
    v_mul_f32 v226, v218, v222
    v_mfma_f32_16x16x32_bf16 v[60:63], v[172:175], a[200:203], v[60:63]
    v_mul_f32 v227, v219, v223
    v_mfma_f32_16x16x32_bf16 v[64:67], v[168:171], a[204:207], v[64:67]
    v_cvt_pk_bf16_f32 v212, v224, v225
    v_mfma_f32_16x16x32_bf16 v[68:71], v[172:175], a[204:207], v[68:71]
    v_cvt_pk_bf16_f32 v213, v226, v227
    s_waitcnt lgkmcnt(4)
    v_mfma_f32_16x16x32_bf16 v[40:43], v[176:179], a[208:211], v[40:43]
    ds_read_b128 v[168:171], v3 offset:32768
    ds_read_b128 v[172:175], v3 offset:33792
    v_mfma_f32_16x16x32_bf16 v[44:47], v[180:183], a[208:211], v[44:47]
    ds_read_b128 v[228:231], v7 offset:384
    v_mfma_f32_16x16x32_bf16 v[48:51], v[176:179], a[212:215], v[48:51]
    ds_read_b128 v[232:235], v7 offset:448
    v_mfma_f32_16x16x32_bf16 v[52:55], v[180:183], a[212:215], v[52:55]
    v_mfma_f32_16x16x32_bf16 v[56:59], v[176:179], a[216:219], v[56:59]
    v_mfma_f32_16x16x32_bf16 v[60:63], v[180:183], a[216:219], v[60:63]
    v_mfma_f32_16x16x32_bf16 v[64:67], v[176:179], a[220:223], v[64:67]
    v_mfma_f32_16x16x32_bf16 v[68:71], v[180:183], a[220:223], v[68:71]
    s_waitcnt lgkmcnt(0)
    v_fma_f32 v216, v252, v228, v136
    v_mfma_f32_16x16x32_bf16 v[40:43], v[184:187], a[224:227], v[40:43]
    ds_read_b128 v[176:179], v3 offset:34816
    ds_read_b128 v[180:183], v3 offset:35840
    v_mfma_f32_16x16x32_bf16 v[44:47], v[188:191], a[224:227], v[44:47]
    v_fma_f32 v217, v252, v229, v137
    v_mfma_f32_16x16x32_bf16 v[48:51], v[184:187], a[228:231], v[48:51]
    v_fma_f32 v218, v252, v230, v138
    v_mfma_f32_16x16x32_bf16 v[52:55], v[188:191], a[228:231], v[52:55]
    v_fma_f32 v219, v252, v231, v139
    v_mfma_f32_16x16x32_bf16 v[56:59], v[184:187], a[232:235], v[56:59]
    v_fma_f32 v220, v252, v232, v140
    v_mfma_f32_16x16x32_bf16 v[60:63], v[188:191], a[232:235], v[60:63]
    v_fma_f32 v221, v252, v233, v141
    v_mfma_f32_16x16x32_bf16 v[64:67], v[184:187], a[236:239], v[64:67]
    v_fma_f32 v222, v252, v234, v142
    v_mfma_f32_16x16x32_bf16 v[68:71], v[188:191], a[236:239], v[68:71]
    v_fma_f32 v223, v252, v235, v143
    s_waitcnt lgkmcnt(0)
    s_waitcnt vmcnt(17)
    s_barrier
    v_mfma_f32_16x16x32_bf16 v[40:43], v[192:195], a[240:243], v[40:43]
    ds_read_b128 v[184:187], v4 offset:0
    ds_read_b128 v[188:191], v4 offset:1024
    v_mfma_f32_16x16x32_bf16 v[44:47], v[196:199], a[240:243], v[44:47]
    v_mul_f32 v224, v216, v220
    v_mfma_f32_16x16x32_bf16 v[48:51], v[192:195], a[244:247], v[48:51]
    v_mul_f32 v225, v217, v221
    v_mfma_f32_16x16x32_bf16 v[52:55], v[196:199], a[244:247], v[52:55]
    v_mul_f32 v226, v218, v222
    v_mfma_f32_16x16x32_bf16 v[56:59], v[192:195], a[248:251], v[56:59]
    v_mul_f32 v227, v219, v223
    v_mfma_f32_16x16x32_bf16 v[60:63], v[196:199], a[248:251], v[60:63]
    v_cvt_pk_bf16_f32 v202, v224, v225
    v_mfma_f32_16x16x32_bf16 v[64:67], v[192:195], a[252:255], v[64:67]
    v_cvt_pk_bf16_f32 v203, v226, v227
    v_mfma_f32_16x16x32_bf16 v[68:71], v[196:199], a[252:255], v[68:71]
    v_fma_f32 v216, v253, v228, v144
    v_mfma_f32_16x16x32_bf16 v[40:43], v[168:171], v[8:11], v[40:43]
    ds_read_b128 v[192:195], v4 offset:2048
    ds_read_b128 v[196:199], v4 offset:3072
    v_mfma_f32_16x16x32_bf16 v[44:47], v[172:175], v[8:11], v[44:47]
    buffer_store_dwordx4 v[200:203], v3, s[8:11], s36 offen sc1
    s_add_u32 s36, s36, 1024
    v_mfma_f32_16x16x32_bf16 v[48:51], v[168:171], v[12:15], v[48:51]
    v_fma_f32 v217, v253, v229, v145
    v_mfma_f32_16x16x32_bf16 v[52:55], v[172:175], v[12:15], v[52:55]
    v_fma_f32 v218, v253, v230, v146
    v_mfma_f32_16x16x32_bf16 v[56:59], v[168:171], v[16:19], v[56:59]
    v_fma_f32 v219, v253, v231, v147
    v_mfma_f32_16x16x32_bf16 v[60:63], v[172:175], v[16:19], v[60:63]
    v_fma_f32 v220, v253, v232, v148
    v_mfma_f32_16x16x32_bf16 v[64:67], v[168:171], v[20:23], v[64:67]
    v_fma_f32 v221, v253, v233, v149
    v_mfma_f32_16x16x32_bf16 v[68:71], v[172:175], v[20:23], v[68:71]
    v_fma_f32 v222, v253, v234, v150
    v_mfma_f32_16x16x32_bf16 v[40:43], v[176:179], v[24:27], v[40:43]
    ds_read_b128 v[168:171], v4 offset:4096
    ds_read_b128 v[172:175], v4 offset:5120
    v_mfma_f32_16x16x32_bf16 v[44:47], v[180:183], v[24:27], v[44:47]
    v_fma_f32 v223, v253, v235, v151
    v_mfma_f32_16x16x32_bf16 v[48:51], v[176:179], v[28:31], v[48:51]
    v_mul_f32 v224, v216, v220
    v_mfma_f32_16x16x32_bf16 v[52:55], v[180:183], v[28:31], v[52:55]
    v_mul_f32 v225, v217, v221
    v_mfma_f32_16x16x32_bf16 v[56:59], v[176:179], v[32:35], v[56:59]
    v_mul_f32 v226, v218, v222
    v_mfma_f32_16x16x32_bf16 v[60:63], v[180:183], v[32:35], v[60:63]
    v_mul_f32 v227, v219, v223
    v_mfma_f32_16x16x32_bf16 v[64:67], v[176:179], v[36:39], v[64:67]
    v_cvt_pk_bf16_f32 v206, v224, v225
    v_mfma_f32_16x16x32_bf16 v[68:71], v[180:183], v[36:39], v[68:71]
    v_cvt_pk_bf16_f32 v207, v226, v227
    s_waitcnt lgkmcnt(4)
    v_mfma_f32_16x16x32_bf16 v[104:107], v[184:187], a[0:3], 0
    ds_read_b128 v[176:179], v4 offset:6144
    ds_read_b128 v[180:183], v4 offset:7168
    v_mfma_f32_16x16x32_bf16 v[108:111], v[188:191], a[0:3], 0
    s_add_u32 m0, s30, 73728
    s_add_u32 s35, s31, 221184
    buffer_load_dwordx4 v3, s[12:15], s35 offen lds
    v_mfma_f32_16x16x32_bf16 v[112:115], v[184:187], a[4:7], 0
    v_fma_f32 v216, v254, v228, v152
    v_mfma_f32_16x16x32_bf16 v[116:119], v[188:191], a[4:7], 0
    v_fma_f32 v217, v254, v229, v153
    v_mfma_f32_16x16x32_bf16 v[120:123], v[184:187], a[8:11], 0
    v_fma_f32 v218, v254, v230, v154
    v_mfma_f32_16x16x32_bf16 v[124:127], v[188:191], a[8:11], 0
    s_add_u32 m0, s30, 77824
    s_add_u32 s35, s31, 225280
    buffer_load_dwordx4 v3, s[12:15], s35 offen lds
    v_mfma_f32_16x16x32_bf16 v[128:131], v[184:187], a[12:15], 0
    v_fma_f32 v219, v254, v231, v155
    v_mfma_f32_16x16x32_bf16 v[132:135], v[188:191], a[12:15], 0
    v_fma_f32 v220, v254, v232, v156
    s_waitcnt lgkmcnt(4)
    v_mfma_f32_16x16x32_bf16 v[104:107], v[192:195], a[16:19], v[104:107]
    ds_read_b128 v[184:187], v4 offset:8192
    ds_read_b128 v[188:191], v4 offset:9216
    v_mfma_f32_16x16x32_bf16 v[108:111], v[196:199], a[16:19], v[108:111]
    s_add_u32 m0, s30, 81920
    s_add_u32 s35, s31, 229376
    buffer_load_dwordx4 v3, s[12:15], s35 offen lds
    v_mfma_f32_16x16x32_bf16 v[112:115], v[192:195], a[20:23], v[112:115]
    v_fma_f32 v221, v254, v233, v157
    v_mfma_f32_16x16x32_bf16 v[116:119], v[196:199], a[20:23], v[116:119]
    v_fma_f32 v222, v254, v234, v158
    v_mfma_f32_16x16x32_bf16 v[120:123], v[192:195], a[24:27], v[120:123]
    v_fma_f32 v223, v254, v235, v159
    v_mfma_f32_16x16x32_bf16 v[124:127], v[196:199], a[24:27], v[124:127]
    s_add_u32 m0, s30, 86016
    s_add_u32 s35, s31, 233472
    buffer_load_dwordx4 v3, s[12:15], s35 offen lds
    v_mfma_f32_16x16x32_bf16 v[128:131], v[192:195], a[28:31], v[128:131]
    v_mul_f32 v224, v216, v220
    v_mfma_f32_16x16x32_bf16 v[132:135], v[196:199], a[28:31], v[132:135]
    v_mul_f32 v225, v217, v221
    s_waitcnt lgkmcnt(4)
    v_mfma_f32_16x16x32_bf16 v[104:107], v[168:171], a[32:35], v[104:107]
    ds_read_b128 v[192:195], v4 offset:10240
    ds_read_b128 v[196:199], v4 offset:11264
    v_mfma_f32_16x16x32_bf16 v[108:111], v[172:175], a[32:35], v[108:111]
    buffer_store_dwordx4 v[204:207], v3, s[8:11], s37 offen sc1
    s_add_u32 s37, s37, 1024
    v_mfma_f32_16x16x32_bf16 v[112:115], v[168:171], a[36:39], v[112:115]
    v_mul_f32 v226, v218, v222
    v_mfma_f32_16x16x32_bf16 v[116:119], v[172:175], a[36:39], v[116:119]
    v_mul_f32 v227, v219, v223
    v_mfma_f32_16x16x32_bf16 v[120:123], v[168:171], a[40:43], v[120:123]
    v_cvt_pk_bf16_f32 v210, v224, v225
    v_mfma_f32_16x16x32_bf16 v[124:127], v[172:175], a[40:43], v[124:127]
    v_cvt_pk_bf16_f32 v211, v226, v227
    v_mfma_f32_16x16x32_bf16 v[128:131], v[168:171], a[44:47], v[128:131]
    v_fma_f32 v216, v255, v228, v160
    v_mfma_f32_16x16x32_bf16 v[132:135], v[172:175], a[44:47], v[132:135]
    buffer_store_dwordx4 v[208:211], v3, s[8:11], s38 offen sc1
    s_add_u32 s38, s38, 1024
    s_waitcnt lgkmcnt(4)
    v_mfma_f32_16x16x32_bf16 v[104:107], v[176:179], a[48:51], v[104:107]
    ds_read_b128 v[168:171], v4 offset:12288
    ds_read_b128 v[172:175], v4 offset:13312
    v_mfma_f32_16x16x32_bf16 v[108:111], v[180:183], a[48:51], v[108:111]
    v_fma_f32 v217, v255, v229, v161
    v_mfma_f32_16x16x32_bf16 v[112:115], v[176:179], a[52:55], v[112:115]
    v_fma_f32 v218, v255, v230, v162
    v_mfma_f32_16x16x32_bf16 v[116:119], v[180:183], a[52:55], v[116:119]
    v_fma_f32 v219, v255, v231, v163
    v_mfma_f32_16x16x32_bf16 v[120:123], v[176:179], a[56:59], v[120:123]
    v_fma_f32 v220, v255, v232, v164
    v_mfma_f32_16x16x32_bf16 v[124:127], v[180:183], a[56:59], v[124:127]
    v_fma_f32 v221, v255, v233, v165
    v_mfma_f32_16x16x32_bf16 v[128:131], v[176:179], a[60:63], v[128:131]
    v_fma_f32 v222, v255, v234, v166
    v_mfma_f32_16x16x32_bf16 v[132:135], v[180:183], a[60:63], v[132:135]
    v_fma_f32 v223, v255, v235, v167
    s_waitcnt lgkmcnt(4)
    v_mfma_f32_16x16x32_bf16 v[104:107], v[184:187], a[64:67], v[104:107]
    ds_read_b128 v[176:179], v4 offset:14336
    ds_read_b128 v[180:183], v4 offset:15360
    v_mfma_f32_16x16x32_bf16 v[108:111], v[188:191], a[64:67], v[108:111]
    v_mul_f32 v224, v216, v220
    v_mfma_f32_16x16x32_bf16 v[112:115], v[184:187], a[68:71], v[112:115]
    v_mul_f32 v225, v217, v221
    v_mfma_f32_16x16x32_bf16 v[116:119], v[188:191], a[68:71], v[116:119]
    v_mul_f32 v226, v218, v222
    v_mfma_f32_16x16x32_bf16 v[120:123], v[184:187], a[72:75], v[120:123]
    v_mul_f32 v227, v219, v223
    v_mfma_f32_16x16x32_bf16 v[124:127], v[188:191], a[72:75], v[124:127]
    v_cvt_pk_bf16_f32 v214, v224, v225
    v_mfma_f32_16x16x32_bf16 v[128:131], v[184:187], a[76:79], v[128:131]
    v_cvt_pk_bf16_f32 v215, v226, v227
    v_mfma_f32_16x16x32_bf16 v[132:135], v[188:191], a[76:79], v[132:135]
    s_mov_b32 s16, s6
    s_and_b32 s17, s7, 0xffff
    s_waitcnt lgkmcnt(4)
    v_mfma_f32_16x16x32_bf16 v[104:107], v[192:195], a[80:83], v[104:107]
    ds_read_b128 v[184:187], v4 offset:16384
    ds_read_b128 v[188:191], v4 offset:17408
    v_mfma_f32_16x16x32_bf16 v[108:111], v[196:199], a[80:83], v[108:111]
    buffer_store_dwordx4 v[212:215], v3, s[8:11], s39 offen sc1
    s_add_u32 s39, s39, 1024
    v_mfma_f32_16x16x32_bf16 v[112:115], v[192:195], a[84:87], v[112:115]
    s_mov_b32 s18, 2359296
    s_mul_i32 s26, s55, 36864
    v_mfma_f32_16x16x32_bf16 v[116:119], v[196:199], a[84:87], v[116:119]
    s_mul_i32 s29, s3, 9216
    s_sub_u32 s27, s56, s30
    v_mfma_f32_16x16x32_bf16 v[120:123], v[192:195], a[88:91], v[120:123]
    s_add_u32 s27, s27, s29
    v_mov_b32 v246, 0
    v_mfma_f32_16x16x32_bf16 v[124:127], v[196:199], a[88:91], v[124:127]
    v_mfma_f32_16x16x32_bf16 v[128:131], v[192:195], a[92:95], v[128:131]
    v_add_u32 v249, 147456, v3
    v_lshlrev_b32 v2, 3, v1
    v_mfma_f32_16x16x32_bf16 v[132:135], v[196:199], a[92:95], v[132:135]
    v_add_u32 v250, 147456, v2
    v_min_u32 v251, 2, v1
    s_waitcnt lgkmcnt(4)
    v_mfma_f32_16x16x32_bf16 v[104:107], v[168:171], a[96:99], v[104:107]
    ds_read_b128 v[192:195], v4 offset:18432
    ds_read_b128 v[196:199], v4 offset:19456
    v_mfma_f32_16x16x32_bf16 v[108:111], v[172:175], a[96:99], v[108:111]
    s_add_u32 m0, s30, 110592
    s_add_u32 s35, s31, 258048
    buffer_load_dwordx4 v3, s[12:15], s35 offen lds
    v_mfma_f32_16x16x32_bf16 v[112:115], v[168:171], a[100:103], v[112:115]
    v_lshlrev_b32 v251, 7, v251
    v_mfma_f32_16x16x32_bf16 v[116:119], v[172:175], a[100:103], v[116:119]
    ds_read_b128 v[228:231], v7 offset:512
    v_mfma_f32_16x16x32_bf16 v[120:123], v[168:171], a[104:107], v[120:123]
    ds_read_b128 v[232:235], v7 offset:576
    v_mfma_f32_16x16x32_bf16 v[124:127], v[172:175], a[104:107], v[124:127]
    s_add_u32 m0, s30, 114688
    s_add_u32 s35, s31, 262144
    buffer_load_dwordx4 v3, s[12:15], s35 offen lds
    v_mfma_f32_16x16x32_bf16 v[128:131], v[168:171], a[108:111], v[128:131]
    v_mfma_f32_16x16x32_bf16 v[132:135], v[172:175], a[108:111], v[132:135]
    s_waitcnt lgkmcnt(6)
    v_mfma_f32_16x16x32_bf16 v[104:107], v[176:179], a[112:115], v[104:107]
    ds_read_b128 v[168:171], v4 offset:20480
    ds_read_b128 v[172:175], v4 offset:21504
    v_mfma_f32_16x16x32_bf16 v[108:111], v[180:183], a[112:115], v[108:111]
    s_add_u32 m0, s30, 118784
    s_add_u32 s35, s31, 266240
    buffer_load_dwordx4 v3, s[12:15], s35 offen lds
    v_mfma_f32_16x16x32_bf16 v[112:115], v[176:179], a[116:119], v[112:115]
    v_mfma_f32_16x16x32_bf16 v[116:119], v[180:183], a[116:119], v[116:119]
    v_mfma_f32_16x16x32_bf16 v[120:123], v[176:179], a[120:123], v[120:123]
    s_waitcnt lgkmcnt(2)
    v_fma_f32 v216, v252, v228, v40
    v_mfma_f32_16x16x32_bf16 v[124:127], v[180:183], a[120:123], v[124:127]
    s_add_u32 m0, s30, 122880
    s_add_u32 s35, s31, 270336
    buffer_load_dwordx4 v3, s[12:15], s35 offen lds
    v_mfma_f32_16x16x32_bf16 v[128:131], v[176:179], a[124:127], v[128:131]
    v_fma_f32 v217, v252, v229, v41
    v_mfma_f32_16x16x32_bf16 v[132:135], v[180:183], a[124:127], v[132:135]
    v_fma_f32 v218, v252, v230, v42
    v_mfma_f32_16x16x32_bf16 v[104:107], v[184:187], a[128:131], v[104:107]
    ds_read_b128 v[176:179], v4 offset:22528
    ds_read_b128 v[180:183], v4 offset:23552
    v_mfma_f32_16x16x32_bf16 v[108:111], v[188:191], a[128:131], v[108:111]
    s_add_u32 m0, s30, 126976
    s_add_u32 s35, s31, 274432
    buffer_load_dwordx4 v3, s[12:15], s35 offen lds
    v_mfma_f32_16x16x32_bf16 v[112:115], v[184:187], a[132:135], v[112:115]
    v_fma_f32 v219, v252, v231, v43
    v_mfma_f32_16x16x32_bf16 v[116:119], v[188:191], a[132:135], v[116:119]
    v_fma_f32 v220, v252, v232, v44
    v_mfma_f32_16x16x32_bf16 v[120:123], v[184:187], a[136:139], v[120:123]
    v_fma_f32 v221, v252, v233, v45
    v_mfma_f32_16x16x32_bf16 v[124:127], v[188:191], a[136:139], v[124:127]
    s_add_u32 m0, s30, 131072
    s_add_u32 s35, s31, 278528
    buffer_load_dwordx4 v3, s[12:15], s35 offen lds
    v_mfma_f32_16x16x32_bf16 v[128:131], v[184:187], a[140:143], v[128:131]
    v_fma_f32 v222, v252, v234, v46
    v_mfma_f32_16x16x32_bf16 v[132:135], v[188:191], a[140:143], v[132:135]
    v_fma_f32 v223, v252, v235, v47
    v_mfma_f32_16x16x32_bf16 v[104:107], v[192:195], a[144:147], v[104:107]
    ds_read_b128 v[184:187], v4 offset:24576
    ds_read_b128 v[188:191], v4 offset:25600
    v_mfma_f32_16x16x32_bf16 v[108:111], v[196:199], a[144:147], v[108:111]
    s_add_u32 m0, s30, 135168
    s_add_u32 s35, s31, 282624
    buffer_load_dwordx4 v3, s[12:15], s35 offen lds
    v_mfma_f32_16x16x32_bf16 v[112:115], v[192:195], a[148:151], v[112:115]
    v_mul_f32 v224, v216, v220
    v_mfma_f32_16x16x32_bf16 v[116:119], v[196:199], a[148:151], v[116:119]
    v_mul_f32 v225, v217, v221
    v_mfma_f32_16x16x32_bf16 v[120:123], v[192:195], a[152:155], v[120:123]
    v_mul_f32 v226, v218, v222
    v_mfma_f32_16x16x32_bf16 v[124:127], v[196:199], a[152:155], v[124:127]
    s_add_u32 m0, s30, 139264
    s_add_u32 s35, s31, 286720
    buffer_load_dwordx4 v3, s[12:15], s35 offen lds
    v_mfma_f32_16x16x32_bf16 v[128:131], v[192:195], a[156:159], v[128:131]
    v_mul_f32 v227, v219, v223
    v_mfma_f32_16x16x32_bf16 v[132:135], v[196:199], a[156:159], v[132:135]
    v_cvt_pk_bf16_f32 v200, v224, v225
    s_waitcnt lgkmcnt(4)
    v_mfma_f32_16x16x32_bf16 v[104:107], v[168:171], a[160:163], v[104:107]
    ds_read_b128 v[192:195], v4 offset:26624
    ds_read_b128 v[196:199], v4 offset:27648
    v_mfma_f32_16x16x32_bf16 v[108:111], v[172:175], a[160:163], v[108:111]
    s_add_u32 m0, s30, 143360
    s_add_u32 s35, s31, 290816
    buffer_load_dwordx4 v3, s[12:15], s35 offen lds
    v_mfma_f32_16x16x32_bf16 v[112:115], v[168:171], a[164:167], v[112:115]
    v_cvt_pk_bf16_f32 v201, v226, v227
    v_mfma_f32_16x16x32_bf16 v[116:119], v[172:175], a[164:167], v[116:119]
    v_fma_f32 v216, v253, v228, v48
    v_mfma_f32_16x16x32_bf16 v[120:123], v[168:171], a[168:171], v[120:123]
    v_fma_f32 v217, v253, v229, v49
    v_mfma_f32_16x16x32_bf16 v[124:127], v[172:175], a[168:171], v[124:127]
    s_waitcnt vmcnt(22)
    s_mov_b64 exec, 1
    v_mov_b32 v247, 1
    buffer_atomic_add v247, v246, s[68:71], s76 offen offset:0
    s_mov_b64 exec, -1
    v_mfma_f32_16x16x32_bf16 v[128:131], v[168:171], a[172:175], v[128:131]
    v_fma_f32 v218, v253, v230, v50
    v_mfma_f32_16x16x32_bf16 v[132:135], v[172:175], a[172:175], v[132:135]
    v_fma_f32 v219, v253, v231, v51
    s_waitcnt lgkmcnt(4)
    v_mfma_f32_16x16x32_bf16 v[104:107], v[176:179], a[176:179], v[104:107]
    ds_read_b128 v[168:171], v4 offset:28672
    ds_read_b128 v[172:175], v4 offset:29696
    v_mfma_f32_16x16x32_bf16 v[108:111], v[180:183], a[176:179], v[108:111]
    s_sub_u32 s31, s34, 294912
    v_mfma_f32_16x16x32_bf16 v[112:115], v[176:179], a[180:183], v[112:115]
    v_fma_f32 v220, v253, v232, v52
    v_mfma_f32_16x16x32_bf16 v[116:119], v[180:183], a[180:183], v[116:119]
    v_fma_f32 v221, v253, v233, v53
    v_mfma_f32_16x16x32_bf16 v[120:123], v[176:179], a[184:187], v[120:123]
    v_fma_f32 v222, v253, v234, v54
    v_mfma_f32_16x16x32_bf16 v[124:127], v[180:183], a[184:187], v[124:127]
    s_add_u32 m0, s30, 0
    s_add_u32 s35, s31, 294912
    buffer_load_dwordx4 v3, s[12:15], s35 offen lds
    v_mfma_f32_16x16x32_bf16 v[128:131], v[176:179], a[188:191], v[128:131]
    v_fma_f32 v223, v253, v235, v55
    v_mfma_f32_16x16x32_bf16 v[132:135], v[180:183], a[188:191], v[132:135]
    v_mul_f32 v224, v216, v220
    s_waitcnt lgkmcnt(4)
    v_mfma_f32_16x16x32_bf16 v[104:107], v[184:187], a[192:195], v[104:107]
    ds_read_b128 v[176:179], v4 offset:30720
    ds_read_b128 v[180:183], v4 offset:31744
    v_mfma_f32_16x16x32_bf16 v[108:111], v[188:191], a[192:195], v[108:111]
    s_add_u32 m0, s30, 4096
    s_add_u32 s35, s31, 299008
    buffer_load_dwordx4 v3, s[12:15], s35 offen lds
    v_mfma_f32_16x16x32_bf16 v[112:115], v[184:187], a[196:199], v[112:115]
    v_mul_f32 v225, v217, v221
    v_mfma_f32_16x16x32_bf16 v[116:119], v[188:191], a[196:199], v[116:119]
    v_mul_f32 v226, v218, v222
    v_mfma_f32_16x16x32_bf16 v[120:123], v[184:187], a[200:203], v[120:123]
    v_mul_f32 v227, v219, v223
    v_mfma_f32_16x16x32_bf16 v[124:127], v[188:191], a[200:203], v[124:127]
    s_add_u32 m0, s30, 8192
    s_add_u32 s35, s31, 303104
    buffer_load_dwordx4 v3, s[12:15], s35 offen lds
    v_mfma_f32_16x16x32_bf16 v[128:131], v[184:187], a[204:207], v[128:131]
    v_cvt_pk_bf16_f32 v204, v224, v225
    v_mfma_f32_16x16x32_bf16 v[132:135], v[188:191], a[204:207], v[132:135]
    v_cvt_pk_bf16_f32 v205, v226, v227
    s_waitcnt lgkmcnt(4)
    v_mfma_f32_16x16x32_bf16 v[104:107], v[192:195], a[208:211], v[104:107]
    ds_read_b128 v[184:187], v4 offset:32768
    ds_read_b128 v[188:191], v4 offset:33792
    v_mfma_f32_16x16x32_bf16 v[108:111], v[196:199], a[208:211], v[108:111]
    s_add_u32 m0, s30, 12288
    s_add_u32 s35, s31, 307200
    buffer_load_dwordx4 v3, s[12:15], s35 offen lds
    v_mfma_f32_16x16x32_bf16 v[112:115], v[192:195], a[212:215], v[112:115]
    v_fma_f32 v216, v254, v228, v56
    v_mfma_f32_16x16x32_bf16 v[116:119], v[196:199], a[212:215], v[116:119]
    v_fma_f32 v217, v254, v229, v57
    v_mfma_f32_16x16x32_bf16 v[120:123], v[192:195], a[216:219], v[120:123]
    v_fma_f32 v218, v254, v230, v58
    v_mfma_f32_16x16x32_bf16 v[124:127], v[196:199], a[216:219], v[124:127]
    s_add_u32 m0, s30, 16384
    s_add_u32 s35, s31, 311296
    buffer_load_dwordx4 v3, s[12:15], s35 offen lds
    v_mfma_f32_16x16x32_bf16 v[128:131], v[192:195], a[220:223], v[128:131]
    v_fma_f32 v219, v254, v231, v59
    v_mfma_f32_16x16x32_bf16 v[132:135], v[196:199], a[220:223], v[132:135]
    v_fma_f32 v220, v254, v232, v60
    s_waitcnt lgkmcnt(4)
    v_mfma_f32_16x16x32_bf16 v[104:107], v[168:171], a[224:227], v[104:107]
    ds_read_b128 v[192:195], v4 offset:34816
    ds_read_b128 v[196:199], v4 offset:35840
    v_mfma_f32_16x16x32_bf16 v[108:111], v[172:175], a[224:227], v[108:111]
    s_waitcnt vmcnt(15)
    s_mov_b64 exec, 1
    v_mov_b32 v247, 1
    buffer_atomic_add v247, v246, s[8:11], s61 offen offset:0
    s_mov_b64 exec, -1
    v_mfma_f32_16x16x32_bf16 v[112:115], v[168:171], a[228:231], v[112:115]
    v_fma_f32 v221, v254, v233, v61
    v_mfma_f32_16x16x32_bf16 v[116:119], v[172:175], a[228:231], v[116:119]
    v_fma_f32 v222, v254, v234, v62
    v_mfma_f32_16x16x32_bf16 v[120:123], v[168:171], a[232:235], v[120:123]
    v_fma_f32 v223, v254, v235, v63
    v_mfma_f32_16x16x32_bf16 v[124:127], v[172:175], a[232:235], v[124:127]
    v_mul_f32 v224, v216, v220
    v_mfma_f32_16x16x32_bf16 v[128:131], v[168:171], a[236:239], v[128:131]
    v_mul_f32 v225, v217, v221
    v_mfma_f32_16x16x32_bf16 v[132:135], v[172:175], a[236:239], v[132:135]
    v_mul_f32 v226, v218, v222
    s_waitcnt lgkmcnt(0)
    s_barrier
    v_mfma_f32_16x16x32_bf16 v[104:107], v[176:179], a[240:243], v[104:107]
    ds_read_b128 v[168:171], v5 offset:0
    ds_read_b128 v[172:175], v5 offset:1024
    v_mfma_f32_16x16x32_bf16 v[108:111], v[180:183], a[240:243], v[108:111]
    v_mul_f32 v227, v219, v223
    v_mfma_f32_16x16x32_bf16 v[112:115], v[176:179], a[244:247], v[112:115]
    v_cvt_pk_bf16_f32 v208, v224, v225
    v_mfma_f32_16x16x32_bf16 v[116:119], v[180:183], a[244:247], v[116:119]
    v_cvt_pk_bf16_f32 v209, v226, v227
    v_mfma_f32_16x16x32_bf16 v[120:123], v[176:179], a[248:251], v[120:123]
    v_fma_f32 v216, v255, v228, v64
    v_mfma_f32_16x16x32_bf16 v[124:127], v[180:183], a[248:251], v[124:127]
    v_fma_f32 v217, v255, v229, v65
    v_mfma_f32_16x16x32_bf16 v[128:131], v[176:179], a[252:255], v[128:131]
    v_fma_f32 v218, v255, v230, v66
    v_mfma_f32_16x16x32_bf16 v[132:135], v[180:183], a[252:255], v[132:135]
    v_fma_f32 v219, v255, v231, v67
    v_mfma_f32_16x16x32_bf16 v[104:107], v[184:187], v[8:11], v[104:107]
    ds_read_b128 v[176:179], v5 offset:2048
    ds_read_b128 v[180:183], v5 offset:3072
    v_mfma_f32_16x16x32_bf16 v[108:111], v[188:191], v[8:11], v[108:111]
    v_fma_f32 v220, v255, v232, v68
    v_mfma_f32_16x16x32_bf16 v[112:115], v[184:187], v[12:15], v[112:115]
    v_fma_f32 v221, v255, v233, v69
    v_mfma_f32_16x16x32_bf16 v[116:119], v[188:191], v[12:15], v[116:119]
L_pad_k3_kernel_4:
    s_cbranch_execz k3_kernel_end
    v_fma_f32 v222, v255, v234, v70
    v_mfma_f32_16x16x32_bf16 v[120:123], v[184:187], v[16:19], v[120:123]
    v_fma_f32 v223, v255, v235, v71
    v_mfma_f32_16x16x32_bf16 v[124:127], v[188:191], v[16:19], v[124:127]
    v_mul_f32 v224, v216, v220
    v_mfma_f32_16x16x32_bf16 v[128:131], v[184:187], v[20:23], v[128:131]
    v_mul_f32 v225, v217, v221
    v_mfma_f32_16x16x32_bf16 v[132:135], v[188:191], v[20:23], v[132:135]
    v_mul_f32 v226, v218, v222
    v_mfma_f32_16x16x32_bf16 v[104:107], v[192:195], v[24:27], v[104:107]
    ds_read_b128 v[184:187], v5 offset:4096
    ds_read_b128 v[188:191], v5 offset:5120
    v_mfma_f32_16x16x32_bf16 v[108:111], v[196:199], v[24:27], v[108:111]
    v_mul_f32 v227, v219, v223
    v_mfma_f32_16x16x32_bf16 v[112:115], v[192:195], v[28:31], v[112:115]
    v_cvt_pk_bf16_f32 v212, v224, v225
    v_mfma_f32_16x16x32_bf16 v[116:119], v[196:199], v[28:31], v[116:119]
    v_cvt_pk_bf16_f32 v213, v226, v227
    v_mfma_f32_16x16x32_bf16 v[120:123], v[192:195], v[32:35], v[120:123]
    v_mfma_f32_16x16x32_bf16 v[124:127], v[196:199], v[32:35], v[124:127]
    v_mfma_f32_16x16x32_bf16 v[128:131], v[192:195], v[36:39], v[128:131]
    v_mfma_f32_16x16x32_bf16 v[132:135], v[196:199], v[36:39], v[132:135]
    s_waitcnt lgkmcnt(4)
    v_mfma_f32_16x16x32_bf16 v[40:43], v[168:171], a[0:3], 0
    ds_read_b128 v[192:195], v5 offset:6144
    ds_read_b128 v[196:199], v5 offset:7168
    v_mfma_f32_16x16x32_bf16 v[44:47], v[172:175], a[0:3], 0
    s_add_u32 m0, s30, 20480
    s_add_u32 s35, s31, 315392
    buffer_load_dwordx4 v3, s[12:15], s35 offen lds
    v_mfma_f32_16x16x32_bf16 v[48:51], v[168:171], a[4:7], 0
    ds_read_b128 v[228:231], v7 offset:640
    v_mfma_f32_16x16x32_bf16 v[52:55], v[172:175], a[4:7], 0
    ds_read_b128 v[232:235], v7 offset:704
    v_mfma_f32_16x16x32_bf16 v[56:59], v[168:171], a[8:11], 0
    v_mfma_f32_16x16x32_bf16 v[60:63], v[172:175], a[8:11], 0
    v_mfma_f32_16x16x32_bf16 v[64:67], v[168:171], a[12:15], 0
    v_mfma_f32_16x16x32_bf16 v[68:71], v[172:175], a[12:15], 0
    s_waitcnt lgkmcnt(6)
    v_mfma_f32_16x16x32_bf16 v[40:43], v[176:179], a[16:19], v[40:43]
    ds_read_b128 v[168:171], v5 offset:8192
    ds_read_b128 v[172:175], v5 offset:9216
    v_mfma_f32_16x16x32_bf16 v[44:47], v[180:183], a[16:19], v[44:47]
    s_waitcnt lgkmcnt(2)
    v_fma_f32 v216, v252, v228, v104
    v_mfma_f32_16x16x32_bf16 v[48:51], v[176:179], a[20:23], v[48:51]
    v_fma_f32 v217, v252, v229, v105
    v_mfma_f32_16x16x32_bf16 v[52:55], v[180:183], a[20:23], v[52:55]
    v_fma_f32 v218, v252, v230, v106
    v_mfma_f32_16x16x32_bf16 v[56:59], v[176:179], a[24:27], v[56:59]
    s_add_u32 m0, s30, 24576
    s_add_u32 s35, s31, 319488
    buffer_load_dwordx4 v3, s[12:15], s35 offen lds
    v_mfma_f32_16x16x32_bf16 v[60:63], v[180:183], a[24:27], v[60:63]
    v_fma_f32 v219, v252, v231, v107
    v_mfma_f32_16x16x32_bf16 v[64:67], v[176:179], a[28:31], v[64:67]
    v_fma_f32 v220, v252, v232, v108
    v_mfma_f32_16x16x32_bf16 v[68:71], v[180:183], a[28:31], v[68:71]
    v_fma_f32 v221, v252, v233, v109
    v_mfma_f32_16x16x32_bf16 v[40:43], v[184:187], a[32:35], v[40:43]
    ds_read_b128 v[176:179], v5 offset:10240
    ds_read_b128 v[180:183], v5 offset:11264
    v_mfma_f32_16x16x32_bf16 v[44:47], v[188:191], a[32:35], v[44:47]
    v_fma_f32 v222, v252, v234, v110
    v_mfma_f32_16x16x32_bf16 v[48:51], v[184:187], a[36:39], v[48:51]
    v_fma_f32 v223, v252, v235, v111
    v_mfma_f32_16x16x32_bf16 v[52:55], v[188:191], a[36:39], v[52:55]
    v_mul_f32 v224, v216, v220
    v_mfma_f32_16x16x32_bf16 v[56:59], v[184:187], a[40:43], v[56:59]
    v_mul_f32 v225, v217, v221
    v_mfma_f32_16x16x32_bf16 v[60:63], v[188:191], a[40:43], v[60:63]
    v_mul_f32 v226, v218, v222
    v_mfma_f32_16x16x32_bf16 v[64:67], v[184:187], a[44:47], v[64:67]
    v_mul_f32 v227, v219, v223
    v_mfma_f32_16x16x32_bf16 v[68:71], v[188:191], a[44:47], v[68:71]
    s_add_u32 m0, s30, 28672
    s_add_u32 s35, s31, 323584
    buffer_load_dwordx4 v3, s[12:15], s35 offen lds
    v_mfma_f32_16x16x32_bf16 v[40:43], v[192:195], a[48:51], v[40:43]
    ds_read_b128 v[184:187], v5 offset:12288
    ds_read_b128 v[188:191], v5 offset:13312
    v_mfma_f32_16x16x32_bf16 v[44:47], v[196:199], a[48:51], v[44:47]
    v_cvt_pk_bf16_f32 v202, v224, v225
    v_mfma_f32_16x16x32_bf16 v[48:51], v[192:195], a[52:55], v[48:51]
    v_cvt_pk_bf16_f32 v203, v226, v227
    v_mfma_f32_16x16x32_bf16 v[52:55], v[196:199], a[52:55], v[52:55]
    v_fma_f32 v216, v253, v228, v112
    v_mfma_f32_16x16x32_bf16 v[56:59], v[192:195], a[56:59], v[56:59]
    v_fma_f32 v217, v253, v229, v113
    v_mfma_f32_16x16x32_bf16 v[60:63], v[196:199], a[56:59], v[60:63]
    v_fma_f32 v218, v253, v230, v114
    v_mfma_f32_16x16x32_bf16 v[64:67], v[192:195], a[60:63], v[64:67]
    v_fma_f32 v219, v253, v231, v115
    v_mfma_f32_16x16x32_bf16 v[68:71], v[196:199], a[60:63], v[68:71]
    v_fma_f32 v220, v253, v232, v116
    s_waitcnt lgkmcnt(4)
    v_mfma_f32_16x16x32_bf16 v[40:43], v[168:171], a[64:67], v[40:43]
    ds_read_b128 v[192:195], v5 offset:14336
    ds_read_b128 v[196:199], v5 offset:15360
    v_mfma_f32_16x16x32_bf16 v[44:47], v[172:175], a[64:67], v[44:47]
    v_fma_f32 v221, v253, v233, v117
    v_mfma_f32_16x16x32_bf16 v[48:51], v[168:171], a[68:71], v[48:51]
    s_add_u32 m0, s30, 32768
    s_add_u32 s35, s31, 327680
    buffer_load_dwordx4 v3, s[12:15], s35 offen lds
    v_mfma_f32_16x16x32_bf16 v[52:55], v[172:175], a[68:71], v[52:55]
    v_fma_f32 v222, v253, v234, v118
    v_mfma_f32_16x16x32_bf16 v[56:59], v[168:171], a[72:75], v[56:59]
    v_fma_f32 v223, v253, v235, v119
    v_mfma_f32_16x16x32_bf16 v[60:63], v[172:175], a[72:75], v[60:63]
    v_mul_f32 v224, v216, v220
    v_mfma_f32_16x16x32_bf16 v[64:67], v[168:171], a[76:79], v[64:67]
    v_mul_f32 v225, v217, v221
    v_mfma_f32_16x16x32_bf16 v[68:71], v[172:175], a[76:79], v[68:71]
    v_mul_f32 v226, v218, v222
    s_waitcnt lgkmcnt(4)
    v_mfma_f32_16x16x32_bf16 v[40:43], v[176:179], a[80:83], v[40:43]
    ds_read_b128 v[168:171], v5 offset:16384
    ds_read_b128 v[172:175], v5 offset:17408
    v_mfma_f32_16x16x32_bf16 v[44:47], v[180:183], a[80:83], v[44:47]
    v_mul_f32 v227, v219, v223
    v_mfma_f32_16x16x32_bf16 v[48:51], v[176:179], a[84:87], v[48:51]
    v_cvt_pk_bf16_f32 v206, v224, v225
    v_mfma_f32_16x16x32_bf16 v[52:55], v[180:183], a[84:87], v[52:55]
    v_cvt_pk_bf16_f32 v207, v226, v227
    v_mfma_f32_16x16x32_bf16 v[56:59], v[176:179], a[88:91], v[56:59]
    v_fma_f32 v216, v254, v228, v120
    v_mfma_f32_16x16x32_bf16 v[60:63], v[180:183], a[88:91], v[60:63]
    buffer_load_dword v236, v246, s[16:19], s26 offen
    v_mfma_f32_16x16x32_bf16 v[64:67], v[176:179], a[92:95], v[64:67]
    v_fma_f32 v217, v254, v229, v121
    v_mfma_f32_16x16x32_bf16 v[68:71], v[180:183], a[92:95], v[68:71]
    v_fma_f32 v218, v254, v230, v122
    s_waitcnt lgkmcnt(4)
    v_mfma_f32_16x16x32_bf16 v[40:43], v[184:187], a[96:99], v[40:43]
    ds_read_b128 v[176:179], v5 offset:18432
    ds_read_b128 v[180:183], v5 offset:19456
    v_mfma_f32_16x16x32_bf16 v[44:47], v[188:191], a[96:99], v[44:47]
    v_fma_f32 v219, v254, v231, v123
    v_mfma_f32_16x16x32_bf16 v[48:51], v[184:187], a[100:103], v[48:51]
    v_fma_f32 v220, v254, v232, v124
    v_mfma_f32_16x16x32_bf16 v[52:55], v[188:191], a[100:103], v[52:55]
    v_fma_f32 v221, v254, v233, v125
    v_mfma_f32_16x16x32_bf16 v[56:59], v[184:187], a[104:107], v[56:59]
    v_fma_f32 v222, v254, v234, v126
    v_mfma_f32_16x16x32_bf16 v[60:63], v[188:191], a[104:107], v[60:63]
    v_fma_f32 v223, v254, v235, v127
    v_mfma_f32_16x16x32_bf16 v[64:67], v[184:187], a[108:111], v[64:67]
    v_mul_f32 v224, v216, v220
    v_mfma_f32_16x16x32_bf16 v[68:71], v[188:191], a[108:111], v[68:71]
    v_mul_f32 v225, v217, v221
    s_waitcnt lgkmcnt(4)
    v_mfma_f32_16x16x32_bf16 v[40:43], v[192:195], a[112:115], v[40:43]
    ds_read_b128 v[184:187], v5 offset:20480
    ds_read_b128 v[188:191], v5 offset:21504
    v_mfma_f32_16x16x32_bf16 v[44:47], v[196:199], a[112:115], v[44:47]
    buffer_store_dwordx4 v[200:203], v3, s[8:11], s36 offen sc1
    s_add_u32 s36, s36, 1024
    v_mfma_f32_16x16x32_bf16 v[48:51], v[192:195], a[116:119], v[48:51]
    v_mul_f32 v226, v218, v222
    v_mfma_f32_16x16x32_bf16 v[52:55], v[196:199], a[116:119], v[52:55]
    v_mul_f32 v227, v219, v223
    v_mfma_f32_16x16x32_bf16 v[56:59], v[192:195], a[120:123], v[56:59]
    v_cvt_pk_bf16_f32 v210, v224, v225
    v_mfma_f32_16x16x32_bf16 v[60:63], v[196:199], a[120:123], v[60:63]
    v_cvt_pk_bf16_f32 v211, v226, v227
    v_mfma_f32_16x16x32_bf16 v[64:67], v[192:195], a[124:127], v[64:67]
    v_fma_f32 v216, v255, v228, v128
    v_mfma_f32_16x16x32_bf16 v[68:71], v[196:199], a[124:127], v[68:71]
    v_fma_f32 v217, v255, v229, v129
    s_waitcnt lgkmcnt(4)
    v_mfma_f32_16x16x32_bf16 v[40:43], v[168:171], a[128:131], v[40:43]
    ds_read_b128 v[192:195], v5 offset:22528
    ds_read_b128 v[196:199], v5 offset:23552
    v_mfma_f32_16x16x32_bf16 v[44:47], v[172:175], a[128:131], v[44:47]
    v_fma_f32 v218, v255, v230, v130
    v_mfma_f32_16x16x32_bf16 v[48:51], v[168:171], a[132:135], v[48:51]
    v_fma_f32 v219, v255, v231, v131
    v_mfma_f32_16x16x32_bf16 v[52:55], v[172:175], a[132:135], v[52:55]
    v_fma_f32 v220, v255, v232, v132
    v_mfma_f32_16x16x32_bf16 v[56:59], v[168:171], a[136:139], v[56:59]
    buffer_store_dwordx4 v[204:207], v3, s[8:11], s37 offen sc1
    s_add_u32 s37, s37, 1024
    v_mfma_f32_16x16x32_bf16 v[60:63], v[172:175], a[136:139], v[60:63]
    v_fma_f32 v221, v255, v233, v133
    v_mfma_f32_16x16x32_bf16 v[64:67], v[168:171], a[140:143], v[64:67]
    v_fma_f32 v222, v255, v234, v134
    v_mfma_f32_16x16x32_bf16 v[68:71], v[172:175], a[140:143], v[68:71]
    v_fma_f32 v223, v255, v235, v135
    s_waitcnt lgkmcnt(4)
    v_mfma_f32_16x16x32_bf16 v[40:43], v[176:179], a[144:147], v[40:43]
    ds_read_b128 v[168:171], v5 offset:24576
    ds_read_b128 v[172:175], v5 offset:25600
    v_mfma_f32_16x16x32_bf16 v[44:47], v[180:183], a[144:147], v[44:47]
    v_mul_f32 v224, v216, v220
    v_mfma_f32_16x16x32_bf16 v[48:51], v[176:179], a[148:151], v[48:51]
    v_mul_f32 v225, v217, v221
    v_mfma_f32_16x16x32_bf16 v[52:55], v[180:183], a[148:151], v[52:55]
    v_mul_f32 v226, v218, v222
    v_mfma_f32_16x16x32_bf16 v[56:59], v[176:179], a[152:155], v[56:59]
    v_mul_f32 v227, v219, v223
    v_mfma_f32_16x16x32_bf16 v[60:63], v[180:183], a[152:155], v[60:63]
    v_cvt_pk_bf16_f32 v214, v224, v225
    v_mfma_f32_16x16x32_bf16 v[64:67], v[176:179], a[156:159], v[64:67]
    v_cvt_pk_bf16_f32 v215, v226, v227
    v_mfma_f32_16x16x32_bf16 v[68:71], v[180:183], a[156:159], v[68:71]
    buffer_store_dwordx4 v[208:211], v3, s[8:11], s38 offen sc1
    s_add_u32 s38, s38, 1024
    s_waitcnt lgkmcnt(4)
    v_mfma_f32_16x16x32_bf16 v[40:43], v[184:187], a[160:163], v[40:43]
    ds_read_b128 v[176:179], v5 offset:26624
    ds_read_b128 v[180:183], v5 offset:27648
    v_mfma_f32_16x16x32_bf16 v[44:47], v[188:191], a[160:163], v[44:47]
    v_mfma_f32_16x16x32_bf16 v[48:51], v[184:187], a[164:167], v[48:51]
    v_mfma_f32_16x16x32_bf16 v[52:55], v[188:191], a[164:167], v[52:55]
    v_mfma_f32_16x16x32_bf16 v[56:59], v[184:187], a[168:171], v[56:59]
    v_mfma_f32_16x16x32_bf16 v[60:63], v[188:191], a[168:171], v[60:63]
    v_mfma_f32_16x16x32_bf16 v[64:67], v[184:187], a[172:175], v[64:67]
    v_mfma_f32_16x16x32_bf16 v[68:71], v[188:191], a[172:175], v[68:71]
    s_waitcnt lgkmcnt(4)
    v_mfma_f32_16x16x32_bf16 v[40:43], v[192:195], a[176:179], v[40:43]
    ds_read_b128 v[184:187], v5 offset:28672
    ds_read_b128 v[188:191], v5 offset:29696
    v_mfma_f32_16x16x32_bf16 v[44:47], v[196:199], a[176:179], v[44:47]
    v_mfma_f32_16x16x32_bf16 v[48:51], v[192:195], a[180:183], v[48:51]
    buffer_store_dwordx4 v[212:215], v3, s[8:11], s39 offen sc1
    s_add_u32 s39, s39, 1024
    v_mfma_f32_16x16x32_bf16 v[52:55], v[196:199], a[180:183], v[52:55]
    v_mfma_f32_16x16x32_bf16 v[56:59], v[192:195], a[184:187], v[56:59]
    v_mfma_f32_16x16x32_bf16 v[60:63], v[196:199], a[184:187], v[60:63]
    v_mfma_f32_16x16x32_bf16 v[64:67], v[192:195], a[188:191], v[64:67]
    v_mfma_f32_16x16x32_bf16 v[68:71], v[196:199], a[188:191], v[68:71]
    s_waitcnt lgkmcnt(4)
    v_mfma_f32_16x16x32_bf16 v[40:43], v[168:171], a[192:195], v[40:43]
    ds_read_b128 v[192:195], v5 offset:30720
    ds_read_b128 v[196:199], v5 offset:31744
    v_mfma_f32_16x16x32_bf16 v[44:47], v[172:175], a[192:195], v[44:47]
    v_mfma_f32_16x16x32_bf16 v[48:51], v[168:171], a[196:199], v[48:51]
    v_mfma_f32_16x16x32_bf16 v[52:55], v[172:175], a[196:199], v[52:55]
    v_mfma_f32_16x16x32_bf16 v[56:59], v[168:171], a[200:203], v[56:59]
    v_mfma_f32_16x16x32_bf16 v[60:63], v[172:175], a[200:203], v[60:63]
    buffer_load_dword v248, v251, s[8:11], s66 offen offset:0 sc1
    v_mfma_f32_16x16x32_bf16 v[64:67], v[168:171], a[204:207], v[64:67]
    v_mfma_f32_16x16x32_bf16 v[68:71], v[172:175], a[204:207], v[68:71]
    s_waitcnt lgkmcnt(4)
    v_mfma_f32_16x16x32_bf16 v[40:43], v[176:179], a[208:211], v[40:43]
    ds_read_b128 v[168:171], v5 offset:32768
    ds_read_b128 v[172:175], v5 offset:33792
    v_mfma_f32_16x16x32_bf16 v[44:47], v[180:183], a[208:211], v[44:47]
    v_mfma_f32_16x16x32_bf16 v[48:51], v[176:179], a[212:215], v[48:51]
    v_mfma_f32_16x16x32_bf16 v[52:55], v[180:183], a[212:215], v[52:55]
    v_mfma_f32_16x16x32_bf16 v[56:59], v[176:179], a[216:219], v[56:59]
    v_mfma_f32_16x16x32_bf16 v[60:63], v[180:183], a[216:219], v[60:63]
    v_mfma_f32_16x16x32_bf16 v[64:67], v[176:179], a[220:223], v[64:67]
    v_mfma_f32_16x16x32_bf16 v[68:71], v[180:183], a[220:223], v[68:71]
    s_waitcnt lgkmcnt(4)
    v_mfma_f32_16x16x32_bf16 v[40:43], v[184:187], a[224:227], v[40:43]
    ds_read_b128 v[176:179], v5 offset:34816
    ds_read_b128 v[180:183], v5 offset:35840
    v_mfma_f32_16x16x32_bf16 v[44:47], v[188:191], a[224:227], v[44:47]
    v_mfma_f32_16x16x32_bf16 v[48:51], v[184:187], a[228:231], v[48:51]
    v_mfma_f32_16x16x32_bf16 v[52:55], v[188:191], a[228:231], v[52:55]
    v_mfma_f32_16x16x32_bf16 v[56:59], v[184:187], a[232:235], v[56:59]
    v_mfma_f32_16x16x32_bf16 v[60:63], v[188:191], a[232:235], v[60:63]
    v_mfma_f32_16x16x32_bf16 v[64:67], v[184:187], a[236:239], v[64:67]
    v_mfma_f32_16x16x32_bf16 v[68:71], v[188:191], a[236:239], v[68:71]
    s_waitcnt lgkmcnt(0)
    s_waitcnt vmcnt(17)
    s_barrier
    v_mfma_f32_16x16x32_bf16 v[40:43], v[192:195], a[240:243], v[40:43]
    ds_read_b128 v[184:187], v6 offset:0
    ds_read_b128 v[188:191], v6 offset:1024
    v_mfma_f32_16x16x32_bf16 v[44:47], v[196:199], a[240:243], v[44:47]
    v_mfma_f32_16x16x32_bf16 v[48:51], v[192:195], a[244:247], v[48:51]
    v_mfma_f32_16x16x32_bf16 v[52:55], v[196:199], a[244:247], v[52:55]
    v_mfma_f32_16x16x32_bf16 v[56:59], v[192:195], a[248:251], v[56:59]
    v_mfma_f32_16x16x32_bf16 v[60:63], v[196:199], a[248:251], v[60:63]
    v_mfma_f32_16x16x32_bf16 v[64:67], v[192:195], a[252:255], v[64:67]
    v_mfma_f32_16x16x32_bf16 v[68:71], v[196:199], a[252:255], v[68:71]
    v_mfma_f32_16x16x32_bf16 v[40:43], v[168:171], v[8:11], v[40:43]
    ds_read_b128 v[192:195], v6 offset:2048
    ds_read_b128 v[196:199], v6 offset:3072
    v_mfma_f32_16x16x32_bf16 v[44:47], v[172:175], v[8:11], v[44:47]
    v_mfma_f32_16x16x32_bf16 v[48:51], v[168:171], v[12:15], v[48:51]
    v_mfma_f32_16x16x32_bf16 v[52:55], v[172:175], v[12:15], v[52:55]
    v_mfma_f32_16x16x32_bf16 v[56:59], v[168:171], v[16:19], v[56:59]
    v_mfma_f32_16x16x32_bf16 v[60:63], v[172:175], v[16:19], v[60:63]
    v_mfma_f32_16x16x32_bf16 v[64:67], v[168:171], v[20:23], v[64:67]
    v_mfma_f32_16x16x32_bf16 v[68:71], v[172:175], v[20:23], v[68:71]
    v_mfma_f32_16x16x32_bf16 v[40:43], v[176:179], v[24:27], v[40:43]
    ds_read_b128 v[168:171], v6 offset:4096
    ds_read_b128 v[172:175], v6 offset:5120
    v_mfma_f32_16x16x32_bf16 v[44:47], v[180:183], v[24:27], v[44:47]
    v_mfma_f32_16x16x32_bf16 v[48:51], v[176:179], v[28:31], v[48:51]
    v_mfma_f32_16x16x32_bf16 v[52:55], v[180:183], v[28:31], v[52:55]
    v_mfma_f32_16x16x32_bf16 v[56:59], v[176:179], v[32:35], v[56:59]
    v_mfma_f32_16x16x32_bf16 v[60:63], v[180:183], v[32:35], v[60:63]
    v_mfma_f32_16x16x32_bf16 v[64:67], v[176:179], v[36:39], v[64:67]
    v_mfma_f32_16x16x32_bf16 v[68:71], v[180:183], v[36:39], v[68:71]
    s_waitcnt lgkmcnt(4)
    v_mfma_f32_16x16x32_bf16 v[136:139], v[184:187], a[0:3], 0
    ds_read_b128 v[176:179], v6 offset:6144
    ds_read_b128 v[180:183], v6 offset:7168
    v_mfma_f32_16x16x32_bf16 v[140:143], v[188:191], a[0:3], 0
    v_mfma_f32_16x16x32_bf16 v[144:147], v[184:187], a[4:7], 0
    ds_read_b128 v[228:231], v7 offset:768
    v_mfma_f32_16x16x32_bf16 v[148:151], v[188:191], a[4:7], 0
    ds_read_b128 v[232:235], v7 offset:832
    v_mfma_f32_16x16x32_bf16 v[152:155], v[184:187], a[8:11], 0
    v_mfma_f32_16x16x32_bf16 v[156:159], v[188:191], a[8:11], 0
    v_mfma_f32_16x16x32_bf16 v[160:163], v[184:187], a[12:15], 0
    v_mfma_f32_16x16x32_bf16 v[164:167], v[188:191], a[12:15], 0
    s_waitcnt lgkmcnt(6)
    v_mfma_f32_16x16x32_bf16 v[136:139], v[192:195], a[16:19], v[136:139]
    ds_read_b128 v[184:187], v6 offset:8192
    ds_read_b128 v[188:191], v6 offset:9216
    v_mfma_f32_16x16x32_bf16 v[140:143], v[196:199], a[16:19], v[140:143]
    v_mfma_f32_16x16x32_bf16 v[144:147], v[192:195], a[20:23], v[144:147]
    v_mfma_f32_16x16x32_bf16 v[148:151], v[196:199], a[20:23], v[148:151]
    s_waitcnt lgkmcnt(2)
    v_fma_f32 v216, v252, v228, v40
    v_mfma_f32_16x16x32_bf16 v[152:155], v[192:195], a[24:27], v[152:155]
    v_fma_f32 v217, v252, v229, v41
    v_mfma_f32_16x16x32_bf16 v[156:159], v[196:199], a[24:27], v[156:159]
    s_waitcnt vmcnt(0)
    v_cmp_ne_u32 vcc, 18, v248
    s_nop 0
    s_cmp_eq_u64 vcc, 0
    s_cbranch_scc0 k3_kernel_slowW
k3_kernel_backW:
    v_mfma_f32_16x16x32_bf16 v[160:163], v[192:195], a[28:31], v[160:163]
    v_fma_f32 v218, v252, v230, v42
    v_mfma_f32_16x16x32_bf16 v[164:167], v[196:199], a[28:31], v[164:167]
    v_fma_f32 v219, v252, v231, v43
    v_mfma_f32_16x16x32_bf16 v[136:139], v[168:171], a[32:35], v[136:139]
    ds_read_b128 v[192:195], v6 offset:10240
    ds_read_b128 v[196:199], v6 offset:11264
    v_mfma_f32_16x16x32_bf16 v[140:143], v[172:175], a[32:35], v[140:143]
    buffer_load_dword v248, v246, s[8:11], s62 offen offset:0 sc1
    v_mfma_f32_16x16x32_bf16 v[144:147], v[168:171], a[36:39], v[144:147]
    v_fma_f32 v220, v252, v232, v44
    v_mfma_f32_16x16x32_bf16 v[148:151], v[172:175], a[36:39], v[148:151]
    v_fma_f32 v221, v252, v233, v45
    v_mfma_f32_16x16x32_bf16 v[152:155], v[168:171], a[40:43], v[152:155]
    v_fma_f32 v222, v252, v234, v46
    v_mfma_f32_16x16x32_bf16 v[156:159], v[172:175], a[40:43], v[156:159]
    s_add_u32 m0, s29, 36864
    s_add_u32 s28, s27, 0
    buffer_load_dwordx4 v3, s[8:11], s28 offen offset:0 sc1 lds
    v_mfma_f32_16x16x32_bf16 v[160:163], v[168:171], a[44:47], v[160:163]
    v_fma_f32 v223, v252, v235, v47
    v_mfma_f32_16x16x32_bf16 v[164:167], v[172:175], a[44:47], v[164:167]
    v_mul_f32 v224, v216, v220
    v_mfma_f32_16x16x32_bf16 v[136:139], v[176:179], a[48:51], v[136:139]
    ds_read_b128 v[168:171], v6 offset:12288
    ds_read_b128 v[172:175], v6 offset:13312
    v_mfma_f32_16x16x32_bf16 v[140:143], v[180:183], a[48:51], v[140:143]
    buffer_load_dwordx4 v3, s[8:11], s28 offen offset:1024 sc1 lds
    v_mfma_f32_16x16x32_bf16 v[144:147], v[176:179], a[52:55], v[144:147]
    v_mul_f32 v225, v217, v221
    v_mfma_f32_16x16x32_bf16 v[148:151], v[180:183], a[52:55], v[148:151]
    v_mul_f32 v226, v218, v222
    v_mfma_f32_16x16x32_bf16 v[152:155], v[176:179], a[56:59], v[152:155]
    v_mul_f32 v227, v219, v223
    v_mfma_f32_16x16x32_bf16 v[156:159], v[180:183], a[56:59], v[156:159]
    buffer_load_dwordx4 v3, s[8:11], s28 offen offset:2048 sc1 lds
    v_mfma_f32_16x16x32_bf16 v[160:163], v[176:179], a[60:63], v[160:163]
    v_cvt_pk_bf16_f32 v200, v224, v225
    v_mfma_f32_16x16x32_bf16 v[164:167], v[180:183], a[60:63], v[164:167]
    v_cvt_pk_bf16_f32 v201, v226, v227
    s_waitcnt lgkmcnt(4)
    v_mfma_f32_16x16x32_bf16 v[136:139], v[184:187], a[64:67], v[136:139]
    ds_read_b128 v[176:179], v6 offset:14336
    ds_read_b128 v[180:183], v6 offset:15360
    v_mfma_f32_16x16x32_bf16 v[140:143], v[188:191], a[64:67], v[140:143]
    buffer_load_dwordx4 v3, s[8:11], s28 offen offset:3072 sc1 lds
    v_mfma_f32_16x16x32_bf16 v[144:147], v[184:187], a[68:71], v[144:147]
    v_fma_f32 v216, v253, v228, v48
    v_mfma_f32_16x16x32_bf16 v[148:151], v[188:191], a[68:71], v[148:151]
    v_fma_f32 v217, v253, v229, v49
    v_mfma_f32_16x16x32_bf16 v[152:155], v[184:187], a[72:75], v[152:155]
    v_fma_f32 v218, v253, v230, v50
    v_mfma_f32_16x16x32_bf16 v[156:159], v[188:191], a[72:75], v[156:159]
    s_add_u32 m0, s29, 40960
    s_add_u32 s28, s27, 4096
    buffer_load_dwordx4 v3, s[8:11], s28 offen offset:0 sc1 lds
    v_mfma_f32_16x16x32_bf16 v[160:163], v[184:187], a[76:79], v[160:163]
    v_fma_f32 v219, v253, v231, v51
    v_mfma_f32_16x16x32_bf16 v[164:167], v[188:191], a[76:79], v[164:167]
    v_fma_f32 v220, v253, v232, v52
    s_waitcnt lgkmcnt(4)
    v_mfma_f32_16x16x32_bf16 v[136:139], v[192:195], a[80:83], v[136:139]
    ds_read_b128 v[184:187], v6 offset:16384
    ds_read_b128 v[188:191], v6 offset:17408
    v_mfma_f32_16x16x32_bf16 v[140:143], v[196:199], a[80:83], v[140:143]
    buffer_load_dwordx4 v3, s[8:11], s28 offen offset:1024 sc1 lds
    v_mfma_f32_16x16x32_bf16 v[144:147], v[192:195], a[84:87], v[144:147]
    v_fma_f32 v221, v253, v233, v53
    v_mfma_f32_16x16x32_bf16 v[148:151], v[196:199], a[84:87], v[148:151]
    v_fma_f32 v222, v253, v234, v54
    v_mfma_f32_16x16x32_bf16 v[152:155], v[192:195], a[88:91], v[152:155]
    v_fma_f32 v223, v253, v235, v55
    v_mfma_f32_16x16x32_bf16 v[156:159], v[196:199], a[88:91], v[156:159]
    buffer_load_dwordx4 v3, s[8:11], s28 offen offset:2048 sc1 lds
    v_mfma_f32_16x16x32_bf16 v[160:163], v[192:195], a[92:95], v[160:163]
    v_mul_f32 v224, v216, v220
    v_mfma_f32_16x16x32_bf16 v[164:167], v[196:199], a[92:95], v[164:167]
    v_mul_f32 v225, v217, v221
    s_waitcnt lgkmcnt(4)
    v_mfma_f32_16x16x32_bf16 v[136:139], v[168:171], a[96:99], v[136:139]
    ds_read_b128 v[192:195], v6 offset:18432
    ds_read_b128 v[196:199], v6 offset:19456
    v_mfma_f32_16x16x32_bf16 v[140:143], v[172:175], a[96:99], v[140:143]
    buffer_load_dwordx4 v3, s[8:11], s28 offen offset:3072 sc1 lds
    v_mfma_f32_16x16x32_bf16 v[144:147], v[168:171], a[100:103], v[144:147]
    v_mul_f32 v226, v218, v222
    v_mfma_f32_16x16x32_bf16 v[148:151], v[172:175], a[100:103], v[148:151]
    v_mul_f32 v227, v219, v223
    v_mfma_f32_16x16x32_bf16 v[152:155], v[168:171], a[104:107], v[152:155]
    v_cvt_pk_bf16_f32 v204, v224, v225
    v_mfma_f32_16x16x32_bf16 v[156:159], v[172:175], a[104:107], v[156:159]
    s_add_u32 m0, s29, 45056
    s_add_u32 s28, s27, 8192
    buffer_load_dwordx4 v3, s[8:11], s28 offen offset:0 sc1 lds
    v_mfma_f32_16x16x32_bf16 v[160:163], v[168:171], a[108:111], v[160:163]
    v_cvt_pk_bf16_f32 v205, v226, v227
    v_mfma_f32_16x16x32_bf16 v[164:167], v[172:175], a[108:111], v[164:167]
    v_fma_f32 v216, v254, v228, v56
    s_waitcnt lgkmcnt(4)
    v_mfma_f32_16x16x32_bf16 v[136:139], v[176:179], a[112:115], v[136:139]
    ds_read_b128 v[168:171], v6 offset:20480
    ds_read_b128 v[172:175], v6 offset:21504
    v_mfma_f32_16x16x32_bf16 v[140:143], v[180:183], a[112:115], v[140:143]
    s_mov_b64 exec, 1
    v_mov_b32 v247, 16
    buffer_atomic_add v247, v246, s[8:11], s61 offen offset:128
    s_mov_b64 exec, -1
    v_mfma_f32_16x16x32_bf16 v[144:147], v[176:179], a[116:119], v[144:147]
    v_fma_f32 v217, v254, v229, v57
    v_mfma_f32_16x16x32_bf16 v[148:151], v[180:183], a[116:119], v[148:151]
    v_fma_f32 v218, v254, v230, v58
    v_mfma_f32_16x16x32_bf16 v[152:155], v[176:179], a[120:123], v[152:155]
    v_fma_f32 v219, v254, v231, v59
    v_mfma_f32_16x16x32_bf16 v[156:159], v[180:183], a[120:123], v[156:159]
    s_waitcnt vmcnt(10)
    v_readfirstlane_b32 s64, v248
    s_nop 0
    s_bitcmp1_b32 s64, 3
    s_cbranch_scc0 k3_kernel_slowA
k3_kernel_backA:
    v_mfma_f32_16x16x32_bf16 v[160:163], v[176:179], a[124:127], v[160:163]
    v_fma_f32 v220, v254, v232, v60
    v_mfma_f32_16x16x32_bf16 v[164:167], v[180:183], a[124:127], v[164:167]
    v_fma_f32 v221, v254, v233, v61
    s_waitcnt lgkmcnt(4)
    v_mfma_f32_16x16x32_bf16 v[136:139], v[184:187], a[128:131], v[136:139]
    ds_read_b128 v[176:179], v6 offset:22528
    ds_read_b128 v[180:183], v6 offset:23552
    v_mfma_f32_16x16x32_bf16 v[140:143], v[188:191], a[128:131], v[140:143]
    s_add_u32 m0, s29, 73728
    s_add_u32 s28, s27, 36864
    buffer_load_dwordx4 v3, s[8:11], s28 offen offset:0 sc1 lds
    v_mfma_f32_16x16x32_bf16 v[144:147], v[184:187], a[132:135], v[144:147]
    v_fma_f32 v222, v254, v234, v62
    v_mfma_f32_16x16x32_bf16 v[148:151], v[188:191], a[132:135], v[148:151]
    v_fma_f32 v223, v254, v235, v63
    v_mfma_f32_16x16x32_bf16 v[152:155], v[184:187], a[136:139], v[152:155]
    v_mul_f32 v224, v216, v220
    v_mfma_f32_16x16x32_bf16 v[156:159], v[188:191], a[136:139], v[156:159]
    buffer_load_dwordx4 v3, s[8:11], s28 offen offset:1024 sc1 lds
    v_mfma_f32_16x16x32_bf16 v[160:163], v[184:187], a[140:143], v[160:163]
    v_mul_f32 v225, v217, v221
    v_mfma_f32_16x16x32_bf16 v[164:167], v[188:191], a[140:143], v[164:167]
    v_mul_f32 v226, v218, v222
    s_waitcnt lgkmcnt(4)
    v_mfma_f32_16x16x32_bf16 v[136:139], v[192:195], a[144:147], v[136:139]
    ds_read_b128 v[184:187], v6 offset:24576
    ds_read_b128 v[188:191], v6 offset:25600
    v_mfma_f32_16x16x32_bf16 v[140:143], v[196:199], a[144:147], v[140:143]
    buffer_load_dwordx4 v3, s[8:11], s28 offen offset:2048 sc1 lds
    v_mfma_f32_16x16x32_bf16 v[144:147], v[192:195], a[148:151], v[144:147]
    v_mul_f32 v227, v219, v223
    v_mfma_f32_16x16x32_bf16 v[148:151], v[196:199], a[148:151], v[148:151]
    v_cvt_pk_bf16_f32 v208, v224, v225
    v_mfma_f32_16x16x32_bf16 v[152:155], v[192:195], a[152:155], v[152:155]
    v_cvt_pk_bf16_f32 v209, v226, v227
    v_mfma_f32_16x16x32_bf16 v[156:159], v[196:199], a[152:155], v[156:159]
    buffer_load_dwordx4 v3, s[8:11], s28 offen offset:3072 sc1 lds
    v_mfma_f32_16x16x32_bf16 v[160:163], v[192:195], a[156:159], v[160:163]
    v_fma_f32 v216, v255, v228, v64
    v_mfma_f32_16x16x32_bf16 v[164:167], v[196:199], a[156:159], v[164:167]
    v_fma_f32 v217, v255, v229, v65
    s_waitcnt lgkmcnt(4)
    v_mfma_f32_16x16x32_bf16 v[136:139], v[168:171], a[160:163], v[136:139]
    ds_read_b128 v[192:195], v6 offset:26624
    ds_read_b128 v[196:199], v6 offset:27648
    v_mfma_f32_16x16x32_bf16 v[140:143], v[172:175], a[160:163], v[140:143]
    s_add_u32 m0, s29, 77824
    s_add_u32 s28, s27, 40960
    buffer_load_dwordx4 v3, s[8:11], s28 offen offset:0 sc1 lds
    v_mfma_f32_16x16x32_bf16 v[144:147], v[168:171], a[164:167], v[144:147]
    v_fma_f32 v218, v255, v230, v66
    v_mfma_f32_16x16x32_bf16 v[148:151], v[172:175], a[164:167], v[148:151]
    v_fma_f32 v219, v255, v231, v67
    v_mfma_f32_16x16x32_bf16 v[152:155], v[168:171], a[168:171], v[152:155]
    v_fma_f32 v220, v255, v232, v68
    v_mfma_f32_16x16x32_bf16 v[156:159], v[172:175], a[168:171], v[156:159]
    buffer_load_dwordx4 v3, s[8:11], s28 offen offset:1024 sc1 lds
    v_mfma_f32_16x16x32_bf16 v[160:163], v[168:171], a[172:175], v[160:163]
    v_fma_f32 v221, v255, v233, v69
    v_mfma_f32_16x16x32_bf16 v[164:167], v[172:175], a[172:175], v[164:167]
    v_fma_f32 v222, v255, v234, v70
    s_waitcnt lgkmcnt(4)
    v_mfma_f32_16x16x32_bf16 v[136:139], v[176:179], a[176:179], v[136:139]
    ds_read_b128 v[168:171], v6 offset:28672
    ds_read_b128 v[172:175], v6 offset:29696
    v_mfma_f32_16x16x32_bf16 v[140:143], v[180:183], a[176:179], v[140:143]
    buffer_load_dwordx4 v3, s[8:11], s28 offen offset:2048 sc1 lds
    v_mfma_f32_16x16x32_bf16 v[144:147], v[176:179], a[180:183], v[144:147]
    v_fma_f32 v223, v255, v235, v71
    v_mfma_f32_16x16x32_bf16 v[148:151], v[180:183], a[180:183], v[148:151]
    v_mul_f32 v224, v216, v220
    v_mfma_f32_16x16x32_bf16 v[152:155], v[176:179], a[184:187], v[152:155]
    v_mul_f32 v225, v217, v221
    v_mfma_f32_16x16x32_bf16 v[156:159], v[180:183], a[184:187], v[156:159]
    buffer_load_dwordx4 v3, s[8:11], s28 offen offset:3072 sc1 lds
    v_mfma_f32_16x16x32_bf16 v[160:163], v[176:179], a[188:191], v[160:163]
    v_mul_f32 v226, v218, v222
    v_mfma_f32_16x16x32_bf16 v[164:167], v[180:183], a[188:191], v[164:167]
    v_mul_f32 v227, v219, v223
    s_waitcnt lgkmcnt(4)
    v_mfma_f32_16x16x32_bf16 v[136:139], v[184:187], a[192:195], v[136:139]
    ds_read_b128 v[176:179], v6 offset:30720
    ds_read_b128 v[180:183], v6 offset:31744
    v_mfma_f32_16x16x32_bf16 v[140:143], v[188:191], a[192:195], v[140:143]
    s_add_u32 m0, s29, 81920
    s_add_u32 s28, s27, 45056
    buffer_load_dwordx4 v3, s[8:11], s28 offen offset:0 sc1 lds
    v_mfma_f32_16x16x32_bf16 v[144:147], v[184:187], a[196:199], v[144:147]
    v_cvt_pk_bf16_f32 v212, v224, v225
    v_mfma_f32_16x16x32_bf16 v[148:151], v[188:191], a[196:199], v[148:151]
    v_cvt_pk_bf16_f32 v213, v226, v227
    v_mfma_f32_16x16x32_bf16 v[152:155], v[184:187], a[200:203], v[152:155]
    v_mfma_f32_16x16x32_bf16 v[156:159], v[188:191], a[200:203], v[156:159]
    v_mfma_f32_16x16x32_bf16 v[160:163], v[184:187], a[204:207], v[160:163]
    v_mfma_f32_16x16x32_bf16 v[164:167], v[188:191], a[204:207], v[164:167]
    s_waitcnt lgkmcnt(4)
    v_mfma_f32_16x16x32_bf16 v[136:139], v[192:195], a[208:211], v[136:139]
    ds_read_b128 v[184:187], v6 offset:32768
    ds_read_b128 v[188:191], v6 offset:33792
    v_mfma_f32_16x16x32_bf16 v[140:143], v[196:199], a[208:211], v[140:143]
    v_mfma_f32_16x16x32_bf16 v[144:147], v[192:195], a[212:215], v[144:147]
    v_mfma_f32_16x16x32_bf16 v[148:151], v[196:199], a[212:215], v[148:151]
L_pad_k3_kernel_5:
    s_cbranch_execz k3_kernel_end
    v_mfma_f32_16x16x32_bf16 v[152:155], v[192:195], a[216:219], v[152:155]
    v_mfma_f32_16x16x32_bf16 v[156:159], v[196:199], a[216:219], v[156:159]
    v_mfma_f32_16x16x32_bf16 v[160:163], v[192:195], a[220:223], v[160:163]
    v_mfma_f32_16x16x32_bf16 v[164:167], v[196:199], a[220:223], v[164:167]
    s_waitcnt lgkmcnt(4)
    v_mfma_f32_16x16x32_bf16 v[136:139], v[168:171], a[224:227], v[136:139]
    ds_read_b128 v[192:195], v6 offset:34816
    ds_read_b128 v[196:199], v6 offset:35840
    v_mfma_f32_16x16x32_bf16 v[140:143], v[172:175], a[224:227], v[140:143]
    v_mfma_f32_16x16x32_bf16 v[144:147], v[168:171], a[228:231], v[144:147]
    v_mfma_f32_16x16x32_bf16 v[148:151], v[172:175], a[228:231], v[148:151]
    v_mfma_f32_16x16x32_bf16 v[152:155], v[168:171], a[232:235], v[152:155]
    v_mfma_f32_16x16x32_bf16 v[156:159], v[172:175], a[232:235], v[156:159]
    v_mfma_f32_16x16x32_bf16 v[160:163], v[168:171], a[236:239], v[160:163]
    v_mfma_f32_16x16x32_bf16 v[164:167], v[172:175], a[236:239], v[164:167]
    s_waitcnt lgkmcnt(0)
    s_barrier
    v_mfma_f32_16x16x32_bf16 v[136:139], v[176:179], a[240:243], v[136:139]
    ds_read_b128 v[168:171], v3 offset:0
    ds_read_b128 v[172:175], v3 offset:1024
    v_mfma_f32_16x16x32_bf16 v[140:143], v[180:183], a[240:243], v[140:143]
    v_mfma_f32_16x16x32_bf16 v[144:147], v[176:179], a[244:247], v[144:147]
    v_mfma_f32_16x16x32_bf16 v[148:151], v[180:183], a[244:247], v[148:151]
    v_mfma_f32_16x16x32_bf16 v[152:155], v[176:179], a[248:251], v[152:155]
    v_mfma_f32_16x16x32_bf16 v[156:159], v[180:183], a[248:251], v[156:159]
    v_mfma_f32_16x16x32_bf16 v[160:163], v[176:179], a[252:255], v[160:163]
    v_mfma_f32_16x16x32_bf16 v[164:167], v[180:183], a[252:255], v[164:167]
    v_mfma_f32_16x16x32_bf16 v[136:139], v[184:187], v[8:11], v[136:139]
    ds_read_b128 v[176:179], v3 offset:2048
    ds_read_b128 v[180:183], v3 offset:3072
    v_mfma_f32_16x16x32_bf16 v[140:143], v[188:191], v[8:11], v[140:143]
    v_mfma_f32_16x16x32_bf16 v[144:147], v[184:187], v[12:15], v[144:147]
    v_mfma_f32_16x16x32_bf16 v[148:151], v[188:191], v[12:15], v[148:151]
    v_mfma_f32_16x16x32_bf16 v[152:155], v[184:187], v[16:19], v[152:155]
    v_mfma_f32_16x16x32_bf16 v[156:159], v[188:191], v[16:19], v[156:159]
    v_mfma_f32_16x16x32_bf16 v[160:163], v[184:187], v[20:23], v[160:163]
    v_mfma_f32_16x16x32_bf16 v[164:167], v[188:191], v[20:23], v[164:167]
    v_mfma_f32_16x16x32_bf16 v[136:139], v[192:195], v[24:27], v[136:139]
    ds_read_b128 v[184:187], v3 offset:4096
    ds_read_b128 v[188:191], v3 offset:5120
    v_mfma_f32_16x16x32_bf16 v[140:143], v[196:199], v[24:27], v[140:143]
    v_mfma_f32_16x16x32_bf16 v[144:147], v[192:195], v[28:31], v[144:147]
    v_mfma_f32_16x16x32_bf16 v[148:151], v[196:199], v[28:31], v[148:151]
    v_mfma_f32_16x16x32_bf16 v[152:155], v[192:195], v[32:35], v[152:155]
    v_mfma_f32_16x16x32_bf16 v[156:159], v[196:199], v[32:35], v[156:159]
    v_mfma_f32_16x16x32_bf16 v[160:163], v[192:195], v[36:39], v[160:163]
    v_mfma_f32_16x16x32_bf16 v[164:167], v[196:199], v[36:39], v[164:167]
    s_waitcnt lgkmcnt(4)
    v_mfma_f32_16x16x32_bf16 v[40:43], v[168:171], a[0:3], 0
    ds_read_b128 v[192:195], v3 offset:6144
    ds_read_b128 v[196:199], v3 offset:7168
    v_mfma_f32_16x16x32_bf16 v[44:47], v[172:175], a[0:3], 0
    ds_read_b128 v[228:231], v7 offset:896
    v_mfma_f32_16x16x32_bf16 v[48:51], v[168:171], a[4:7], 0
    ds_read_b128 v[232:235], v7 offset:960
    v_mfma_f32_16x16x32_bf16 v[52:55], v[172:175], a[4:7], 0
    v_mfma_f32_16x16x32_bf16 v[56:59], v[168:171], a[8:11], 0
    v_mfma_f32_16x16x32_bf16 v[60:63], v[172:175], a[8:11], 0
    v_mfma_f32_16x16x32_bf16 v[64:67], v[168:171], a[12:15], 0
    v_mfma_f32_16x16x32_bf16 v[68:71], v[172:175], a[12:15], 0
    s_waitcnt lgkmcnt(0)
    v_fma_f32 v216, v252, v228, v136
    v_mfma_f32_16x16x32_bf16 v[40:43], v[176:179], a[16:19], v[40:43]
    ds_read_b128 v[168:171], v3 offset:8192
    ds_read_b128 v[172:175], v3 offset:9216
    v_mfma_f32_16x16x32_bf16 v[44:47], v[180:183], a[16:19], v[44:47]
    s_add_u32 s63, s57, 0
    buffer_load_dwordx4 a[0:3], v3, s[8:11], s63 offen sc1
    v_mfma_f32_16x16x32_bf16 v[48:51], v[176:179], a[20:23], v[48:51]
    v_fma_f32 v217, v252, v229, v137
    v_mfma_f32_16x16x32_bf16 v[52:55], v[180:183], a[20:23], v[52:55]
    v_fma_f32 v218, v252, v230, v138
    v_mfma_f32_16x16x32_bf16 v[56:59], v[176:179], a[24:27], v[56:59]
    v_fma_f32 v219, v252, v231, v139
    v_mfma_f32_16x16x32_bf16 v[60:63], v[180:183], a[24:27], v[60:63]
    v_fma_f32 v220, v252, v232, v140
    v_mfma_f32_16x16x32_bf16 v[64:67], v[176:179], a[28:31], v[64:67]
    buffer_load_dwordx4 a[4:7], v249, s[8:11], s63 offen sc1
    v_mfma_f32_16x16x32_bf16 v[68:71], v[180:183], a[28:31], v[68:71]
    v_fma_f32 v221, v252, v233, v141
    v_mfma_f32_16x16x32_bf16 v[40:43], v[184:187], a[32:35], v[40:43]
    ds_read_b128 v[176:179], v3 offset:10240
    ds_read_b128 v[180:183], v3 offset:11264
    v_mfma_f32_16x16x32_bf16 v[44:47], v[188:191], a[32:35], v[44:47]
    v_fma_f32 v222, v252, v234, v142
    v_mfma_f32_16x16x32_bf16 v[48:51], v[184:187], a[36:39], v[48:51]
    v_fma_f32 v223, v252, v235, v143
    v_mfma_f32_16x16x32_bf16 v[52:55], v[188:191], a[36:39], v[52:55]
    s_add_u32 s63, s57, 9216
    buffer_load_dwordx4 a[8:11], v3, s[8:11], s63 offen sc1
    v_mfma_f32_16x16x32_bf16 v[56:59], v[184:187], a[40:43], v[56:59]
    v_mul_f32 v224, v216, v220
    v_mfma_f32_16x16x32_bf16 v[60:63], v[188:191], a[40:43], v[60:63]
    v_mul_f32 v225, v217, v221
    v_mfma_f32_16x16x32_bf16 v[64:67], v[184:187], a[44:47], v[64:67]
    v_mul_f32 v226, v218, v222
    v_mfma_f32_16x16x32_bf16 v[68:71], v[188:191], a[44:47], v[68:71]
    v_mul_f32 v227, v219, v223
    v_mfma_f32_16x16x32_bf16 v[40:43], v[192:195], a[48:51], v[40:43]
    ds_read_b128 v[184:187], v3 offset:12288
    ds_read_b128 v[188:191], v3 offset:13312
    v_mfma_f32_16x16x32_bf16 v[44:47], v[196:199], a[48:51], v[44:47]
    buffer_load_dwordx4 a[12:15], v249, s[8:11], s63 offen sc1
    v_mfma_f32_16x16x32_bf16 v[48:51], v[192:195], a[52:55], v[48:51]
    v_cvt_pk_bf16_f32 v202, v224, v225
    v_mfma_f32_16x16x32_bf16 v[52:55], v[196:199], a[52:55], v[52:55]
    v_cvt_pk_bf16_f32 v203, v226, v227
    v_mfma_f32_16x16x32_bf16 v[56:59], v[192:195], a[56:59], v[56:59]
    v_fma_f32 v216, v253, v228, v144
    v_mfma_f32_16x16x32_bf16 v[60:63], v[196:199], a[56:59], v[60:63]
    v_fma_f32 v217, v253, v229, v145
    v_mfma_f32_16x16x32_bf16 v[64:67], v[192:195], a[60:63], v[64:67]
    buffer_store_dwordx4 v[200:203], v3, s[8:11], s36 offen sc1
    s_add_u32 s36, s36, 1024
    v_mfma_f32_16x16x32_bf16 v[68:71], v[196:199], a[60:63], v[68:71]
    v_fma_f32 v218, v253, v230, v146
    s_waitcnt lgkmcnt(4)
    v_mfma_f32_16x16x32_bf16 v[40:43], v[168:171], a[64:67], v[40:43]
    ds_read_b128 v[192:195], v3 offset:14336
    ds_read_b128 v[196:199], v3 offset:15360
    v_mfma_f32_16x16x32_bf16 v[44:47], v[172:175], a[64:67], v[44:47]
    v_fma_f32 v219, v253, v231, v147
    v_mfma_f32_16x16x32_bf16 v[48:51], v[168:171], a[68:71], v[48:51]
    v_fma_f32 v220, v253, v232, v148
    v_mfma_f32_16x16x32_bf16 v[52:55], v[172:175], a[68:71], v[52:55]
    s_add_u32 s63, s57, 18432
    buffer_load_dwordx4 a[16:19], v3, s[8:11], s63 offen sc1
    v_mfma_f32_16x16x32_bf16 v[56:59], v[168:171], a[72:75], v[56:59]
    v_fma_f32 v221, v253, v233, v149
    v_mfma_f32_16x16x32_bf16 v[60:63], v[172:175], a[72:75], v[60:63]
    v_fma_f32 v222, v253, v234, v150
    v_mfma_f32_16x16x32_bf16 v[64:67], v[168:171], a[76:79], v[64:67]
    v_fma_f32 v223, v253, v235, v151
    v_mfma_f32_16x16x32_bf16 v[68:71], v[172:175], a[76:79], v[68:71]
    v_mul_f32 v224, v216, v220
    s_waitcnt lgkmcnt(4)
    v_mfma_f32_16x16x32_bf16 v[40:43], v[176:179], a[80:83], v[40:43]
    ds_read_b128 v[168:171], v3 offset:16384
    ds_read_b128 v[172:175], v3 offset:17408
    v_mfma_f32_16x16x32_bf16 v[44:47], v[180:183], a[80:83], v[44:47]
    buffer_load_dwordx4 a[20:23], v249, s[8:11], s63 offen sc1
    v_mfma_f32_16x16x32_bf16 v[48:51], v[176:179], a[84:87], v[48:51]
    v_mul_f32 v225, v217, v221
    v_mfma_f32_16x16x32_bf16 v[52:55], v[180:183], a[84:87], v[52:55]
    v_mul_f32 v226, v218, v222
    v_mfma_f32_16x16x32_bf16 v[56:59], v[176:179], a[88:91], v[56:59]
    v_mul_f32 v227, v219, v223
    v_mfma_f32_16x16x32_bf16 v[60:63], v[180:183], a[88:91], v[60:63]
    v_cvt_pk_bf16_f32 v206, v224, v225
    v_mfma_f32_16x16x32_bf16 v[64:67], v[176:179], a[92:95], v[64:67]
    s_add_u32 s63, s57, 27648
    buffer_load_dwordx4 a[24:27], v3, s[8:11], s63 offen sc1
    v_mfma_f32_16x16x32_bf16 v[68:71], v[180:183], a[92:95], v[68:71]
    v_cvt_pk_bf16_f32 v207, v226, v227
    s_waitcnt lgkmcnt(4)
    v_mfma_f32_16x16x32_bf16 v[40:43], v[184:187], a[96:99], v[40:43]
    ds_read_b128 v[176:179], v3 offset:18432
    ds_read_b128 v[180:183], v3 offset:19456
    v_mfma_f32_16x16x32_bf16 v[44:47], v[188:191], a[96:99], v[44:47]
    v_fma_f32 v216, v254, v228, v152
    v_mfma_f32_16x16x32_bf16 v[48:51], v[184:187], a[100:103], v[48:51]
    v_fma_f32 v217, v254, v229, v153
    v_mfma_f32_16x16x32_bf16 v[52:55], v[188:191], a[100:103], v[52:55]
    buffer_store_dwordx4 v[204:207], v3, s[8:11], s37 offen sc1
    s_add_u32 s37, s37, 1024
    v_mfma_f32_16x16x32_bf16 v[56:59], v[184:187], a[104:107], v[56:59]
    v_fma_f32 v218, v254, v230, v154
    v_mfma_f32_16x16x32_bf16 v[60:63], v[188:191], a[104:107], v[60:63]
    v_fma_f32 v219, v254, v231, v155
    v_mfma_f32_16x16x32_bf16 v[64:67], v[184:187], a[108:111], v[64:67]
    v_fma_f32 v220, v254, v232, v156
    v_mfma_f32_16x16x32_bf16 v[68:71], v[188:191], a[108:111], v[68:71]
    v_fma_f32 v221, v254, v233, v157
    s_waitcnt lgkmcnt(4)
    v_mfma_f32_16x16x32_bf16 v[40:43], v[192:195], a[112:115], v[40:43]
    ds_read_b128 v[184:187], v3 offset:20480
    ds_read_b128 v[188:191], v3 offset:21504
    v_mfma_f32_16x16x32_bf16 v[44:47], v[196:199], a[112:115], v[44:47]
    buffer_load_dwordx4 a[28:31], v249, s[8:11], s63 offen sc1
    v_mfma_f32_16x16x32_bf16 v[48:51], v[192:195], a[116:119], v[48:51]
    v_fma_f32 v222, v254, v234, v158
    v_mfma_f32_16x16x32_bf16 v[52:55], v[196:199], a[116:119], v[52:55]
    v_fma_f32 v223, v254, v235, v159
    v_mfma_f32_16x16x32_bf16 v[56:59], v[192:195], a[120:123], v[56:59]
    v_mul_f32 v224, v216, v220
    v_mfma_f32_16x16x32_bf16 v[60:63], v[196:199], a[120:123], v[60:63]
    v_mul_f32 v225, v217, v221
    v_mfma_f32_16x16x32_bf16 v[64:67], v[192:195], a[124:127], v[64:67]
    s_add_u32 s63, s57, 5120
    buffer_load_dwordx4 a[32:35], v3, s[8:11], s63 offen sc1
    v_mfma_f32_16x16x32_bf16 v[68:71], v[196:199], a[124:127], v[68:71]
    v_mul_f32 v226, v218, v222
    s_waitcnt lgkmcnt(4)
    v_mfma_f32_16x16x32_bf16 v[40:43], v[168:171], a[128:131], v[40:43]
    ds_read_b128 v[192:195], v3 offset:22528
    ds_read_b128 v[196:199], v3 offset:23552
    v_mfma_f32_16x16x32_bf16 v[44:47], v[172:175], a[128:131], v[44:47]
    v_mul_f32 v227, v219, v223
    v_mfma_f32_16x16x32_bf16 v[48:51], v[168:171], a[132:135], v[48:51]
    v_cvt_pk_bf16_f32 v210, v224, v225
    v_mfma_f32_16x16x32_bf16 v[52:55], v[172:175], a[132:135], v[52:55]
    buffer_load_dwordx4 a[36:39], v249, s[8:11], s63 offen sc1
    v_mfma_f32_16x16x32_bf16 v[56:59], v[168:171], a[136:139], v[56:59]
    v_cvt_pk_bf16_f32 v211, v226, v227
    v_mfma_f32_16x16x32_bf16 v[60:63], v[172:175], a[136:139], v[60:63]
    v_fma_f32 v216, v255, v228, v160
    v_mfma_f32_16x16x32_bf16 v[64:67], v[168:171], a[140:143], v[64:67]
    v_fma_f32 v217, v255, v229, v161
    v_mfma_f32_16x16x32_bf16 v[68:71], v[172:175], a[140:143], v[68:71]
    v_fma_f32 v218, v255, v230, v162
    s_waitcnt lgkmcnt(4)
    v_mfma_f32_16x16x32_bf16 v[40:43], v[176:179], a[144:147], v[40:43]
    ds_read_b128 v[168:171], v3 offset:24576
    ds_read_b128 v[172:175], v3 offset:25600
    v_mfma_f32_16x16x32_bf16 v[44:47], v[180:183], a[144:147], v[44:47]
    buffer_store_dwordx4 v[208:211], v3, s[8:11], s38 offen sc1
    s_add_u32 s38, s38, 1024
    v_mfma_f32_16x16x32_bf16 v[48:51], v[176:179], a[148:151], v[48:51]
    v_fma_f32 v219, v255, v231, v163
    v_mfma_f32_16x16x32_bf16 v[52:55], v[180:183], a[148:151], v[52:55]
    v_fma_f32 v220, v255, v232, v164
    v_mfma_f32_16x16x32_bf16 v[56:59], v[176:179], a[152:155], v[56:59]
    v_fma_f32 v221, v255, v233, v165
    v_mfma_f32_16x16x32_bf16 v[60:63], v[180:183], a[152:155], v[60:63]
    v_fma_f32 v222, v255, v234, v166
    v_mfma_f32_16x16x32_bf16 v[64:67], v[176:179], a[156:159], v[64:67]
    s_add_u32 s63, s57, 14336
    buffer_load_dwordx4 a[40:43], v3, s[8:11], s63 offen sc1
    v_mfma_f32_16x16x32_bf16 v[68:71], v[180:183], a[156:159], v[68:71]
    v_fma_f32 v223, v255, v235, v167
    s_waitcnt lgkmcnt(4)
    v_mfma_f32_16x16x32_bf16 v[40:43], v[184:187], a[160:163], v[40:43]
    ds_read_b128 v[176:179], v3 offset:26624
    ds_read_b128 v[180:183], v3 offset:27648
    v_mfma_f32_16x16x32_bf16 v[44:47], v[188:191], a[160:163], v[44:47]
    v_mul_f32 v224, v216, v220
    v_mfma_f32_16x16x32_bf16 v[48:51], v[184:187], a[164:167], v[48:51]
    v_mul_f32 v225, v217, v221
    v_mfma_f32_16x16x32_bf16 v[52:55], v[188:191], a[164:167], v[52:55]
    buffer_load_dwordx4 a[44:47], v249, s[8:11], s63 offen sc1
    v_mfma_f32_16x16x32_bf16 v[56:59], v[184:187], a[168:171], v[56:59]
    v_mul_f32 v226, v218, v222
    v_mfma_f32_16x16x32_bf16 v[60:63], v[188:191], a[168:171], v[60:63]
    v_mul_f32 v227, v219, v223
    v_mfma_f32_16x16x32_bf16 v[64:67], v[184:187], a[172:175], v[64:67]
    v_cvt_pk_bf16_f32 v214, v224, v225
    v_mfma_f32_16x16x32_bf16 v[68:71], v[188:191], a[172:175], v[68:71]
    v_cvt_pk_bf16_f32 v215, v226, v227
    s_waitcnt lgkmcnt(4)
    v_mfma_f32_16x16x32_bf16 v[40:43], v[192:195], a[176:179], v[40:43]
    ds_read_b128 v[184:187], v3 offset:28672
    ds_read_b128 v[188:191], v3 offset:29696
    v_mfma_f32_16x16x32_bf16 v[44:47], v[196:199], a[176:179], v[44:47]
    s_add_u32 s63, s57, 23552
    buffer_load_dwordx4 a[48:51], v3, s[8:11], s63 offen sc1
    v_mfma_f32_16x16x32_bf16 v[48:51], v[192:195], a[180:183], v[48:51]
    v_mfma_f32_16x16x32_bf16 v[52:55], v[196:199], a[180:183], v[52:55]
    v_mfma_f32_16x16x32_bf16 v[56:59], v[192:195], a[184:187], v[56:59]
    v_mfma_f32_16x16x32_bf16 v[60:63], v[196:199], a[184:187], v[60:63]
    v_mfma_f32_16x16x32_bf16 v[64:67], v[192:195], a[188:191], v[64:67]
    buffer_store_dwordx4 v[212:215], v3, s[8:11], s39 offen sc1
    s_add_u32 s39, s39, 1024
    v_mfma_f32_16x16x32_bf16 v[68:71], v[196:199], a[188:191], v[68:71]
    s_waitcnt lgkmcnt(4)
    v_mfma_f32_16x16x32_bf16 v[40:43], v[168:171], a[192:195], v[40:43]
    ds_read_b128 v[192:195], v3 offset:30720
    ds_read_b128 v[196:199], v3 offset:31744
    v_mfma_f32_16x16x32_bf16 v[44:47], v[172:175], a[192:195], v[44:47]
    v_mfma_f32_16x16x32_bf16 v[48:51], v[168:171], a[196:199], v[48:51]
    v_mfma_f32_16x16x32_bf16 v[52:55], v[172:175], a[196:199], v[52:55]
    buffer_load_dwordx4 a[52:55], v249, s[8:11], s63 offen sc1
    v_mfma_f32_16x16x32_bf16 v[56:59], v[168:171], a[200:203], v[56:59]
    v_mfma_f32_16x16x32_bf16 v[60:63], v[172:175], a[200:203], v[60:63]
    v_mfma_f32_16x16x32_bf16 v[64:67], v[168:171], a[204:207], v[64:67]
    v_mfma_f32_16x16x32_bf16 v[68:71], v[172:175], a[204:207], v[68:71]
    s_waitcnt lgkmcnt(4)
    v_mfma_f32_16x16x32_bf16 v[40:43], v[176:179], a[208:211], v[40:43]
    ds_read_b128 v[168:171], v3 offset:32768
    ds_read_b128 v[172:175], v3 offset:33792
    v_mfma_f32_16x16x32_bf16 v[44:47], v[180:183], a[208:211], v[44:47]
    s_add_u32 s63, s57, 32768
    buffer_load_dwordx4 a[56:59], v3, s[8:11], s63 offen sc1
    v_mfma_f32_16x16x32_bf16 v[48:51], v[176:179], a[212:215], v[48:51]
    v_mfma_f32_16x16x32_bf16 v[52:55], v[180:183], a[212:215], v[52:55]
    v_mfma_f32_16x16x32_bf16 v[56:59], v[176:179], a[216:219], v[56:59]
    v_mfma_f32_16x16x32_bf16 v[60:63], v[180:183], a[216:219], v[60:63]
    v_mfma_f32_16x16x32_bf16 v[64:67], v[176:179], a[220:223], v[64:67]
    buffer_load_dwordx4 a[60:63], v249, s[8:11], s63 offen sc1
    v_mfma_f32_16x16x32_bf16 v[68:71], v[180:183], a[220:223], v[68:71]
    s_waitcnt lgkmcnt(4)
    v_mfma_f32_16x16x32_bf16 v[40:43], v[184:187], a[224:227], v[40:43]
    ds_read_b128 v[176:179], v3 offset:34816
    ds_read_b128 v[180:183], v3 offset:35840
    v_mfma_f32_16x16x32_bf16 v[44:47], v[188:191], a[224:227], v[44:47]
    v_mfma_f32_16x16x32_bf16 v[48:51], v[184:187], a[228:231], v[48:51]
    v_mfma_f32_16x16x32_bf16 v[52:55], v[188:191], a[228:231], v[52:55]
    s_add_u32 s63, s57, 1024
    buffer_load_dwordx4 a[64:67], v3, s[8:11], s63 offen sc1
    v_mfma_f32_16x16x32_bf16 v[56:59], v[184:187], a[232:235], v[56:59]
    v_mfma_f32_16x16x32_bf16 v[60:63], v[188:191], a[232:235], v[60:63]
    v_mfma_f32_16x16x32_bf16 v[64:67], v[184:187], a[236:239], v[64:67]
    v_mfma_f32_16x16x32_bf16 v[68:71], v[188:191], a[236:239], v[68:71]
    s_waitcnt vmcnt(31)
    s_barrier
    s_waitcnt lgkmcnt(4)
    v_mfma_f32_16x16x32_bf16 v[40:43], v[192:195], a[240:243], v[40:43]
    buffer_load_dwordx4 a[68:71], v249, s[8:11], s63 offen sc1
    v_mfma_f32_16x16x32_bf16 v[44:47], v[196:199], a[240:243], v[44:47]
    v_mfma_f32_16x16x32_bf16 v[48:51], v[192:195], a[244:247], v[48:51]
    v_mfma_f32_16x16x32_bf16 v[52:55], v[196:199], a[244:247], v[52:55]
    v_mfma_f32_16x16x32_bf16 v[56:59], v[192:195], a[248:251], v[56:59]
    v_mfma_f32_16x16x32_bf16 v[60:63], v[196:199], a[248:251], v[60:63]
    s_add_u32 s63, s57, 10240
    buffer_load_dwordx4 a[72:75], v3, s[8:11], s63 offen sc1
    v_mfma_f32_16x16x32_bf16 v[64:67], v[192:195], a[252:255], v[64:67]
    v_mfma_f32_16x16x32_bf16 v[68:71], v[196:199], a[252:255], v[68:71]
    s_waitcnt lgkmcnt(2)
    v_mfma_f32_16x16x32_bf16 v[40:43], v[168:171], v[8:11], v[40:43]
    ds_read_b128 v[144:147], v4 offset:0
    v_mfma_f32_16x16x32_bf16 v[44:47], v[172:175], v[8:11], v[44:47]
    v_mfma_f32_16x16x32_bf16 v[48:51], v[168:171], v[12:15], v[48:51]
    ds_read_b128 v[148:151], v4 offset:1024
    v_mfma_f32_16x16x32_bf16 v[52:55], v[172:175], v[12:15], v[52:55]
    buffer_load_dwordx4 a[76:79], v249, s[8:11], s63 offen sc1
    v_mfma_f32_16x16x32_bf16 v[56:59], v[168:171], v[16:19], v[56:59]
    ds_read_b128 v[152:155], v4 offset:2048
    v_mfma_f32_16x16x32_bf16 v[60:63], v[172:175], v[16:19], v[60:63]
    v_mfma_f32_16x16x32_bf16 v[64:67], v[168:171], v[20:23], v[64:67]
    ds_read_b128 v[156:159], v4 offset:3072
    v_mfma_f32_16x16x32_bf16 v[68:71], v[172:175], v[20:23], v[68:71]
    s_waitcnt lgkmcnt(4)
    v_mfma_f32_16x16x32_bf16 v[40:43], v[176:179], v[24:27], v[40:43]
    ds_read_b128 v[160:163], v4 offset:4096
    v_mfma_f32_16x16x32_bf16 v[44:47], v[180:183], v[24:27], v[44:47]
    s_add_u32 s63, s57, 19456
    buffer_load_dwordx4 a[80:83], v3, s[8:11], s63 offen sc1
    v_mfma_f32_16x16x32_bf16 v[48:51], v[176:179], v[28:31], v[48:51]
    ds_read_b128 v[164:167], v4 offset:5120
    v_mfma_f32_16x16x32_bf16 v[52:55], v[180:183], v[28:31], v[52:55]
    v_mfma_f32_16x16x32_bf16 v[56:59], v[176:179], v[32:35], v[56:59]
    v_mfma_f32_16x16x32_bf16 v[60:63], v[180:183], v[32:35], v[60:63]
    v_mfma_f32_16x16x32_bf16 v[64:67], v[176:179], v[36:39], v[64:67]
    buffer_load_dwordx4 a[84:87], v249, s[8:11], s63 offen sc1
    v_mfma_f32_16x16x32_bf16 v[68:71], v[180:183], v[36:39], v[68:71]
    s_waitcnt vmcnt(24)
    s_waitcnt lgkmcnt(4)
    v_mfma_f32_16x16x32_bf16 v[72:75], v[144:147], a[0:3], 0
    ds_read_b128 v[168:171], v4 offset:6144
    v_mfma_f32_16x16x32_bf16 v[76:79], v[144:147], a[4:7], 0
    ds_read_b128 v[228:231], v7 offset:1024
    ds_read_b128 v[232:235], v7 offset:1088
    v_mfma_f32_16x16x32_bf16 v[80:83], v[148:151], a[0:3], 0
    ds_read_b128 v[172:175], v4 offset:7168
    v_mfma_f32_16x16x32_bf16 v[84:87], v[148:151], a[4:7], 0
    s_add_u32 m0, s29, 110592
    s_add_u32 s28, s27, 73728
    buffer_load_dwordx4 v3, s[8:11], s28 offen offset:0 sc1 lds
    s_waitcnt vmcnt(10)
    s_mov_b64 exec, 1
    v_mov_b32 v247, 256
    buffer_atomic_add v247, v246, s[8:11], s61 offen offset:256
    s_mov_b64 exec, -1
    s_waitcnt lgkmcnt(6)
    v_mfma_f32_16x16x32_bf16 v[88:91], v[152:155], a[0:3], 0
    ds_read_b128 v[176:179], v4 offset:8192
    v_mfma_f32_16x16x32_bf16 v[92:95], v[152:155], a[4:7], 0
    v_mfma_f32_16x16x32_bf16 v[96:99], v[156:159], a[0:3], 0
    ds_read_b128 v[180:183], v4 offset:9216
    v_mfma_f32_16x16x32_bf16 v[100:103], v[156:159], a[4:7], 0
    buffer_load_dwordx4 v3, s[8:11], s28 offen offset:1024 sc1 lds
    s_waitcnt lgkmcnt(6)
    v_mfma_f32_16x16x32_bf16 v[104:107], v[160:163], a[0:3], 0
    ds_read_b128 v[184:187], v4 offset:10240
    v_mfma_f32_16x16x32_bf16 v[108:111], v[160:163], a[4:7], 0
    v_mfma_f32_16x16x32_bf16 v[112:115], v[164:167], a[0:3], 0
    ds_read_b128 v[188:191], v4 offset:11264
    v_mfma_f32_16x16x32_bf16 v[116:119], v[164:167], a[4:7], 0
    buffer_load_dwordx4 v3, s[8:11], s28 offen offset:2048 sc1 lds
    s_waitcnt lgkmcnt(4)
    v_mfma_f32_16x16x32_bf16 v[120:123], v[168:171], a[0:3], 0
    ds_read_b128 v[144:147], v4 offset:12288
    v_mfma_f32_16x16x32_bf16 v[124:127], v[168:171], a[4:7], 0
    v_fma_f32 v216, v252, v228, v40
    v_fma_f32 v217, v252, v229, v41
    v_mfma_f32_16x16x32_bf16 v[72:75], v[172:175], a[8:11], v[72:75]
    ds_read_b128 v[148:151], v4 offset:13312
    v_mfma_f32_16x16x32_bf16 v[76:79], v[172:175], a[12:15], v[76:79]
    buffer_load_dwordx4 v3, s[8:11], s28 offen offset:3072 sc1 lds
    s_waitcnt lgkmcnt(4)
    v_mfma_f32_16x16x32_bf16 v[80:83], v[176:179], a[8:11], v[80:83]
    ds_read_b128 v[152:155], v4 offset:14336
    v_mfma_f32_16x16x32_bf16 v[84:87], v[176:179], a[12:15], v[84:87]
    v_fma_f32 v218, v252, v230, v42
    v_fma_f32 v219, v252, v231, v43
    v_mfma_f32_16x16x32_bf16 v[88:91], v[180:183], a[8:11], v[88:91]
    ds_read_b128 v[156:159], v4 offset:15360
    v_mfma_f32_16x16x32_bf16 v[92:95], v[180:183], a[12:15], v[92:95]
    s_add_u32 m0, s29, 114688
    s_add_u32 s28, s27, 77824
    buffer_load_dwordx4 v3, s[8:11], s28 offen offset:0 sc1 lds
    s_waitcnt lgkmcnt(4)
    v_mfma_f32_16x16x32_bf16 v[96:99], v[184:187], a[8:11], v[96:99]
    ds_read_b128 v[160:163], v4 offset:16384
    v_mfma_f32_16x16x32_bf16 v[100:103], v[184:187], a[12:15], v[100:103]
    v_fma_f32 v220, v252, v232, v44
    v_fma_f32 v221, v252, v233, v45
    v_mfma_f32_16x16x32_bf16 v[104:107], v[188:191], a[8:11], v[104:107]
    ds_read_b128 v[164:167], v4 offset:17408
    v_mfma_f32_16x16x32_bf16 v[108:111], v[188:191], a[12:15], v[108:111]
    buffer_load_dwordx4 v3, s[8:11], s28 offen offset:1024 sc1 lds
    buffer_load_dword v248, v246, s[8:11], s62 offen offset:128 sc1
    s_waitcnt lgkmcnt(4)
    v_mfma_f32_16x16x32_bf16 v[112:115], v[144:147], a[8:11], v[112:115]
    ds_read_b128 v[168:171], v4 offset:18432
    v_mfma_f32_16x16x32_bf16 v[116:119], v[144:147], a[12:15], v[116:119]
    v_fma_f32 v222, v252, v234, v46
    v_fma_f32 v223, v252, v235, v47
    v_mfma_f32_16x16x32_bf16 v[120:123], v[148:151], a[8:11], v[120:123]
    ds_read_b128 v[172:175], v4 offset:19456
    v_mfma_f32_16x16x32_bf16 v[124:127], v[148:151], a[12:15], v[124:127]
    buffer_load_dwordx4 v3, s[8:11], s28 offen offset:2048 sc1 lds
    s_waitcnt lgkmcnt(4)
    v_mfma_f32_16x16x32_bf16 v[72:75], v[152:155], a[16:19], v[72:75]
    ds_read_b128 v[176:179], v4 offset:20480
    v_mfma_f32_16x16x32_bf16 v[76:79], v[152:155], a[20:23], v[76:79]
    v_mul_f32 v224, v216, v220
    v_mul_f32 v225, v217, v221
    v_mfma_f32_16x16x32_bf16 v[80:83], v[156:159], a[16:19], v[80:83]
    ds_read_b128 v[180:183], v4 offset:21504
    v_mfma_f32_16x16x32_bf16 v[84:87], v[156:159], a[20:23], v[84:87]
    buffer_load_dwordx4 v3, s[8:11], s28 offen offset:3072 sc1 lds
    s_waitcnt lgkmcnt(4)
    v_mfma_f32_16x16x32_bf16 v[88:91], v[160:163], a[16:19], v[88:91]
    ds_read_b128 v[184:187], v4 offset:22528
    v_mfma_f32_16x16x32_bf16 v[92:95], v[160:163], a[20:23], v[92:95]
    v_mul_f32 v226, v218, v222
    v_mul_f32 v227, v219, v223
    v_mfma_f32_16x16x32_bf16 v[96:99], v[164:167], a[16:19], v[96:99]
    ds_read_b128 v[188:191], v4 offset:23552
    v_mfma_f32_16x16x32_bf16 v[100:103], v[164:167], a[20:23], v[100:103]
    s_add_u32 m0, s29, 118784
    s_add_u32 s28, s27, 81920
    buffer_load_dwordx4 v3, s[8:11], s28 offen offset:0 sc1 lds
    s_waitcnt lgkmcnt(4)
    v_mfma_f32_16x16x32_bf16 v[104:107], v[168:171], a[16:19], v[104:107]
    ds_read_b128 v[144:147], v4 offset:24576
    v_mfma_f32_16x16x32_bf16 v[108:111], v[168:171], a[20:23], v[108:111]
    v_cvt_pk_bf16_f32 v200, v224, v225
    v_cvt_pk_bf16_f32 v201, v226, v227
    v_mfma_f32_16x16x32_bf16 v[112:115], v[172:175], a[16:19], v[112:115]
    ds_read_b128 v[148:151], v4 offset:25600
    v_mfma_f32_16x16x32_bf16 v[116:119], v[172:175], a[20:23], v[116:119]
    s_add_u32 s63, s57, 28672
    buffer_load_dwordx4 a[88:91], v3, s[8:11], s63 offen sc1
    s_waitcnt lgkmcnt(4)
    v_mfma_f32_16x16x32_bf16 v[120:123], v[176:179], a[16:19], v[120:123]
    ds_read_b128 v[152:155], v4 offset:26624
    v_mfma_f32_16x16x32_bf16 v[124:127], v[176:179], a[20:23], v[124:127]
    v_fma_f32 v216, v253, v228, v48
    v_fma_f32 v217, v253, v229, v49
    v_mfma_f32_16x16x32_bf16 v[72:75], v[180:183], a[24:27], v[72:75]
    ds_read_b128 v[156:159], v4 offset:27648
    v_mfma_f32_16x16x32_bf16 v[76:79], v[180:183], a[28:31], v[76:79]
    buffer_load_dwordx4 a[92:95], v249, s[8:11], s63 offen sc1
    s_waitcnt lgkmcnt(4)
    v_mfma_f32_16x16x32_bf16 v[80:83], v[184:187], a[24:27], v[80:83]
    ds_read_b128 v[160:163], v4 offset:28672
    v_mfma_f32_16x16x32_bf16 v[84:87], v[184:187], a[28:31], v[84:87]
    v_fma_f32 v218, v253, v230, v50
    v_fma_f32 v219, v253, v231, v51
    v_mfma_f32_16x16x32_bf16 v[88:91], v[188:191], a[24:27], v[88:91]
    ds_read_b128 v[164:167], v4 offset:29696
    v_mfma_f32_16x16x32_bf16 v[92:95], v[188:191], a[28:31], v[92:95]
    s_add_u32 s63, s57, 6144
    buffer_load_dwordx4 a[96:99], v3, s[8:11], s63 offen sc1
    s_waitcnt lgkmcnt(4)
    v_mfma_f32_16x16x32_bf16 v[96:99], v[144:147], a[24:27], v[96:99]
    ds_read_b128 v[168:171], v4 offset:30720
    v_mfma_f32_16x16x32_bf16 v[100:103], v[144:147], a[28:31], v[100:103]
    v_fma_f32 v220, v253, v232, v52
    v_fma_f32 v221, v253, v233, v53
    v_mfma_f32_16x16x32_bf16 v[104:107], v[148:151], a[24:27], v[104:107]
    ds_read_b128 v[172:175], v4 offset:31744
    v_mfma_f32_16x16x32_bf16 v[108:111], v[148:151], a[28:31], v[108:111]
    buffer_load_dwordx4 a[100:103], v249, s[8:11], s63 offen sc1
    s_waitcnt lgkmcnt(4)
    v_mfma_f32_16x16x32_bf16 v[112:115], v[152:155], a[24:27], v[112:115]
    ds_read_b128 v[176:179], v4 offset:32768
    v_mfma_f32_16x16x32_bf16 v[116:119], v[152:155], a[28:31], v[116:119]
    v_fma_f32 v222, v253, v234, v54
    v_fma_f32 v223, v253, v235, v55
    v_mfma_f32_16x16x32_bf16 v[120:123], v[156:159], a[24:27], v[120:123]
    ds_read_b128 v[180:183], v4 offset:33792
    v_mfma_f32_16x16x32_bf16 v[124:127], v[156:159], a[28:31], v[124:127]
    s_add_u32 s63, s57, 15360
    buffer_load_dwordx4 a[104:107], v3, s[8:11], s63 offen sc1
    s_waitcnt lgkmcnt(4)
    v_mfma_f32_16x16x32_bf16 v[72:75], v[160:163], a[32:35], v[72:75]
    ds_read_b128 v[184:187], v4 offset:34816
    v_mfma_f32_16x16x32_bf16 v[76:79], v[160:163], a[36:39], v[76:79]
    v_mul_f32 v224, v216, v220
    v_mul_f32 v225, v217, v221
    v_mfma_f32_16x16x32_bf16 v[80:83], v[164:167], a[32:35], v[80:83]
    ds_read_b128 v[188:191], v4 offset:35840
    v_mfma_f32_16x16x32_bf16 v[84:87], v[164:167], a[36:39], v[84:87]
    buffer_load_dwordx4 a[108:111], v249, s[8:11], s63 offen sc1
    s_barrier
    s_waitcnt lgkmcnt(4)
    v_mfma_f32_16x16x32_bf16 v[88:91], v[168:171], a[32:35], v[88:91]
    ds_read_b128 v[144:147], v5 offset:0
    v_mfma_f32_16x16x32_bf16 v[92:95], v[168:171], a[36:39], v[92:95]
    v_mul_f32 v226, v218, v222
    v_mul_f32 v227, v219, v223
    v_mfma_f32_16x16x32_bf16 v[96:99], v[172:175], a[32:35], v[96:99]
    ds_read_b128 v[148:151], v5 offset:1024
    v_mfma_f32_16x16x32_bf16 v[100:103], v[172:175], a[36:39], v[100:103]
    s_add_u32 s63, s57, 24576
    buffer_load_dwordx4 a[112:115], v3, s[8:11], s63 offen sc1
    s_waitcnt lgkmcnt(4)
    v_mfma_f32_16x16x32_bf16 v[104:107], v[176:179], a[32:35], v[104:107]
    ds_read_b128 v[152:155], v5 offset:2048
    v_mfma_f32_16x16x32_bf16 v[108:111], v[176:179], a[36:39], v[108:111]
    v_cvt_pk_bf16_f32 v202, v224, v225
    v_cvt_pk_bf16_f32 v203, v226, v227
    v_mfma_f32_16x16x32_bf16 v[112:115], v[180:183], a[32:35], v[112:115]
    ds_read_b128 v[156:159], v5 offset:3072
    v_mfma_f32_16x16x32_bf16 v[116:119], v[180:183], a[36:39], v[116:119]
    buffer_load_dwordx4 a[116:119], v249, s[8:11], s63 offen sc1
    s_waitcnt lgkmcnt(4)
    v_mfma_f32_16x16x32_bf16 v[120:123], v[184:187], a[32:35], v[120:123]
    ds_read_b128 v[160:163], v5 offset:4096
    v_mfma_f32_16x16x32_bf16 v[124:127], v[184:187], a[36:39], v[124:127]
    s_add_u32 s36, s36, s40
    buffer_store_dwordx4 v[200:203], v3, s[8:11], s36 offen sc1
    v_fma_f32 v216, v254, v228, v56
    v_mfma_f32_16x16x32_bf16 v[72:75], v[188:191], a[40:43], v[72:75]
    ds_read_b128 v[164:167], v5 offset:5120
    v_mfma_f32_16x16x32_bf16 v[76:79], v[188:191], a[44:47], v[76:79]
    s_add_u32 s63, s57, 33792
    buffer_load_dwordx4 a[120:123], v3, s[8:11], s63 offen sc1
    s_waitcnt lgkmcnt(4)
    v_mfma_f32_16x16x32_bf16 v[80:83], v[144:147], a[40:43], v[80:83]
    ds_read_b128 v[168:171], v5 offset:6144
    v_mfma_f32_16x16x32_bf16 v[84:87], v[144:147], a[44:47], v[84:87]
    v_fma_f32 v217, v254, v229, v57
    v_fma_f32 v218, v254, v230, v58
    v_mfma_f32_16x16x32_bf16 v[88:91], v[148:151], a[40:43], v[88:91]
L_pad_k3_kernel_6:
    s_cbranch_execz k3_kernel_end
    ds_read_b128 v[172:175], v5 offset:7168
    v_mfma_f32_16x16x32_bf16 v[92:95], v[148:151], a[44:47], v[92:95]
    buffer_load_dwordx4 a[124:127], v249, s[8:11], s63 offen sc1
    s_waitcnt lgkmcnt(4)
    v_mfma_f32_16x16x32_bf16 v[96:99], v[152:155], a[40:43], v[96:99]
    ds_read_b128 v[176:179], v5 offset:8192
    v_mfma_f32_16x16x32_bf16 v[100:103], v[152:155], a[44:47], v[100:103]
    v_fma_f32 v219, v254, v231, v59
    v_fma_f32 v220, v254, v232, v60
    v_mfma_f32_16x16x32_bf16 v[104:107], v[156:159], a[40:43], v[104:107]
    ds_read_b128 v[180:183], v5 offset:9216
    v_mfma_f32_16x16x32_bf16 v[108:111], v[156:159], a[44:47], v[108:111]
    s_add_u32 m0, s29, 0
    s_add_u32 s28, s27, 110592
    buffer_load_dwordx4 v3, s[8:11], s28 offen offset:0 sc1 lds
    s_waitcnt lgkmcnt(4)
    v_mfma_f32_16x16x32_bf16 v[112:115], v[160:163], a[40:43], v[112:115]
    ds_read_b128 v[184:187], v5 offset:10240
    v_mfma_f32_16x16x32_bf16 v[116:119], v[160:163], a[44:47], v[116:119]
    v_fma_f32 v221, v254, v233, v61
    v_fma_f32 v222, v254, v234, v62
    v_mfma_f32_16x16x32_bf16 v[120:123], v[164:167], a[40:43], v[120:123]
    ds_read_b128 v[188:191], v5 offset:11264
    v_mfma_f32_16x16x32_bf16 v[124:127], v[164:167], a[44:47], v[124:127]
    buffer_load_dwordx4 v3, s[8:11], s28 offen offset:1024 sc1 lds
    s_waitcnt vmcnt(16)
    v_readfirstlane_b32 s64, v248
    s_nop 0
    s_bitcmp1_b32 s64, 7
    s_cbranch_scc0 k3_kernel_slowB
k3_kernel_backB:
    s_waitcnt lgkmcnt(4)
    v_mfma_f32_16x16x32_bf16 v[72:75], v[168:171], a[48:51], v[72:75]
    ds_read_b128 v[144:147], v5 offset:12288
    v_mfma_f32_16x16x32_bf16 v[76:79], v[168:171], a[52:55], v[76:79]
    v_fma_f32 v223, v254, v235, v63
    v_mul_f32 v224, v216, v220
    v_mfma_f32_16x16x32_bf16 v[80:83], v[172:175], a[48:51], v[80:83]
    ds_read_b128 v[148:151], v5 offset:13312
    v_mfma_f32_16x16x32_bf16 v[84:87], v[172:175], a[52:55], v[84:87]
    buffer_load_dwordx4 v3, s[8:11], s28 offen offset:2048 sc1 lds
    s_waitcnt lgkmcnt(4)
    v_mfma_f32_16x16x32_bf16 v[88:91], v[176:179], a[48:51], v[88:91]
    ds_read_b128 v[152:155], v5 offset:14336
    v_mfma_f32_16x16x32_bf16 v[92:95], v[176:179], a[52:55], v[92:95]
    v_mul_f32 v225, v217, v221
    v_mul_f32 v226, v218, v222
    v_mfma_f32_16x16x32_bf16 v[96:99], v[180:183], a[48:51], v[96:99]
    ds_read_b128 v[156:159], v5 offset:15360
    v_mfma_f32_16x16x32_bf16 v[100:103], v[180:183], a[52:55], v[100:103]
    buffer_load_dwordx4 v3, s[8:11], s28 offen offset:3072 sc1 lds
    s_waitcnt lgkmcnt(4)
    v_mfma_f32_16x16x32_bf16 v[104:107], v[184:187], a[48:51], v[104:107]
    ds_read_b128 v[160:163], v5 offset:16384
    v_mfma_f32_16x16x32_bf16 v[108:111], v[184:187], a[52:55], v[108:111]
    v_mul_f32 v227, v219, v223
    v_cvt_pk_bf16_f32 v204, v224, v225
    v_mfma_f32_16x16x32_bf16 v[112:115], v[188:191], a[48:51], v[112:115]
    ds_read_b128 v[164:167], v5 offset:17408
    v_mfma_f32_16x16x32_bf16 v[116:119], v[188:191], a[52:55], v[116:119]
    s_add_u32 m0, s29, 4096
    s_add_u32 s28, s27, 114688
    buffer_load_dwordx4 v3, s[8:11], s28 offen offset:0 sc1 lds
    s_waitcnt lgkmcnt(4)
    v_mfma_f32_16x16x32_bf16 v[120:123], v[144:147], a[48:51], v[120:123]
    ds_read_b128 v[168:171], v5 offset:18432
    v_mfma_f32_16x16x32_bf16 v[124:127], v[144:147], a[52:55], v[124:127]
    v_cvt_pk_bf16_f32 v205, v226, v227
    v_fma_f32 v216, v255, v228, v64
    v_mfma_f32_16x16x32_bf16 v[72:75], v[148:151], a[56:59], v[72:75]
    ds_read_b128 v[172:175], v5 offset:19456
    v_mfma_f32_16x16x32_bf16 v[76:79], v[148:151], a[60:63], v[76:79]
    buffer_load_dwordx4 v3, s[8:11], s28 offen offset:1024 sc1 lds
    s_waitcnt lgkmcnt(4)
    v_mfma_f32_16x16x32_bf16 v[80:83], v[152:155], a[56:59], v[80:83]
    ds_read_b128 v[176:179], v5 offset:20480
    v_mfma_f32_16x16x32_bf16 v[84:87], v[152:155], a[60:63], v[84:87]
    v_fma_f32 v217, v255, v229, v65
    v_fma_f32 v218, v255, v230, v66
    v_mfma_f32_16x16x32_bf16 v[88:91], v[156:159], a[56:59], v[88:91]
    ds_read_b128 v[180:183], v5 offset:21504
    v_mfma_f32_16x16x32_bf16 v[92:95], v[156:159], a[60:63], v[92:95]
    buffer_load_dwordx4 v3, s[8:11], s28 offen offset:2048 sc1 lds
    s_waitcnt lgkmcnt(4)
    v_mfma_f32_16x16x32_bf16 v[96:99], v[160:163], a[56:59], v[96:99]
    ds_read_b128 v[184:187], v5 offset:22528
    v_mfma_f32_16x16x32_bf16 v[100:103], v[160:163], a[60:63], v[100:103]
    v_fma_f32 v219, v255, v231, v67
    v_fma_f32 v220, v255, v232, v68
    v_mfma_f32_16x16x32_bf16 v[104:107], v[164:167], a[56:59], v[104:107]
    ds_read_b128 v[188:191], v5 offset:23552
    v_mfma_f32_16x16x32_bf16 v[108:111], v[164:167], a[60:63], v[108:111]
    buffer_load_dwordx4 v3, s[8:11], s28 offen offset:3072 sc1 lds
    s_waitcnt lgkmcnt(4)
    v_mfma_f32_16x16x32_bf16 v[112:115], v[168:171], a[56:59], v[112:115]
    ds_read_b128 v[144:147], v5 offset:24576
    v_mfma_f32_16x16x32_bf16 v[116:119], v[168:171], a[60:63], v[116:119]
    v_fma_f32 v221, v255, v233, v69
    v_fma_f32 v222, v255, v234, v70
    v_mfma_f32_16x16x32_bf16 v[120:123], v[172:175], a[56:59], v[120:123]
    ds_read_b128 v[148:151], v5 offset:25600
    v_mfma_f32_16x16x32_bf16 v[124:127], v[172:175], a[60:63], v[124:127]
    s_add_u32 m0, s29, 8192
    s_add_u32 s28, s27, 118784
    buffer_load_dwordx4 v3, s[8:11], s28 offen offset:0 sc1 lds
    s_waitcnt lgkmcnt(4)
    v_mfma_f32_16x16x32_bf16 v[72:75], v[176:179], a[64:67], v[72:75]
    ds_read_b128 v[152:155], v5 offset:26624
    v_mfma_f32_16x16x32_bf16 v[76:79], v[176:179], a[68:71], v[76:79]
    v_fma_f32 v223, v255, v235, v71
    v_mul_f32 v224, v216, v220
    v_mfma_f32_16x16x32_bf16 v[80:83], v[180:183], a[64:67], v[80:83]
    ds_read_b128 v[156:159], v5 offset:27648
    v_mfma_f32_16x16x32_bf16 v[84:87], v[180:183], a[68:71], v[84:87]
    s_add_u32 s63, s57, 2048
    buffer_load_dwordx4 a[128:131], v3, s[8:11], s63 offen sc1
    s_waitcnt lgkmcnt(4)
    v_mfma_f32_16x16x32_bf16 v[88:91], v[184:187], a[64:67], v[88:91]
    ds_read_b128 v[160:163], v5 offset:28672
    v_mfma_f32_16x16x32_bf16 v[92:95], v[184:187], a[68:71], v[92:95]
    v_mul_f32 v225, v217, v221
    v_mul_f32 v226, v218, v222
    v_mfma_f32_16x16x32_bf16 v[96:99], v[188:191], a[64:67], v[96:99]
    ds_read_b128 v[164:167], v5 offset:29696
    v_mfma_f32_16x16x32_bf16 v[100:103], v[188:191], a[68:71], v[100:103]
    buffer_load_dwordx4 a[132:135], v249, s[8:11], s63 offen sc1
    s_waitcnt lgkmcnt(4)
    v_mfma_f32_16x16x32_bf16 v[104:107], v[144:147], a[64:67], v[104:107]
    ds_read_b128 v[168:171], v5 offset:30720
    v_mfma_f32_16x16x32_bf16 v[108:111], v[144:147], a[68:71], v[108:111]
    v_mul_f32 v227, v219, v223
    v_cvt_pk_bf16_f32 v206, v224, v225
    v_mfma_f32_16x16x32_bf16 v[112:115], v[148:151], a[64:67], v[112:115]
    ds_read_b128 v[172:175], v5 offset:31744
    v_mfma_f32_16x16x32_bf16 v[116:119], v[148:151], a[68:71], v[116:119]
    s_add_u32 s63, s57, 11264
    buffer_load_dwordx4 a[136:139], v3, s[8:11], s63 offen sc1
    s_waitcnt lgkmcnt(4)
    v_mfma_f32_16x16x32_bf16 v[120:123], v[152:155], a[64:67], v[120:123]
    ds_read_b128 v[176:179], v5 offset:32768
    v_mfma_f32_16x16x32_bf16 v[124:127], v[152:155], a[68:71], v[124:127]
    v_cvt_pk_bf16_f32 v207, v226, v227
    s_add_u32 s38, s38, s40
    buffer_store_dwordx4 v[204:207], v3, s[8:11], s38 offen sc1
    v_mfma_f32_16x16x32_bf16 v[72:75], v[156:159], a[72:75], v[72:75]
    ds_read_b128 v[180:183], v5 offset:33792
    v_mfma_f32_16x16x32_bf16 v[76:79], v[156:159], a[76:79], v[76:79]
    buffer_load_dwordx4 a[140:143], v249, s[8:11], s63 offen sc1
    buffer_load_dword v248, v246, s[8:11], s62 offen offset:256 sc1
    s_waitcnt lgkmcnt(4)
    v_mfma_f32_16x16x32_bf16 v[80:83], v[160:163], a[72:75], v[80:83]
    ds_read_b128 v[184:187], v5 offset:34816
    v_mfma_f32_16x16x32_bf16 v[84:87], v[160:163], a[76:79], v[84:87]
    v_mfma_f32_16x16x32_bf16 v[88:91], v[164:167], a[72:75], v[88:91]
    ds_read_b128 v[188:191], v5 offset:35840
    v_mfma_f32_16x16x32_bf16 v[92:95], v[164:167], a[76:79], v[92:95]
    s_add_u32 s63, s57, 20480
    buffer_load_dwordx4 a[144:147], v3, s[8:11], s63 offen sc1
    s_waitcnt vmcnt(27)
    s_barrier
    s_waitcnt lgkmcnt(4)
    v_mfma_f32_16x16x32_bf16 v[96:99], v[168:171], a[72:75], v[96:99]
    ds_read_b128 v[144:147], v6 offset:0
    v_mfma_f32_16x16x32_bf16 v[100:103], v[168:171], a[76:79], v[100:103]
    v_mfma_f32_16x16x32_bf16 v[104:107], v[172:175], a[72:75], v[104:107]
    ds_read_b128 v[148:151], v6 offset:1024
    v_mfma_f32_16x16x32_bf16 v[108:111], v[172:175], a[76:79], v[108:111]
    buffer_load_dwordx4 a[148:151], v249, s[8:11], s63 offen sc1
    s_waitcnt lgkmcnt(4)
    v_mfma_f32_16x16x32_bf16 v[112:115], v[176:179], a[72:75], v[112:115]
    ds_read_b128 v[152:155], v6 offset:2048
    v_mfma_f32_16x16x32_bf16 v[116:119], v[176:179], a[76:79], v[116:119]
    v_mfma_f32_16x16x32_bf16 v[120:123], v[180:183], a[72:75], v[120:123]
    ds_read_b128 v[156:159], v6 offset:3072
    v_mfma_f32_16x16x32_bf16 v[124:127], v[180:183], a[76:79], v[124:127]
    s_add_u32 s63, s57, 29696
    buffer_load_dwordx4 a[152:155], v3, s[8:11], s63 offen sc1
    s_waitcnt lgkmcnt(4)
    v_mfma_f32_16x16x32_bf16 v[72:75], v[184:187], a[80:83], v[72:75]
    ds_read_b128 v[160:163], v6 offset:4096
    v_mfma_f32_16x16x32_bf16 v[76:79], v[184:187], a[84:87], v[76:79]
    v_mfma_f32_16x16x32_bf16 v[80:83], v[188:191], a[80:83], v[80:83]
    ds_read_b128 v[164:167], v6 offset:5120
    v_mfma_f32_16x16x32_bf16 v[84:87], v[188:191], a[84:87], v[84:87]
    buffer_load_dwordx4 a[156:159], v249, s[8:11], s63 offen sc1
    s_waitcnt lgkmcnt(4)
    v_mfma_f32_16x16x32_bf16 v[88:91], v[144:147], a[80:83], v[88:91]
    ds_read_b128 v[168:171], v6 offset:6144
    v_mfma_f32_16x16x32_bf16 v[92:95], v[144:147], a[84:87], v[92:95]
    v_mfma_f32_16x16x32_bf16 v[96:99], v[148:151], a[80:83], v[96:99]
    ds_read_b128 v[172:175], v6 offset:7168
    v_mfma_f32_16x16x32_bf16 v[100:103], v[148:151], a[84:87], v[100:103]
    s_add_u32 s63, s57, 7168
    buffer_load_dwordx4 a[160:163], v3, s[8:11], s63 offen sc1
    s_waitcnt lgkmcnt(4)
    v_mfma_f32_16x16x32_bf16 v[104:107], v[152:155], a[80:83], v[104:107]
    ds_read_b128 v[176:179], v6 offset:8192
    v_mfma_f32_16x16x32_bf16 v[108:111], v[152:155], a[84:87], v[108:111]
    v_mfma_f32_16x16x32_bf16 v[112:115], v[156:159], a[80:83], v[112:115]
    ds_read_b128 v[180:183], v6 offset:9216
    v_mfma_f32_16x16x32_bf16 v[116:119], v[156:159], a[84:87], v[116:119]
    buffer_load_dwordx4 a[164:167], v249, s[8:11], s63 offen sc1
    s_waitcnt lgkmcnt(4)
    v_mfma_f32_16x16x32_bf16 v[120:123], v[160:163], a[80:83], v[120:123]
    ds_read_b128 v[184:187], v6 offset:10240
    v_mfma_f32_16x16x32_bf16 v[124:127], v[160:163], a[84:87], v[124:127]
    s_waitcnt vmcnt(30)
    v_mfma_f32_16x16x32_bf16 v[72:75], v[164:167], a[88:91], v[72:75]
    ds_read_b128 v[188:191], v6 offset:11264
    v_mfma_f32_16x16x32_bf16 v[76:79], v[164:167], a[92:95], v[76:79]
    s_add_u32 m0, s29, 36864
    s_add_u32 s28, s27, 147456
    buffer_load_dwordx4 v3, s[8:11], s28 offen offset:0 sc1 lds
    s_waitcnt lgkmcnt(4)
    v_mfma_f32_16x16x32_bf16 v[80:83], v[168:171], a[88:91], v[80:83]
    ds_read_b128 v[144:147], v6 offset:12288
    v_mfma_f32_16x16x32_bf16 v[84:87], v[168:171], a[92:95], v[84:87]
    v_mfma_f32_16x16x32_bf16 v[88:91], v[172:175], a[88:91], v[88:91]
    ds_read_b128 v[148:151], v6 offset:13312
    v_mfma_f32_16x16x32_bf16 v[92:95], v[172:175], a[92:95], v[92:95]
    buffer_load_dwordx4 v3, s[8:11], s28 offen offset:1024 sc1 lds
    s_waitcnt lgkmcnt(4)
    v_mfma_f32_16x16x32_bf16 v[96:99], v[176:179], a[88:91], v[96:99]
    ds_read_b128 v[152:155], v6 offset:14336
    v_mfma_f32_16x16x32_bf16 v[100:103], v[176:179], a[92:95], v[100:103]
    v_mfma_f32_16x16x32_bf16 v[104:107], v[180:183], a[88:91], v[104:107]
    ds_read_b128 v[156:159], v6 offset:15360
    v_mfma_f32_16x16x32_bf16 v[108:111], v[180:183], a[92:95], v[108:111]
    buffer_load_dwordx4 v3, s[8:11], s28 offen offset:2048 sc1 lds
    s_waitcnt lgkmcnt(4)
    v_mfma_f32_16x16x32_bf16 v[112:115], v[184:187], a[88:91], v[112:115]
    ds_read_b128 v[160:163], v6 offset:16384
    v_mfma_f32_16x16x32_bf16 v[116:119], v[184:187], a[92:95], v[116:119]
    v_mfma_f32_16x16x32_bf16 v[120:123], v[188:191], a[88:91], v[120:123]
    ds_read_b128 v[164:167], v6 offset:17408
    v_mfma_f32_16x16x32_bf16 v[124:127], v[188:191], a[92:95], v[124:127]
    buffer_load_dwordx4 v3, s[8:11], s28 offen offset:3072 sc1 lds
    s_waitcnt vmcnt(32)
    s_waitcnt lgkmcnt(4)
    v_mfma_f32_16x16x32_bf16 v[72:75], v[144:147], a[96:99], v[72:75]
    ds_read_b128 v[168:171], v6 offset:18432
    v_mfma_f32_16x16x32_bf16 v[76:79], v[144:147], a[100:103], v[76:79]
    v_mfma_f32_16x16x32_bf16 v[80:83], v[148:151], a[96:99], v[80:83]
    ds_read_b128 v[172:175], v6 offset:19456
    v_mfma_f32_16x16x32_bf16 v[84:87], v[148:151], a[100:103], v[84:87]
    s_add_u32 m0, s29, 40960
    s_add_u32 s28, s27, 151552
    buffer_load_dwordx4 v3, s[8:11], s28 offen offset:0 sc1 lds
    s_waitcnt lgkmcnt(4)
    v_mfma_f32_16x16x32_bf16 v[88:91], v[152:155], a[96:99], v[88:91]
    ds_read_b128 v[176:179], v6 offset:20480
    v_mfma_f32_16x16x32_bf16 v[92:95], v[152:155], a[100:103], v[92:95]
    v_mfma_f32_16x16x32_bf16 v[96:99], v[156:159], a[96:99], v[96:99]
    ds_read_b128 v[180:183], v6 offset:21504
    v_mfma_f32_16x16x32_bf16 v[100:103], v[156:159], a[100:103], v[100:103]
    buffer_load_dwordx4 v3, s[8:11], s28 offen offset:1024 sc1 lds
    s_waitcnt lgkmcnt(4)
    v_mfma_f32_16x16x32_bf16 v[104:107], v[160:163], a[96:99], v[104:107]
    ds_read_b128 v[184:187], v6 offset:22528
    v_mfma_f32_16x16x32_bf16 v[108:111], v[160:163], a[100:103], v[108:111]
    v_mfma_f32_16x16x32_bf16 v[112:115], v[164:167], a[96:99], v[112:115]
    ds_read_b128 v[188:191], v6 offset:23552
    v_mfma_f32_16x16x32_bf16 v[116:119], v[164:167], a[100:103], v[116:119]
    buffer_load_dwordx4 v3, s[8:11], s28 offen offset:2048 sc1 lds
    s_waitcnt lgkmcnt(4)
    v_mfma_f32_16x16x32_bf16 v[120:123], v[168:171], a[96:99], v[120:123]
    ds_read_b128 v[144:147], v6 offset:24576
    v_mfma_f32_16x16x32_bf16 v[124:127], v[168:171], a[100:103], v[124:127]
    s_waitcnt vmcnt(33)
    v_mfma_f32_16x16x32_bf16 v[72:75], v[172:175], a[104:107], v[72:75]
    ds_read_b128 v[148:151], v6 offset:25600
    v_mfma_f32_16x16x32_bf16 v[76:79], v[172:175], a[108:111], v[76:79]
    buffer_load_dwordx4 v3, s[8:11], s28 offen offset:3072 sc1 lds
    s_waitcnt vmcnt(14)
    v_readfirstlane_b32 s64, v248
    s_nop 0
    s_bitcmp1_b32 s64, 11
    s_cbranch_scc0 k3_kernel_slowC
k3_kernel_backC:
    s_waitcnt lgkmcnt(4)
    v_mfma_f32_16x16x32_bf16 v[80:83], v[176:179], a[104:107], v[80:83]
    ds_read_b128 v[152:155], v6 offset:26624
    v_mfma_f32_16x16x32_bf16 v[84:87], v[176:179], a[108:111], v[84:87]
    v_mfma_f32_16x16x32_bf16 v[88:91], v[180:183], a[104:107], v[88:91]
    ds_read_b128 v[156:159], v6 offset:27648
    v_mfma_f32_16x16x32_bf16 v[92:95], v[180:183], a[108:111], v[92:95]
    s_add_u32 m0, s29, 45056
    s_add_u32 s28, s27, 155648
    buffer_load_dwordx4 v3, s[8:11], s28 offen offset:0 sc1 lds
    s_waitcnt lgkmcnt(4)
    v_mfma_f32_16x16x32_bf16 v[96:99], v[184:187], a[104:107], v[96:99]
    ds_read_b128 v[160:163], v6 offset:28672
    v_mfma_f32_16x16x32_bf16 v[100:103], v[184:187], a[108:111], v[100:103]
    v_mfma_f32_16x16x32_bf16 v[104:107], v[188:191], a[104:107], v[104:107]
    ds_read_b128 v[164:167], v6 offset:29696
    v_mfma_f32_16x16x32_bf16 v[108:111], v[188:191], a[108:111], v[108:111]
    s_add_u32 s63, s57, 16384
    buffer_load_dwordx4 a[168:171], v3, s[8:11], s63 offen sc1
    s_mov_b64 exec, 1
    v_mov_b32 v247, 4096
    buffer_atomic_add v247, v246, s[8:11], s61 offen offset:384
    s_mov_b64 exec, -1
    s_waitcnt lgkmcnt(4)
    v_mfma_f32_16x16x32_bf16 v[112:115], v[144:147], a[104:107], v[112:115]
    ds_read_b128 v[168:171], v6 offset:30720
    v_mfma_f32_16x16x32_bf16 v[116:119], v[144:147], a[108:111], v[116:119]
    v_mfma_f32_16x16x32_bf16 v[120:123], v[148:151], a[104:107], v[120:123]
    ds_read_b128 v[172:175], v6 offset:31744
    v_mfma_f32_16x16x32_bf16 v[124:127], v[148:151], a[108:111], v[124:127]
    buffer_load_dwordx4 a[172:175], v249, s[8:11], s63 offen sc1
    s_waitcnt lgkmcnt(4)
    v_mfma_f32_16x16x32_bf16 v[72:75], v[152:155], a[112:115], v[72:75]
    ds_read_b128 v[176:179], v6 offset:32768
    v_mfma_f32_16x16x32_bf16 v[76:79], v[152:155], a[116:119], v[76:79]
    v_mfma_f32_16x16x32_bf16 v[80:83], v[156:159], a[112:115], v[80:83]
    ds_read_b128 v[180:183], v6 offset:33792
    v_mfma_f32_16x16x32_bf16 v[84:87], v[156:159], a[116:119], v[84:87]
    s_add_u32 s63, s57, 25600
    buffer_load_dwordx4 a[176:179], v3, s[8:11], s63 offen sc1
    s_waitcnt lgkmcnt(4)
    v_mfma_f32_16x16x32_bf16 v[88:91], v[160:163], a[112:115], v[88:91]
    ds_read_b128 v[184:187], v6 offset:34816
    v_mfma_f32_16x16x32_bf16 v[92:95], v[160:163], a[116:119], v[92:95]
    v_mfma_f32_16x16x32_bf16 v[96:99], v[164:167], a[112:115], v[96:99]
    ds_read_b128 v[188:191], v6 offset:35840
    v_mfma_f32_16x16x32_bf16 v[100:103], v[164:167], a[116:119], v[100:103]
    buffer_load_dwordx4 a[180:183], v249, s[8:11], s63 offen sc1
    s_barrier
    s_waitcnt lgkmcnt(4)
    v_mfma_f32_16x16x32_bf16 v[104:107], v[168:171], a[112:115], v[104:107]
    ds_read_b128 v[144:147], v3 offset:0
    v_mfma_f32_16x16x32_bf16 v[108:111], v[168:171], a[116:119], v[108:111]
    v_mfma_f32_16x16x32_bf16 v[112:115], v[172:175], a[112:115], v[112:115]
    ds_read_b128 v[148:151], v3 offset:1024
    v_mfma_f32_16x16x32_bf16 v[116:119], v[172:175], a[116:119], v[116:119]
    s_add_u32 s63, s57, 34816
    buffer_load_dwordx4 a[184:187], v3, s[8:11], s63 offen sc1
    s_waitcnt lgkmcnt(4)
    v_mfma_f32_16x16x32_bf16 v[120:123], v[176:179], a[112:115], v[120:123]
    ds_read_b128 v[152:155], v3 offset:2048
    v_mfma_f32_16x16x32_bf16 v[124:127], v[176:179], a[116:119], v[124:127]
    v_mfma_f32_16x16x32_bf16 v[72:75], v[180:183], a[120:123], v[72:75]
    ds_read_b128 v[156:159], v3 offset:3072
    v_mfma_f32_16x16x32_bf16 v[76:79], v[180:183], a[124:127], v[76:79]
    buffer_load_dwordx4 a[188:191], v249, s[8:11], s63 offen sc1
    s_waitcnt lgkmcnt(4)
    v_mfma_f32_16x16x32_bf16 v[80:83], v[184:187], a[120:123], v[80:83]
    ds_read_b128 v[160:163], v3 offset:4096
    v_mfma_f32_16x16x32_bf16 v[84:87], v[184:187], a[124:127], v[84:87]
    v_mfma_f32_16x16x32_bf16 v[88:91], v[188:191], a[120:123], v[88:91]
    ds_read_b128 v[164:167], v3 offset:5120
    v_mfma_f32_16x16x32_bf16 v[92:95], v[188:191], a[124:127], v[92:95]
    s_add_u32 s63, s57, 3072
    buffer_load_dwordx4 a[192:195], v3, s[8:11], s63 offen sc1
    s_waitcnt lgkmcnt(4)
    v_mfma_f32_16x16x32_bf16 v[96:99], v[144:147], a[120:123], v[96:99]
    ds_read_b128 v[168:171], v3 offset:6144
    v_mfma_f32_16x16x32_bf16 v[100:103], v[144:147], a[124:127], v[100:103]
    v_mfma_f32_16x16x32_bf16 v[104:107], v[148:151], a[120:123], v[104:107]
    ds_read_b128 v[172:175], v3 offset:7168
    v_mfma_f32_16x16x32_bf16 v[108:111], v[148:151], a[124:127], v[108:111]
    buffer_load_dwordx4 a[196:199], v249, s[8:11], s63 offen sc1
    s_waitcnt lgkmcnt(4)
    v_mfma_f32_16x16x32_bf16 v[112:115], v[152:155], a[120:123], v[112:115]
    ds_read_b128 v[176:179], v3 offset:8192
    v_mfma_f32_16x16x32_bf16 v[116:119], v[152:155], a[124:127], v[116:119]
    v_and_b32 v49, 15, v1
    v_lshrrev_b32 v51, 5, v1
    v_bfe_u32 v52, v1, 4, 1
    v_lshl_add_u32 v51, v52, 1, v51
    v_mfma_f32_16x16x32_bf16 v[120:123], v[156:159], a[120:123], v[120:123]
    ds_read_b128 v[180:183], v3 offset:9216
    v_mfma_f32_16x16x32_bf16 v[124:127], v[156:159], a[124:127], v[124:127]
    s_add_u32 s63, s57, 12288
    buffer_load_dwordx4 a[200:203], v3, s[8:11], s63 offen sc1
    s_waitcnt lgkmcnt(4)
    v_mfma_f32_16x16x32_bf16 v[72:75], v[160:163], a[128:131], v[72:75]
    ds_read_b128 v[184:187], v3 offset:10240
    v_mfma_f32_16x16x32_bf16 v[76:79], v[160:163], a[132:135], v[76:79]
    v_lshlrev_b32 v40, 4, v49
    v_lshl_add_u32 v40, v51, 8, v40
    v_mul_u32_u24 v41, 1152, v49
    v_lshl_add_u32 v41, v51, 4, v41
    v_mfma_f32_16x16x32_bf16 v[80:83], v[164:167], a[128:131], v[80:83]
    ds_read_b128 v[188:191], v3 offset:11264
    v_mfma_f32_16x16x32_bf16 v[84:87], v[164:167], a[132:135], v[84:87]
    buffer_load_dwordx4 a[204:207], v249, s[8:11], s63 offen sc1
    s_waitcnt lgkmcnt(4)
    v_mfma_f32_16x16x32_bf16 v[88:91], v[168:171], a[128:131], v[88:91]
    ds_read_b128 v[144:147], v3 offset:12288
    v_mfma_f32_16x16x32_bf16 v[92:95], v[168:171], a[132:135], v[92:95]
    v_lshlrev_b32 v49, 3, v49
    v_and_b32 v50, 3, v1
    v_bfe_u32 v51, v1, 3, 1
    v_bfe_u32 v52, v1, 2, 1
    v_mfma_f32_16x16x32_bf16 v[96:99], v[172:175], a[128:131], v[96:99]
    ds_read_b128 v[148:151], v3 offset:13312
    v_mfma_f32_16x16x32_bf16 v[100:103], v[172:175], a[132:135], v[100:103]
    s_add_u32 m0, s29, 73728
    s_add_u32 s28, s27, 184320
    buffer_load_dwordx4 v3, s[8:11], s28 offen offset:0 sc1 lds
    s_waitcnt lgkmcnt(4)
    v_mfma_f32_16x16x32_bf16 v[104:107], v[176:179], a[128:131], v[104:107]
    ds_read_b128 v[152:155], v3 offset:14336
    v_mfma_f32_16x16x32_bf16 v[108:111], v[176:179], a[132:135], v[108:111]
    v_lshlrev_b32 v44, 8, v51
    v_lshl_add_u32 v44, v50, 4, v44
    v_lshl_add_u32 v44, v52, 3, v44
    v_bfe_u32 v51, v1, 2, 2
    v_mfma_f32_16x16x32_bf16 v[112:115], v[180:183], a[128:131], v[112:115]
    ds_read_b128 v[156:159], v3 offset:15360
    v_mfma_f32_16x16x32_bf16 v[116:119], v[180:183], a[132:135], v[116:119]
    buffer_load_dwordx4 v3, s[8:11], s28 offen offset:1024 sc1 lds
    s_waitcnt lgkmcnt(4)
    v_mfma_f32_16x16x32_bf16 v[120:123], v[184:187], a[128:131], v[120:123]
    ds_read_b128 v[160:163], v3 offset:16384
    v_mfma_f32_16x16x32_bf16 v[124:127], v[184:187], a[132:135], v[124:127]
    v_mul_u32_u24 v45, 1152, v50
    v_lshl_add_u32 v45, v51, 3, v45
    v_lshlrev_b32 v48, 10, v51
    v_lshl_add_u32 v48, v50, 4, v48
    v_mfma_f32_16x16x32_bf16 v[72:75], v[188:191], a[136:139], v[72:75]
    ds_read_b128 v[164:167], v3 offset:17408
    v_mfma_f32_16x16x32_bf16 v[76:79], v[188:191], a[140:143], v[76:79]
    buffer_load_dwordx4 v3, s[8:11], s28 offen offset:2048 sc1 lds
    s_waitcnt lgkmcnt(4)
    v_mfma_f32_16x16x32_bf16 v[80:83], v[144:147], a[136:139], v[80:83]
    ds_read_b128 v[168:171], v3 offset:18432
    v_mfma_f32_16x16x32_bf16 v[84:87], v[144:147], a[140:143], v[84:87]
    v_lshrrev_b32 v51, 4, v1
    v_lshl_add_u32 v48, v51, 6, v48
    v_lshlrev_b32 v50, 3, v50
    s_mul_i32 s48, s54, 9
    v_mfma_f32_16x16x32_bf16 v[88:91], v[148:151], a[136:139], v[88:91]
    ds_read_b128 v[172:175], v3 offset:19456
    v_mfma_f32_16x16x32_bf16 v[92:95], v[148:151], a[140:143], v[92:95]
    buffer_load_dwordx4 v3, s[8:11], s28 offen offset:3072 sc1 lds
    s_waitcnt lgkmcnt(4)
    v_mfma_f32_16x16x32_bf16 v[96:99], v[152:155], a[136:139], v[96:99]
    ds_read_b128 v[176:179], v3 offset:20480
    v_mfma_f32_16x16x32_bf16 v[100:103], v[152:155], a[140:143], v[100:103]
    s_and_b32 s50, s54, 1
    s_lshl_b32 s41, s52, 1
    s_add_u32 s41, s41, s48
    s_add_u32 s41, s41, s50
    v_mfma_f32_16x16x32_bf16 v[104:107], v[156:159], a[136:139], v[104:107]
    ds_read_b128 v[180:183], v3 offset:21504
    v_mfma_f32_16x16x32_bf16 v[108:111], v[156:159], a[140:143], v[108:111]
    s_add_u32 m0, s29, 77824
    s_add_u32 s28, s27, 188416
    buffer_load_dwordx4 v3, s[8:11], s28 offen offset:0 sc1 lds
    s_waitcnt lgkmcnt(4)
    v_mfma_f32_16x16x32_bf16 v[112:115], v[160:163], a[136:139], v[112:115]
    ds_read_b128 v[184:187], v3 offset:22528
    v_mfma_f32_16x16x32_bf16 v[116:119], v[160:163], a[140:143], v[116:119]
    s_lshl_b32 s50, s50, 3
    s_add_u32 s49, s48, 8
    s_sub_u32 s49, s49, s50
    s_mul_i32 s50, s55, 36864
    v_mfma_f32_16x16x32_bf16 v[120:123], v[164:167], a[136:139], v[120:123]
    ds_read_b128 v[188:191], v3 offset:23552
    v_mfma_f32_16x16x32_bf16 v[124:127], v[164:167], a[140:143], v[124:127]
    buffer_load_dwordx4 v3, s[8:11], s28 offen offset:1024 sc1 lds
    s_waitcnt vmcnt(30)
    s_waitcnt lgkmcnt(4)
    v_mfma_f32_16x16x32_bf16 v[72:75], v[168:171], a[144:147], v[72:75]
    ds_read_b128 v[144:147], v3 offset:24576
    v_mfma_f32_16x16x32_bf16 v[76:79], v[168:171], a[148:151], v[76:79]
    s_add_u32 s50, s50, 7864320
    s_lshl_b32 s40, s41, 9
    s_add_u32 s40, s40, s50
    s_add_u32 s39, s40, 18432
    v_mfma_f32_16x16x32_bf16 v[80:83], v[172:175], a[144:147], v[80:83]
    ds_read_b128 v[148:151], v3 offset:25600
    v_mfma_f32_16x16x32_bf16 v[84:87], v[172:175], a[148:151], v[84:87]
    buffer_load_dwordx4 v3, s[8:11], s28 offen offset:2048 sc1 lds
    s_waitcnt lgkmcnt(4)
    v_mfma_f32_16x16x32_bf16 v[88:91], v[176:179], a[144:147], v[88:91]
    ds_read_b128 v[152:155], v3 offset:26624
    v_mfma_f32_16x16x32_bf16 v[92:95], v[176:179], a[148:151], v[92:95]
    s_lshl_b32 s38, s49, 9
    s_add_u32 s38, s38, s50
    s_lshl_b32 s50, s52, 6
    s_add_u32 s38, s38, s50
    v_mfma_f32_16x16x32_bf16 v[96:99], v[180:183], a[144:147], v[96:99]
    ds_read_b128 v[156:159], v3 offset:27648
    v_mfma_f32_16x16x32_bf16 v[100:103], v[180:183], a[148:151], v[100:103]
    buffer_load_dwordx4 v3, s[8:11], s28 offen offset:3072 sc1 lds
    s_waitcnt lgkmcnt(4)
    v_mfma_f32_16x16x32_bf16 v[104:107], v[184:187], a[144:147], v[104:107]
    ds_read_b128 v[160:163], v3 offset:28672
    v_mfma_f32_16x16x32_bf16 v[108:111], v[184:187], a[148:151], v[108:111]
    s_add_u32 s37, s38, 18432
    s_mul_i32 s50, s55, 36864
    s_lshl_b32 s42, s41, 5
    s_add_u32 s42, s42, s50
    v_mfma_f32_16x16x32_bf16 v[112:115], v[188:191], a[144:147], v[112:115]
    ds_read_b128 v[164:167], v3 offset:29696
    v_mfma_f32_16x16x32_bf16 v[116:119], v[188:191], a[148:151], v[116:119]
    s_add_u32 m0, s29, 81920
    s_add_u32 s28, s27, 192512
    buffer_load_dwordx4 v3, s[8:11], s28 offen offset:0 sc1 lds
    s_waitcnt lgkmcnt(4)
    v_mfma_f32_16x16x32_bf16 v[120:123], v[144:147], a[144:147], v[120:123]
    ds_read_b128 v[168:171], v3 offset:30720
    v_mfma_f32_16x16x32_bf16 v[124:127], v[144:147], a[148:151], v[124:127]
    s_add_u32 s36, s42, 18432
    s_lshl_b32 s34, s49, 5
    s_add_u32 s34, s34, s50
    s_mul_i32 s50, s52, 4608
    s_waitcnt vmcnt(31)
    v_mfma_f32_16x16x32_bf16 v[72:75], v[148:151], a[152:155], v[72:75]
    ds_read_b128 v[172:175], v3 offset:31744
    v_mfma_f32_16x16x32_bf16 v[76:79], v[148:151], a[156:159], v[76:79]
    s_add_u32 s63, s57, 21504
    buffer_load_dwordx4 a[208:211], v3, s[8:11], s63 offen sc1
    s_waitcnt lgkmcnt(4)
    v_mfma_f32_16x16x32_bf16 v[80:83], v[152:155], a[152:155], v[80:83]
    ds_read_b128 v[176:179], v3 offset:32768
    v_mfma_f32_16x16x32_bf16 v[84:87], v[152:155], a[156:159], v[84:87]
    s_add_u32 s34, s34, s50
    s_add_u32 s33, s34, 18432
    s_lshl_b32 s32, s55, 8
    s_add_u32 s32, s32, 13631492
    v_mfma_f32_16x16x32_bf16 v[88:91], v[156:159], a[152:155], v[88:91]
    ds_read_b128 v[180:183], v3 offset:33792
    v_mfma_f32_16x16x32_bf16 v[92:95], v[156:159], a[156:159], v[92:95]
    buffer_load_dwordx4 a[212:215], v249, s[8:11], s63 offen sc1
    s_waitcnt lgkmcnt(4)
    v_mfma_f32_16x16x32_bf16 v[96:99], v[160:163], a[152:155], v[96:99]
    ds_read_b128 v[184:187], v3 offset:34816
    v_mfma_f32_16x16x32_bf16 v[100:103], v[160:163], a[156:159], v[100:103]
    s_lshl_b32 s31, s52, 5
    s_add_u32 s31, s31, s32
    s_mov_b32 s43, 0xffff0000
    s_lshl_b32 s50, s55, 2
    v_mfma_f32_16x16x32_bf16 v[104:107], v[164:167], a[152:155], v[104:107]
    ds_read_b128 v[188:191], v3 offset:35840
    v_mfma_f32_16x16x32_bf16 v[108:111], v[164:167], a[156:159], v[108:111]
    s_add_u32 s63, s57, 30720
    buffer_load_dwordx4 a[216:219], v3, s[8:11], s63 offen sc1
    s_waitcnt vmcnt(23)
    s_barrier
    s_waitcnt lgkmcnt(4)
    v_mfma_f32_16x16x32_bf16 v[112:115], v[168:171], a[152:155], v[112:115]
    ds_read_b128 v[144:147], v4 offset:0
    v_mfma_f32_16x16x32_bf16 v[116:119], v[168:171], a[156:159], v[116:119]
    s_add_u32 s50, s50, s54
    s_mul_i32 s44, s50, 24576
    s_mul_i32 s48, s52, 6144
    s_add_u32 s44, s44, s48
    v_mfma_f32_16x16x32_bf16 v[120:123], v[172:175], a[152:155], v[120:123]
    ds_read_b128 v[148:151], v4 offset:1024
    v_mfma_f32_16x16x32_bf16 v[124:127], v[172:175], a[156:159], v[124:127]
    buffer_load_dwordx4 a[220:223], v249, s[8:11], s63 offen sc1
    buffer_load_dword v248, v246, s[8:11], s62 offen offset:384 sc1
    s_waitcnt lgkmcnt(4)
    v_mfma_f32_16x16x32_bf16 v[72:75], v[176:179], a[160:163], v[72:75]
    ds_read_b128 v[152:155], v4 offset:2048
    v_mfma_f32_16x16x32_bf16 v[76:79], v[176:179], a[164:167], v[76:79]
    s_add_u32 s44, s44, 54525952
    s_add_u32 s45, s44, 4096
    s_lshl_b32 s50, s50, 12
    s_add_u32 s50, s50, 60817408
    v_mfma_f32_16x16x32_bf16 v[80:83], v[180:183], a[160:163], v[80:83]
    ds_read_b128 v[156:159], v4 offset:3072
    v_mfma_f32_16x16x32_bf16 v[84:87], v[180:183], a[164:167], v[84:87]
    s_add_u32 s63, s57, 8192
    buffer_load_dwordx4 a[224:227], v3, s[8:11], s63 offen sc1
    s_waitcnt lgkmcnt(4)
    v_mfma_f32_16x16x32_bf16 v[88:91], v[184:187], a[160:163], v[88:91]
    ds_read_b128 v[160:163], v4 offset:4096
    v_mfma_f32_16x16x32_bf16 v[92:95], v[184:187], a[164:167], v[92:95]
    s_lshl_b32 s46, s52, 8
L_pad_k3_kernel_7:
    s_cbranch_execz k3_kernel_end
    s_add_u32 s46, s46, s50
    s_lshl_b32 s47, s52, 10
    s_add_u32 s47, s47, s50
    v_mfma_f32_16x16x32_bf16 v[96:99], v[188:191], a[160:163], v[96:99]
    ds_read_b128 v[164:167], v4 offset:5120
    v_mfma_f32_16x16x32_bf16 v[100:103], v[188:191], a[164:167], v[100:103]
    buffer_load_dwordx4 a[228:231], v249, s[8:11], s63 offen sc1
    s_waitcnt lgkmcnt(4)
    v_mfma_f32_16x16x32_bf16 v[104:107], v[144:147], a[160:163], v[104:107]
    ds_read_b128 v[168:171], v4 offset:6144
    v_mfma_f32_16x16x32_bf16 v[108:111], v[144:147], a[164:167], v[108:111]
    v_mfma_f32_16x16x32_bf16 v[112:115], v[148:151], a[160:163], v[112:115]
    ds_read_b128 v[172:175], v4 offset:7168
    v_mfma_f32_16x16x32_bf16 v[116:119], v[148:151], a[164:167], v[116:119]
    s_add_u32 s63, s57, 17408
    buffer_load_dwordx4 a[232:235], v3, s[8:11], s63 offen sc1
    s_waitcnt lgkmcnt(4)
    v_mfma_f32_16x16x32_bf16 v[120:123], v[152:155], a[160:163], v[120:123]
    ds_read_b128 v[176:179], v4 offset:8192
    v_mfma_f32_16x16x32_bf16 v[124:127], v[152:155], a[164:167], v[124:127]
    s_waitcnt vmcnt(25)
    v_mfma_f32_16x16x32_bf16 v[72:75], v[156:159], a[168:171], v[72:75]
    ds_read_b128 v[180:183], v4 offset:9216
    v_mfma_f32_16x16x32_bf16 v[76:79], v[156:159], a[172:175], v[76:79]
    buffer_load_dwordx4 a[236:239], v249, s[8:11], s63 offen sc1
    s_waitcnt lgkmcnt(4)
    v_mfma_f32_16x16x32_bf16 v[80:83], v[160:163], a[168:171], v[80:83]
    ds_read_b128 v[184:187], v4 offset:10240
    v_mfma_f32_16x16x32_bf16 v[84:87], v[160:163], a[172:175], v[84:87]
    v_mfma_f32_16x16x32_bf16 v[88:91], v[164:167], a[168:171], v[88:91]
    ds_read_b128 v[188:191], v4 offset:11264
    v_mfma_f32_16x16x32_bf16 v[92:95], v[164:167], a[172:175], v[92:95]
    s_add_u32 s63, s57, 26624
    buffer_load_dwordx4 a[240:243], v3, s[8:11], s63 offen sc1
    s_waitcnt lgkmcnt(4)
    v_mfma_f32_16x16x32_bf16 v[96:99], v[168:171], a[168:171], v[96:99]
    ds_read_b128 v[144:147], v4 offset:12288
    v_mfma_f32_16x16x32_bf16 v[100:103], v[168:171], a[172:175], v[100:103]
    v_mfma_f32_16x16x32_bf16 v[104:107], v[172:175], a[168:171], v[104:107]
    ds_read_b128 v[148:151], v4 offset:13312
    v_mfma_f32_16x16x32_bf16 v[108:111], v[172:175], a[172:175], v[108:111]
    buffer_load_dwordx4 a[244:247], v249, s[8:11], s63 offen sc1
    s_waitcnt lgkmcnt(4)
    v_mfma_f32_16x16x32_bf16 v[112:115], v[176:179], a[168:171], v[112:115]
    ds_read_b128 v[152:155], v4 offset:14336
    v_mfma_f32_16x16x32_bf16 v[116:119], v[176:179], a[172:175], v[116:119]
    v_mfma_f32_16x16x32_bf16 v[120:123], v[180:183], a[168:171], v[120:123]
    ds_read_b128 v[156:159], v4 offset:15360
    v_mfma_f32_16x16x32_bf16 v[124:127], v[180:183], a[172:175], v[124:127]
    s_add_u32 m0, s29, 110592
    s_add_u32 s28, s27, 221184
    buffer_load_dwordx4 v3, s[8:11], s28 offen offset:0 sc1 lds
    s_waitcnt vmcnt(27)
    s_waitcnt lgkmcnt(4)
    v_mfma_f32_16x16x32_bf16 v[72:75], v[184:187], a[176:179], v[72:75]
    ds_read_b128 v[160:163], v4 offset:16384
    v_mfma_f32_16x16x32_bf16 v[76:79], v[184:187], a[180:183], v[76:79]
    v_mfma_f32_16x16x32_bf16 v[80:83], v[188:191], a[176:179], v[80:83]
    ds_read_b128 v[164:167], v4 offset:17408
    v_mfma_f32_16x16x32_bf16 v[84:87], v[188:191], a[180:183], v[84:87]
    buffer_load_dwordx4 v3, s[8:11], s28 offen offset:1024 sc1 lds
    s_waitcnt lgkmcnt(4)
    v_mfma_f32_16x16x32_bf16 v[88:91], v[144:147], a[176:179], v[88:91]
    ds_read_b128 v[168:171], v4 offset:18432
    v_mfma_f32_16x16x32_bf16 v[92:95], v[144:147], a[180:183], v[92:95]
    v_mfma_f32_16x16x32_bf16 v[96:99], v[148:151], a[176:179], v[96:99]
    ds_read_b128 v[172:175], v4 offset:19456
    v_mfma_f32_16x16x32_bf16 v[100:103], v[148:151], a[180:183], v[100:103]
    buffer_load_dwordx4 v3, s[8:11], s28 offen offset:2048 sc1 lds
    s_waitcnt lgkmcnt(4)
    v_mfma_f32_16x16x32_bf16 v[104:107], v[152:155], a[176:179], v[104:107]
    ds_read_b128 v[176:179], v4 offset:20480
    v_mfma_f32_16x16x32_bf16 v[108:111], v[152:155], a[180:183], v[108:111]
    v_mfma_f32_16x16x32_bf16 v[112:115], v[156:159], a[176:179], v[112:115]
    ds_read_b128 v[180:183], v4 offset:21504
    v_mfma_f32_16x16x32_bf16 v[116:119], v[156:159], a[180:183], v[116:119]
    buffer_load_dwordx4 v3, s[8:11], s28 offen offset:3072 sc1 lds
    s_waitcnt lgkmcnt(4)
    v_mfma_f32_16x16x32_bf16 v[120:123], v[160:163], a[176:179], v[120:123]
    ds_read_b128 v[184:187], v4 offset:22528
    v_mfma_f32_16x16x32_bf16 v[124:127], v[160:163], a[180:183], v[124:127]
    s_waitcnt vmcnt(28)
    v_mfma_f32_16x16x32_bf16 v[72:75], v[164:167], a[184:187], v[72:75]
    ds_read_b128 v[188:191], v4 offset:23552
    v_mfma_f32_16x16x32_bf16 v[76:79], v[164:167], a[188:191], v[76:79]
    s_add_u32 m0, s29, 114688
    s_add_u32 s28, s27, 225280
    buffer_load_dwordx4 v3, s[8:11], s28 offen offset:0 sc1 lds
    s_waitcnt lgkmcnt(4)
    v_mfma_f32_16x16x32_bf16 v[80:83], v[168:171], a[184:187], v[80:83]
    ds_read_b128 v[144:147], v4 offset:24576
    v_mfma_f32_16x16x32_bf16 v[84:87], v[168:171], a[188:191], v[84:87]
    v_mfma_f32_16x16x32_bf16 v[88:91], v[172:175], a[184:187], v[88:91]
    ds_read_b128 v[148:151], v4 offset:25600
    v_mfma_f32_16x16x32_bf16 v[92:95], v[172:175], a[188:191], v[92:95]
    buffer_load_dwordx4 v3, s[8:11], s28 offen offset:1024 sc1 lds
    s_waitcnt lgkmcnt(4)
    v_mfma_f32_16x16x32_bf16 v[96:99], v[176:179], a[184:187], v[96:99]
    ds_read_b128 v[152:155], v4 offset:26624
    v_mfma_f32_16x16x32_bf16 v[100:103], v[176:179], a[188:191], v[100:103]
    v_mfma_f32_16x16x32_bf16 v[104:107], v[180:183], a[184:187], v[104:107]
    ds_read_b128 v[156:159], v4 offset:27648
    v_mfma_f32_16x16x32_bf16 v[108:111], v[180:183], a[188:191], v[108:111]
    buffer_load_dwordx4 v3, s[8:11], s28 offen offset:2048 sc1 lds
    s_waitcnt lgkmcnt(4)
    v_mfma_f32_16x16x32_bf16 v[112:115], v[184:187], a[184:187], v[112:115]
    ds_read_b128 v[160:163], v4 offset:28672
    v_mfma_f32_16x16x32_bf16 v[116:119], v[184:187], a[188:191], v[116:119]
    v_mfma_f32_16x16x32_bf16 v[120:123], v[188:191], a[184:187], v[120:123]
    ds_read_b128 v[164:167], v4 offset:29696
    v_mfma_f32_16x16x32_bf16 v[124:127], v[188:191], a[188:191], v[124:127]
    buffer_load_dwordx4 v3, s[8:11], s28 offen offset:3072 sc1 lds
    s_waitcnt vmcnt(14)
    v_readfirstlane_b32 s64, v248
    s_nop 0
    s_bitcmp1_b32 s64, 15
    s_cbranch_scc0 k3_kernel_slowD
k3_kernel_backD:
    s_waitcnt lgkmcnt(4)
    v_mfma_f32_16x16x32_bf16 v[72:75], v[144:147], a[192:195], v[72:75]
    ds_read_b128 v[168:171], v4 offset:30720
    v_mfma_f32_16x16x32_bf16 v[76:79], v[144:147], a[196:199], v[76:79]
    v_mfma_f32_16x16x32_bf16 v[80:83], v[148:151], a[192:195], v[80:83]
    ds_read_b128 v[172:175], v4 offset:31744
    v_mfma_f32_16x16x32_bf16 v[84:87], v[148:151], a[196:199], v[84:87]
    s_add_u32 m0, s29, 118784
    s_add_u32 s28, s27, 229376
    buffer_load_dwordx4 v3, s[8:11], s28 offen offset:0 sc1 lds
    s_waitcnt lgkmcnt(4)
    v_mfma_f32_16x16x32_bf16 v[88:91], v[152:155], a[192:195], v[88:91]
    ds_read_b128 v[176:179], v4 offset:32768
    v_mfma_f32_16x16x32_bf16 v[92:95], v[152:155], a[196:199], v[92:95]
    v_mfma_f32_16x16x32_bf16 v[96:99], v[156:159], a[192:195], v[96:99]
    ds_read_b128 v[180:183], v4 offset:33792
    v_mfma_f32_16x16x32_bf16 v[100:103], v[156:159], a[196:199], v[100:103]
    s_add_u32 s63, s57, 35840
    buffer_load_dwordx4 a[248:251], v3, s[8:11], s63 offen sc1
    s_waitcnt lgkmcnt(4)
    v_mfma_f32_16x16x32_bf16 v[104:107], v[160:163], a[192:195], v[104:107]
    ds_read_b128 v[184:187], v4 offset:34816
    v_mfma_f32_16x16x32_bf16 v[108:111], v[160:163], a[196:199], v[108:111]
    v_mfma_f32_16x16x32_bf16 v[112:115], v[164:167], a[192:195], v[112:115]
    ds_read_b128 v[188:191], v4 offset:35840
    v_mfma_f32_16x16x32_bf16 v[116:119], v[164:167], a[196:199], v[116:119]
    buffer_load_dwordx4 a[252:255], v249, s[8:11], s63 offen sc1
    s_barrier
    s_waitcnt lgkmcnt(4)
    v_mfma_f32_16x16x32_bf16 v[120:123], v[168:171], a[192:195], v[120:123]
    ds_read_b128 v[144:147], v5 offset:0
    v_mfma_f32_16x16x32_bf16 v[124:127], v[168:171], a[196:199], v[124:127]
    v_mfma_f32_16x16x32_bf16 v[72:75], v[172:175], a[200:203], v[72:75]
    ds_read_b128 v[148:151], v5 offset:1024
    v_mfma_f32_16x16x32_bf16 v[76:79], v[172:175], a[204:207], v[76:79]
    s_add_u32 s63, s57, 4096
    buffer_load_dwordx4 v[8:11], v3, s[8:11], s63 offen sc1
    buffer_load_dword v248, v246, s[8:11], s81 offen offset:0 sc1
    s_waitcnt lgkmcnt(4)
    v_mfma_f32_16x16x32_bf16 v[80:83], v[176:179], a[200:203], v[80:83]
    ds_read_b128 v[152:155], v5 offset:2048
    v_mfma_f32_16x16x32_bf16 v[84:87], v[176:179], a[204:207], v[84:87]
    v_mfma_f32_16x16x32_bf16 v[88:91], v[180:183], a[200:203], v[88:91]
    ds_read_b128 v[156:159], v5 offset:3072
    v_mfma_f32_16x16x32_bf16 v[92:95], v[180:183], a[204:207], v[92:95]
    buffer_load_dwordx4 v[12:15], v249, s[8:11], s63 offen sc1
    s_waitcnt lgkmcnt(4)
    v_mfma_f32_16x16x32_bf16 v[96:99], v[184:187], a[200:203], v[96:99]
    ds_read_b128 v[160:163], v5 offset:4096
    v_mfma_f32_16x16x32_bf16 v[100:103], v[184:187], a[204:207], v[100:103]
    v_mfma_f32_16x16x32_bf16 v[104:107], v[188:191], a[200:203], v[104:107]
    ds_read_b128 v[164:167], v5 offset:5120
    v_mfma_f32_16x16x32_bf16 v[108:111], v[188:191], a[204:207], v[108:111]
    s_add_u32 s63, s57, 13312
    buffer_load_dwordx4 v[16:19], v3, s[8:11], s63 offen sc1
    s_waitcnt lgkmcnt(4)
    v_mfma_f32_16x16x32_bf16 v[112:115], v[144:147], a[200:203], v[112:115]
    ds_read_b128 v[168:171], v5 offset:6144
    v_mfma_f32_16x16x32_bf16 v[116:119], v[144:147], a[204:207], v[116:119]
    v_mfma_f32_16x16x32_bf16 v[120:123], v[148:151], a[200:203], v[120:123]
    ds_read_b128 v[172:175], v5 offset:7168
    v_mfma_f32_16x16x32_bf16 v[124:127], v[148:151], a[204:207], v[124:127]
    buffer_load_dwordx4 v[20:23], v249, s[8:11], s63 offen sc1
    s_waitcnt lgkmcnt(4)
    v_mfma_f32_16x16x32_bf16 v[72:75], v[152:155], a[208:211], v[72:75]
    ds_read_b128 v[176:179], v5 offset:8192
    v_mfma_f32_16x16x32_bf16 v[76:79], v[152:155], a[212:215], v[76:79]
    v_mfma_f32_16x16x32_bf16 v[80:83], v[156:159], a[208:211], v[80:83]
    ds_read_b128 v[180:183], v5 offset:9216
    v_mfma_f32_16x16x32_bf16 v[84:87], v[156:159], a[212:215], v[84:87]
    s_add_u32 s63, s57, 22528
    buffer_load_dwordx4 v[24:27], v3, s[8:11], s63 offen sc1
    s_waitcnt lgkmcnt(4)
    v_mfma_f32_16x16x32_bf16 v[88:91], v[160:163], a[208:211], v[88:91]
    ds_read_b128 v[184:187], v5 offset:10240
    v_mfma_f32_16x16x32_bf16 v[92:95], v[160:163], a[212:215], v[92:95]
    v_mfma_f32_16x16x32_bf16 v[96:99], v[164:167], a[208:211], v[96:99]
    ds_read_b128 v[188:191], v5 offset:11264
    v_mfma_f32_16x16x32_bf16 v[100:103], v[164:167], a[212:215], v[100:103]
    buffer_load_dwordx4 v[28:31], v249, s[8:11], s63 offen sc1
    s_waitcnt lgkmcnt(4)
    v_mfma_f32_16x16x32_bf16 v[104:107], v[168:171], a[208:211], v[104:107]
    ds_read_b128 v[144:147], v5 offset:12288
    v_mfma_f32_16x16x32_bf16 v[108:111], v[168:171], a[212:215], v[108:111]
    v_mfma_f32_16x16x32_bf16 v[112:115], v[172:175], a[208:211], v[112:115]
    ds_read_b128 v[148:151], v5 offset:13312
    v_mfma_f32_16x16x32_bf16 v[116:119], v[172:175], a[212:215], v[116:119]
    s_add_u32 s63, s57, 31744
    buffer_load_dwordx4 v[32:35], v3, s[8:11], s63 offen sc1
    s_waitcnt lgkmcnt(4)
    v_mfma_f32_16x16x32_bf16 v[120:123], v[176:179], a[208:211], v[120:123]
    ds_read_b128 v[152:155], v5 offset:14336
    v_mfma_f32_16x16x32_bf16 v[124:127], v[176:179], a[212:215], v[124:127]
    v_mfma_f32_16x16x32_bf16 v[72:75], v[180:183], a[216:219], v[72:75]
    ds_read_b128 v[156:159], v5 offset:15360
    v_mfma_f32_16x16x32_bf16 v[76:79], v[180:183], a[220:223], v[76:79]
    buffer_load_dwordx4 v[36:39], v249, s[8:11], s63 offen sc1
    s_waitcnt lgkmcnt(4)
    v_mfma_f32_16x16x32_bf16 v[80:83], v[184:187], a[216:219], v[80:83]
    ds_read_b128 v[160:163], v5 offset:16384
    v_mfma_f32_16x16x32_bf16 v[84:87], v[184:187], a[220:223], v[84:87]
    v_mfma_f32_16x16x32_bf16 v[88:91], v[188:191], a[216:219], v[88:91]
    ds_read_b128 v[164:167], v5 offset:17408
    v_mfma_f32_16x16x32_bf16 v[92:95], v[188:191], a[220:223], v[92:95]
    s_add_u32 m0, s29, 0
    s_add_u32 s28, s27, 258048
    buffer_load_dwordx4 v3, s[8:11], s28 offen offset:0 sc1 lds
    s_waitcnt lgkmcnt(4)
    v_mfma_f32_16x16x32_bf16 v[96:99], v[144:147], a[216:219], v[96:99]
    ds_read_b128 v[168:171], v5 offset:18432
    v_mfma_f32_16x16x32_bf16 v[100:103], v[144:147], a[220:223], v[100:103]
    v_mfma_f32_16x16x32_bf16 v[104:107], v[148:151], a[216:219], v[104:107]
    ds_read_b128 v[172:175], v5 offset:19456
    v_mfma_f32_16x16x32_bf16 v[108:111], v[148:151], a[220:223], v[108:111]
    buffer_load_dwordx4 v3, s[8:11], s28 offen offset:1024 sc1 lds
    s_waitcnt lgkmcnt(4)
    v_mfma_f32_16x16x32_bf16 v[112:115], v[152:155], a[216:219], v[112:115]
    ds_read_b128 v[176:179], v5 offset:20480
    v_mfma_f32_16x16x32_bf16 v[116:119], v[152:155], a[220:223], v[116:119]
    v_mfma_f32_16x16x32_bf16 v[120:123], v[156:159], a[216:219], v[120:123]
    ds_read_b128 v[180:183], v5 offset:21504
    v_mfma_f32_16x16x32_bf16 v[124:127], v[156:159], a[220:223], v[124:127]
    buffer_load_dwordx4 v3, s[8:11], s28 offen offset:2048 sc1 lds
    s_waitcnt vmcnt(27)
    s_waitcnt lgkmcnt(4)
    v_mfma_f32_16x16x32_bf16 v[72:75], v[160:163], a[224:227], v[72:75]
    ds_read_b128 v[184:187], v5 offset:22528
    v_mfma_f32_16x16x32_bf16 v[76:79], v[160:163], a[228:231], v[76:79]
    v_mfma_f32_16x16x32_bf16 v[80:83], v[164:167], a[224:227], v[80:83]
    ds_read_b128 v[188:191], v5 offset:23552
    v_mfma_f32_16x16x32_bf16 v[84:87], v[164:167], a[228:231], v[84:87]
    buffer_load_dwordx4 v3, s[8:11], s28 offen offset:3072 sc1 lds
    s_waitcnt lgkmcnt(4)
    v_mfma_f32_16x16x32_bf16 v[88:91], v[168:171], a[224:227], v[88:91]
    ds_read_b128 v[144:147], v5 offset:24576
    v_mfma_f32_16x16x32_bf16 v[92:95], v[168:171], a[228:231], v[92:95]
    v_mfma_f32_16x16x32_bf16 v[96:99], v[172:175], a[224:227], v[96:99]
    ds_read_b128 v[148:151], v5 offset:25600
    v_mfma_f32_16x16x32_bf16 v[100:103], v[172:175], a[228:231], v[100:103]
    s_add_u32 m0, s29, 4096
    s_add_u32 s28, s27, 262144
    buffer_load_dwordx4 v3, s[8:11], s28 offen offset:0 sc1 lds
    s_waitcnt lgkmcnt(4)
    v_mfma_f32_16x16x32_bf16 v[104:107], v[176:179], a[224:227], v[104:107]
    ds_read_b128 v[152:155], v5 offset:26624
    v_mfma_f32_16x16x32_bf16 v[108:111], v[176:179], a[228:231], v[108:111]
    v_mfma_f32_16x16x32_bf16 v[112:115], v[180:183], a[224:227], v[112:115]
    ds_read_b128 v[156:159], v5 offset:27648
    v_mfma_f32_16x16x32_bf16 v[116:119], v[180:183], a[228:231], v[116:119]
    buffer_load_dwordx4 v3, s[8:11], s28 offen offset:1024 sc1 lds
    s_waitcnt lgkmcnt(4)
    v_mfma_f32_16x16x32_bf16 v[120:123], v[184:187], a[224:227], v[120:123]
    ds_read_b128 v[160:163], v5 offset:28672
    v_mfma_f32_16x16x32_bf16 v[124:127], v[184:187], a[228:231], v[124:127]
    s_waitcnt vmcnt(28)
    v_mfma_f32_16x16x32_bf16 v[72:75], v[188:191], a[232:235], v[72:75]
    ds_read_b128 v[164:167], v5 offset:29696
    v_mfma_f32_16x16x32_bf16 v[76:79], v[188:191], a[236:239], v[76:79]
    buffer_load_dwordx4 v3, s[8:11], s28 offen offset:2048 sc1 lds
    s_waitcnt vmcnt(14)
    v_readfirstlane_b32 s64, v248
    s_nop 0
    s_cmp_ge_u32 s64, 32
    s_cbranch_scc0 k3_kernel_slowR
k3_kernel_backR:
    s_waitcnt lgkmcnt(4)
    v_mfma_f32_16x16x32_bf16 v[80:83], v[144:147], a[232:235], v[80:83]
    ds_read_b128 v[168:171], v5 offset:30720
    v_mfma_f32_16x16x32_bf16 v[84:87], v[144:147], a[236:239], v[84:87]
    v_mfma_f32_16x16x32_bf16 v[88:91], v[148:151], a[232:235], v[88:91]
    ds_read_b128 v[172:175], v5 offset:31744
    v_mfma_f32_16x16x32_bf16 v[92:95], v[148:151], a[236:239], v[92:95]
    buffer_load_dwordx4 v3, s[8:11], s28 offen offset:3072 sc1 lds
    s_waitcnt lgkmcnt(4)
    v_mfma_f32_16x16x32_bf16 v[96:99], v[152:155], a[232:235], v[96:99]
    ds_read_b128 v[176:179], v5 offset:32768
    v_mfma_f32_16x16x32_bf16 v[100:103], v[152:155], a[236:239], v[100:103]
    v_mfma_f32_16x16x32_bf16 v[104:107], v[156:159], a[232:235], v[104:107]
    ds_read_b128 v[180:183], v5 offset:33792
    v_mfma_f32_16x16x32_bf16 v[108:111], v[156:159], a[236:239], v[108:111]
    s_add_u32 m0, s29, 8192
    s_add_u32 s28, s27, 266240
    buffer_load_dwordx4 v3, s[8:11], s28 offen offset:0 sc1 lds
    s_waitcnt lgkmcnt(4)
    v_mfma_f32_16x16x32_bf16 v[112:115], v[160:163], a[232:235], v[112:115]
    ds_read_b128 v[184:187], v5 offset:34816
    v_mfma_f32_16x16x32_bf16 v[116:119], v[160:163], a[236:239], v[116:119]
    v_mfma_f32_16x16x32_bf16 v[120:123], v[164:167], a[232:235], v[120:123]
    ds_read_b128 v[188:191], v5 offset:35840
    v_mfma_f32_16x16x32_bf16 v[124:127], v[164:167], a[236:239], v[124:127]
    s_barrier
    s_waitcnt lgkmcnt(4)
    v_mfma_f32_16x16x32_bf16 v[72:75], v[168:171], a[240:243], v[72:75]
    ds_read_b128 v[144:147], v6 offset:0
    v_mfma_f32_16x16x32_bf16 v[76:79], v[168:171], a[244:247], v[76:79]
    v_mfma_f32_16x16x32_bf16 v[80:83], v[172:175], a[240:243], v[80:83]
    ds_read_b128 v[148:151], v6 offset:1024
    v_mfma_f32_16x16x32_bf16 v[84:87], v[172:175], a[244:247], v[84:87]
    s_add_u32 m0, s29, 36864
    s_add_u32 s28, s27, 294912
    buffer_load_dwordx4 v3, s[8:11], s28 offen offset:0 sc1 lds
    s_waitcnt lgkmcnt(4)
    v_mfma_f32_16x16x32_bf16 v[88:91], v[176:179], a[240:243], v[88:91]
    ds_read_b128 v[152:155], v6 offset:2048
    v_mfma_f32_16x16x32_bf16 v[92:95], v[176:179], a[244:247], v[92:95]
    v_mfma_f32_16x16x32_bf16 v[96:99], v[180:183], a[240:243], v[96:99]
    ds_read_b128 v[156:159], v6 offset:3072
    v_mfma_f32_16x16x32_bf16 v[100:103], v[180:183], a[244:247], v[100:103]
    buffer_load_dwordx4 v3, s[8:11], s28 offen offset:1024 sc1 lds
    s_waitcnt lgkmcnt(4)
    v_mfma_f32_16x16x32_bf16 v[104:107], v[184:187], a[240:243], v[104:107]
    ds_read_b128 v[160:163], v6 offset:4096
    v_mfma_f32_16x16x32_bf16 v[108:111], v[184:187], a[244:247], v[108:111]
    v_mfma_f32_16x16x32_bf16 v[112:115], v[188:191], a[240:243], v[112:115]
    ds_read_b128 v[164:167], v6 offset:5120
    v_mfma_f32_16x16x32_bf16 v[116:119], v[188:191], a[244:247], v[116:119]
    buffer_load_dwordx4 v3, s[8:11], s28 offen offset:2048 sc1 lds
    s_waitcnt lgkmcnt(4)
    v_mfma_f32_16x16x32_bf16 v[120:123], v[144:147], a[240:243], v[120:123]
    ds_read_b128 v[168:171], v6 offset:6144
    v_mfma_f32_16x16x32_bf16 v[124:127], v[144:147], a[244:247], v[124:127]
    v_mfma_f32_16x16x32_bf16 v[72:75], v[148:151], a[248:251], v[72:75]
    ds_read_b128 v[172:175], v6 offset:7168
    v_mfma_f32_16x16x32_bf16 v[76:79], v[148:151], a[252:255], v[76:79]
    buffer_load_dwordx4 v3, s[8:11], s28 offen offset:3072 sc1 lds
    s_waitcnt lgkmcnt(4)
    v_mfma_f32_16x16x32_bf16 v[80:83], v[152:155], a[248:251], v[80:83]
    ds_read_b128 v[176:179], v6 offset:8192
    v_mfma_f32_16x16x32_bf16 v[84:87], v[152:155], a[252:255], v[84:87]
    v_mfma_f32_16x16x32_bf16 v[88:91], v[156:159], a[248:251], v[88:91]
    ds_read_b128 v[180:183], v6 offset:15360
    v_mfma_f32_16x16x32_bf16 v[92:95], v[156:159], a[252:255], v[92:95]
    s_add_u32 m0, s29, 40960
    s_add_u32 s28, s27, 299008
    buffer_load_dwordx4 v3, s[8:11], s28 offen offset:0 sc1 lds
    s_waitcnt lgkmcnt(4)
    v_mfma_f32_16x16x32_bf16 v[96:99], v[160:163], a[248:251], v[96:99]
    ds_read_b128 v[184:187], v6 offset:22528
    v_mfma_f32_16x16x32_bf16 v[100:103], v[160:163], a[252:255], v[100:103]
    v_mfma_f32_16x16x32_bf16 v[104:107], v[164:167], a[248:251], v[104:107]
    ds_read_b128 v[188:191], v6 offset:29696
    v_mfma_f32_16x16x32_bf16 v[108:111], v[164:167], a[252:255], v[108:111]
    buffer_load_dwordx4 v3, s[8:11], s28 offen offset:1024 sc1 lds
    s_waitcnt lgkmcnt(4)
    v_mfma_f32_16x16x32_bf16 v[112:115], v[168:171], a[248:251], v[112:115]
    ds_read_b128 v[144:147], v6 offset:9216
    v_mfma_f32_16x16x32_bf16 v[116:119], v[168:171], a[252:255], v[116:119]
    v_mfma_f32_16x16x32_bf16 v[120:123], v[172:175], a[248:251], v[120:123]
    ds_read_b128 v[148:151], v6 offset:16384
    v_mfma_f32_16x16x32_bf16 v[124:127], v[172:175], a[252:255], v[124:127]
    buffer_load_dwordx4 v3, s[8:11], s28 offen offset:2048 sc1 lds
    s_waitcnt vmcnt(22)
    v_swap_b32 v10, v12
    v_swap_b32 v11, v13
    s_waitcnt lgkmcnt(4)
    s_nop 0
    v_mfma_f32_16x16x32_bf16 v[72:75], v[176:179], v[8:11], v[72:75]
    ds_read_b128 v[152:155], v6 offset:23552
    v_mfma_f32_16x16x32_bf16 v[76:79], v[176:179], v[12:15], v[76:79]
    s_waitcnt vmcnt(20)
    v_swap_b32 v18, v20
    v_swap_b32 v19, v21
    s_nop 1
    v_mfma_f32_16x16x32_bf16 v[72:75], v[180:183], v[16:19], v[72:75]
    ds_read_b128 v[156:159], v6 offset:30720
    v_mfma_f32_16x16x32_bf16 v[76:79], v[180:183], v[20:23], v[76:79]
    buffer_load_dwordx4 v3, s[8:11], s28 offen offset:3072 sc1 lds
    s_waitcnt vmcnt(19)
    v_swap_b32 v26, v28
    v_swap_b32 v27, v29
    s_waitcnt lgkmcnt(4)
    s_nop 0
    v_mfma_f32_16x16x32_bf16 v[72:75], v[184:187], v[24:27], v[72:75]
    ds_read_b128 v[160:163], v6 offset:10240
    v_mfma_f32_16x16x32_bf16 v[76:79], v[184:187], v[28:31], v[76:79]
    s_waitcnt vmcnt(17)
    v_swap_b32 v34, v36
    v_swap_b32 v35, v37
    s_nop 1
    v_mfma_f32_16x16x32_bf16 v[72:75], v[188:191], v[32:35], v[72:75]
    ds_read_b128 v[164:167], v6 offset:17408
    v_mfma_f32_16x16x32_bf16 v[76:79], v[188:191], v[36:39], v[76:79]
    s_add_u32 m0, s29, 45056
    s_add_u32 s28, s27, 303104
    buffer_load_dwordx4 v3, s[8:11], s28 offen offset:0 sc1 lds
    s_waitcnt lgkmcnt(4)
    v_mfma_f32_16x16x32_bf16 v[80:83], v[144:147], v[8:11], v[80:83]
    ds_read_b128 v[168:171], v6 offset:24576
    v_mfma_f32_16x16x32_bf16 v[84:87], v[144:147], v[12:15], v[84:87]
    v_mfma_f32_16x16x32_bf16 v[80:83], v[148:151], v[16:19], v[80:83]
    ds_read_b128 v[172:175], v6 offset:31744
    v_mfma_f32_16x16x32_bf16 v[84:87], v[148:151], v[20:23], v[84:87]
    s_waitcnt lgkmcnt(4)
    v_mfma_f32_16x16x32_bf16 v[80:83], v[152:155], v[24:27], v[80:83]
    ds_read_b128 v[176:179], v6 offset:11264
    v_mfma_f32_16x16x32_bf16 v[84:87], v[152:155], v[28:31], v[84:87]
    v_cvt_pk_bf16_f32 v72, v72, v73
    v_cvt_pk_bf16_f32 v73, v74, v75
    v_mfma_f32_16x16x32_bf16 v[80:83], v[156:159], v[32:35], v[80:83]
    ds_read_b128 v[180:183], v6 offset:18432
    v_mfma_f32_16x16x32_bf16 v[84:87], v[156:159], v[36:39], v[84:87]
    v_cvt_pk_bf16_f32 v74, v76, v77
    v_cvt_pk_bf16_f32 v75, v78, v79
    s_waitcnt lgkmcnt(4)
    v_mfma_f32_16x16x32_bf16 v[88:91], v[160:163], v[8:11], v[88:91]
    ds_read_b128 v[184:187], v6 offset:25600
    v_mfma_f32_16x16x32_bf16 v[92:95], v[160:163], v[12:15], v[92:95]
    buffer_store_dwordx4 v[72:75], v3, s[8:11], s58 offen offset:0 sc1
    v_mfma_f32_16x16x32_bf16 v[88:91], v[164:167], v[16:19], v[88:91]
    ds_read_b128 v[188:191], v6 offset:32768
    v_mfma_f32_16x16x32_bf16 v[92:95], v[164:167], v[20:23], v[92:95]
    s_waitcnt lgkmcnt(4)
    v_mfma_f32_16x16x32_bf16 v[88:91], v[168:171], v[24:27], v[88:91]
    ds_read_b128 v[144:147], v6 offset:12288
    v_mfma_f32_16x16x32_bf16 v[92:95], v[168:171], v[28:31], v[92:95]
    v_cvt_pk_bf16_f32 v80, v80, v81
    v_cvt_pk_bf16_f32 v81, v82, v83
    v_mfma_f32_16x16x32_bf16 v[88:91], v[172:175], v[32:35], v[88:91]
    ds_read_b128 v[148:151], v6 offset:19456
    v_mfma_f32_16x16x32_bf16 v[92:95], v[172:175], v[36:39], v[92:95]
    v_cvt_pk_bf16_f32 v82, v84, v85
    v_cvt_pk_bf16_f32 v83, v86, v87
    s_waitcnt lgkmcnt(4)
    v_mfma_f32_16x16x32_bf16 v[96:99], v[176:179], v[8:11], v[96:99]
    ds_read_b128 v[152:155], v6 offset:26624
    v_mfma_f32_16x16x32_bf16 v[100:103], v[176:179], v[12:15], v[100:103]
    buffer_store_dwordx4 v[80:83], v3, s[8:11], s58 offen offset:1024 sc1
    v_mfma_f32_16x16x32_bf16 v[96:99], v[180:183], v[16:19], v[96:99]
    ds_read_b128 v[156:159], v6 offset:33792
    v_mfma_f32_16x16x32_bf16 v[100:103], v[180:183], v[20:23], v[100:103]
    s_waitcnt lgkmcnt(4)
    v_mfma_f32_16x16x32_bf16 v[96:99], v[184:187], v[24:27], v[96:99]
    ds_read_b128 v[160:163], v6 offset:13312
    v_mfma_f32_16x16x32_bf16 v[100:103], v[184:187], v[28:31], v[100:103]
    v_cvt_pk_bf16_f32 v88, v88, v89
    v_cvt_pk_bf16_f32 v89, v90, v91
    v_mfma_f32_16x16x32_bf16 v[96:99], v[188:191], v[32:35], v[96:99]
    ds_read_b128 v[164:167], v6 offset:20480
    v_mfma_f32_16x16x32_bf16 v[100:103], v[188:191], v[36:39], v[100:103]
    v_cvt_pk_bf16_f32 v90, v92, v93
    v_cvt_pk_bf16_f32 v91, v94, v95
    s_waitcnt lgkmcnt(4)
    v_mfma_f32_16x16x32_bf16 v[104:107], v[144:147], v[8:11], v[104:107]
    ds_read_b128 v[168:171], v6 offset:27648
    v_mfma_f32_16x16x32_bf16 v[108:111], v[144:147], v[12:15], v[108:111]
    buffer_store_dwordx4 v[88:91], v3, s[8:11], s59 offen offset:2048 sc1
    v_mfma_f32_16x16x32_bf16 v[104:107], v[148:151], v[16:19], v[104:107]
    ds_read_b128 v[172:175], v6 offset:34816
    v_mfma_f32_16x16x32_bf16 v[108:111], v[148:151], v[20:23], v[108:111]
    s_waitcnt lgkmcnt(4)
    v_mfma_f32_16x16x32_bf16 v[104:107], v[152:155], v[24:27], v[104:107]
    ds_read_b128 v[176:179], v6 offset:14336
    v_mfma_f32_16x16x32_bf16 v[108:111], v[152:155], v[28:31], v[108:111]
    v_cvt_pk_bf16_f32 v96, v96, v97
    v_cvt_pk_bf16_f32 v97, v98, v99
    v_mfma_f32_16x16x32_bf16 v[104:107], v[156:159], v[32:35], v[104:107]
    ds_read_b128 v[180:183], v6 offset:21504
    v_mfma_f32_16x16x32_bf16 v[108:111], v[156:159], v[36:39], v[108:111]
    v_cvt_pk_bf16_f32 v98, v100, v101
    v_cvt_pk_bf16_f32 v99, v102, v103
    s_waitcnt lgkmcnt(4)
    v_mfma_f32_16x16x32_bf16 v[112:115], v[160:163], v[8:11], v[112:115]
    ds_read_b128 v[184:187], v6 offset:28672
    v_mfma_f32_16x16x32_bf16 v[116:119], v[160:163], v[12:15], v[116:119]
    buffer_store_dwordx4 v[96:99], v3, s[8:11], s59 offen offset:3072 sc1
    v_mfma_f32_16x16x32_bf16 v[112:115], v[164:167], v[16:19], v[112:115]
    ds_read_b128 v[188:191], v6 offset:35840
    v_mfma_f32_16x16x32_bf16 v[116:119], v[164:167], v[20:23], v[116:119]
    s_waitcnt vmcnt(13)
    s_barrier
    s_waitcnt lgkmcnt(4)
    v_mfma_f32_16x16x32_bf16 v[112:115], v[168:171], v[24:27], v[112:115]
    ds_read_b128 v[144:147], v3 offset:0
    v_mfma_f32_16x16x32_bf16 v[116:119], v[168:171], v[28:31], v[116:119]
    v_cvt_pk_bf16_f32 v104, v104, v105
    v_cvt_pk_bf16_f32 v105, v106, v107
    v_mfma_f32_16x16x32_bf16 v[112:115], v[172:175], v[32:35], v[112:115]
    ds_read_b128 v[148:151], v3 offset:1024
    v_mfma_f32_16x16x32_bf16 v[116:119], v[172:175], v[36:39], v[116:119]
    v_cvt_pk_bf16_f32 v106, v108, v109
    v_cvt_pk_bf16_f32 v107, v110, v111
    s_waitcnt lgkmcnt(4)
    v_mfma_f32_16x16x32_bf16 v[120:123], v[176:179], v[8:11], v[120:123]
    ds_read_b128 v[152:155], v3 offset:2048
    v_mfma_f32_16x16x32_bf16 v[124:127], v[176:179], v[12:15], v[124:127]
    s_add_u32 s35, s60, 4096
    buffer_store_dwordx4 v[104:107], v3, s[8:11], s35 offen offset:0 sc1
    v_mfma_f32_16x16x32_bf16 v[120:123], v[180:183], v[16:19], v[120:123]
    ds_read_b128 v[156:159], v3 offset:3072
    v_mfma_f32_16x16x32_bf16 v[124:127], v[180:183], v[20:23], v[124:127]
    s_waitcnt lgkmcnt(4)
    v_mfma_f32_16x16x32_bf16 v[120:123], v[184:187], v[24:27], v[120:123]
    ds_read_b128 v[160:163], v3 offset:4096
    v_mfma_f32_16x16x32_bf16 v[124:127], v[184:187], v[28:31], v[124:127]
    v_cvt_pk_bf16_f32 v112, v112, v113
    v_cvt_pk_bf16_f32 v113, v114, v115
    v_mfma_f32_16x16x32_bf16 v[120:123], v[188:191], v[32:35], v[120:123]
    ds_read_b128 v[164:167], v3 offset:5120
    v_mfma_f32_16x16x32_bf16 v[124:127], v[188:191], v[36:39], v[124:127]
    v_cvt_pk_bf16_f32 v114, v116, v117
    v_cvt_pk_bf16_f32 v115, v118, v119
    s_waitcnt lgkmcnt(4)
    v_mfma_f32_16x16x32_bf16 v[128:131], v[144:147], a[0:3], 0
    ds_read_b128 v[168:171], v3 offset:6144
    v_mfma_f32_16x16x32_bf16 v[132:135], v[144:147], a[4:7], 0
    s_add_u32 s35, s60, 4096
    buffer_store_dwordx4 v[112:115], v3, s[8:11], s35 offen offset:1024 sc1
    v_mfma_f32_16x16x32_bf16 v[136:139], v[148:151], a[0:3], 0
    ds_read_b128 v[172:175], v3 offset:7168
    v_mfma_f32_16x16x32_bf16 v[140:143], v[148:151], a[4:7], 0
    s_waitcnt lgkmcnt(4)
    v_mfma_f32_16x16x32_bf16 v[128:131], v[152:155], a[8:11], v[128:131]
    ds_read_b128 v[176:179], v3 offset:8192
    v_mfma_f32_16x16x32_bf16 v[132:135], v[152:155], a[12:15], v[132:135]
    v_cvt_pk_bf16_f32 v120, v120, v121
    v_cvt_pk_bf16_f32 v121, v122, v123
    v_mfma_f32_16x16x32_bf16 v[136:139], v[156:159], a[8:11], v[136:139]
    ds_read_b128 v[180:183], v3 offset:9216
    v_mfma_f32_16x16x32_bf16 v[140:143], v[156:159], a[12:15], v[140:143]
    v_cvt_pk_bf16_f32 v122, v124, v125
    v_cvt_pk_bf16_f32 v123, v126, v127
    s_waitcnt lgkmcnt(4)
    v_mfma_f32_16x16x32_bf16 v[128:131], v[160:163], a[16:19], v[128:131]
    ds_read_b128 v[184:187], v3 offset:10240
    v_mfma_f32_16x16x32_bf16 v[132:135], v[160:163], a[20:23], v[132:135]
    buffer_store_dwordx4 v[120:123], v48, s[8:11], s46 offen sc1
    v_mfma_f32_16x16x32_bf16 v[136:139], v[164:167], a[16:19], v[136:139]
    ds_read_b128 v[188:191], v3 offset:11264
    v_mfma_f32_16x16x32_bf16 v[140:143], v[164:167], a[20:23], v[140:143]
    buffer_load_dwordx4 v[56:59], v40, s[8:11], s40 offen
    s_waitcnt lgkmcnt(4)
    v_mfma_f32_16x16x32_bf16 v[128:131], v[168:171], a[24:27], v[128:131]
    ds_read_b128 v[144:147], v3 offset:12288
    v_mfma_f32_16x16x32_bf16 v[132:135], v[168:171], a[28:31], v[132:135]
    v_mfma_f32_16x16x32_bf16 v[136:139], v[172:175], a[24:27], v[136:139]
    ds_read_b128 v[148:151], v3 offset:13312
    v_mfma_f32_16x16x32_bf16 v[140:143], v[172:175], a[28:31], v[140:143]
    s_waitcnt lgkmcnt(4)
    v_mfma_f32_16x16x32_bf16 v[128:131], v[176:179], a[32:35], v[128:131]
    ds_read_b128 v[152:155], v3 offset:14336
    v_mfma_f32_16x16x32_bf16 v[132:135], v[176:179], a[36:39], v[132:135]
    buffer_load_dwordx4 v[60:63], v40, s[8:11], s39 offen
    v_mfma_f32_16x16x32_bf16 v[136:139], v[180:183], a[32:35], v[136:139]
    ds_read_b128 v[156:159], v3 offset:15360
    v_mfma_f32_16x16x32_bf16 v[140:143], v[180:183], a[36:39], v[140:143]
L_pad_k3_kernel_8:
    s_cbranch_execz k3_kernel_end
    s_waitcnt lgkmcnt(4)
    v_mfma_f32_16x16x32_bf16 v[128:131], v[184:187], a[40:43], v[128:131]
    ds_read_b128 v[160:163], v3 offset:16384
    v_mfma_f32_16x16x32_bf16 v[132:135], v[184:187], a[44:47], v[132:135]
    v_mfma_f32_16x16x32_bf16 v[136:139], v[188:191], a[40:43], v[136:139]
    ds_read_b128 v[164:167], v3 offset:17408
    v_mfma_f32_16x16x32_bf16 v[140:143], v[188:191], a[44:47], v[140:143]
    buffer_load_dwordx2 v[64:65], v44, s[8:11], s38 offen
    s_waitcnt lgkmcnt(4)
    v_mfma_f32_16x16x32_bf16 v[128:131], v[144:147], a[48:51], v[128:131]
    ds_read_b128 v[168:171], v3 offset:18432
    v_mfma_f32_16x16x32_bf16 v[132:135], v[144:147], a[52:55], v[132:135]
    v_mfma_f32_16x16x32_bf16 v[136:139], v[148:151], a[48:51], v[136:139]
    ds_read_b128 v[172:175], v3 offset:19456
    v_mfma_f32_16x16x32_bf16 v[140:143], v[148:151], a[52:55], v[140:143]
    s_waitcnt lgkmcnt(4)
    v_mfma_f32_16x16x32_bf16 v[128:131], v[152:155], a[56:59], v[128:131]
    ds_read_b128 v[176:179], v3 offset:20480
    v_mfma_f32_16x16x32_bf16 v[132:135], v[152:155], a[60:63], v[132:135]
    buffer_load_dwordx2 v[66:67], v44, s[8:11], s37 offen
    v_mfma_f32_16x16x32_bf16 v[136:139], v[156:159], a[56:59], v[136:139]
    ds_read_b128 v[180:183], v3 offset:21504
    v_mfma_f32_16x16x32_bf16 v[140:143], v[156:159], a[60:63], v[140:143]
    s_waitcnt lgkmcnt(4)
    v_mfma_f32_16x16x32_bf16 v[128:131], v[160:163], a[64:67], v[128:131]
    ds_read_b128 v[184:187], v3 offset:22528
    v_mfma_f32_16x16x32_bf16 v[132:135], v[160:163], a[68:71], v[132:135]
    v_mfma_f32_16x16x32_bf16 v[136:139], v[164:167], a[64:67], v[136:139]
    ds_read_b128 v[188:191], v3 offset:23552
    v_mfma_f32_16x16x32_bf16 v[140:143], v[164:167], a[68:71], v[140:143]
    buffer_load_dword v42, v49, s[8:11], s32 offen offset:0 sc1
    s_waitcnt lgkmcnt(4)
    v_mfma_f32_16x16x32_bf16 v[128:131], v[168:171], a[72:75], v[128:131]
    ds_read_b128 v[144:147], v3 offset:24576
    v_mfma_f32_16x16x32_bf16 v[132:135], v[168:171], a[76:79], v[132:135]
    v_mfma_f32_16x16x32_bf16 v[136:139], v[172:175], a[72:75], v[136:139]
    ds_read_b128 v[148:151], v3 offset:25600
    v_mfma_f32_16x16x32_bf16 v[140:143], v[172:175], a[76:79], v[140:143]
    s_waitcnt lgkmcnt(4)
    v_mfma_f32_16x16x32_bf16 v[128:131], v[176:179], a[80:83], v[128:131]
    ds_read_b128 v[152:155], v3 offset:26624
    v_mfma_f32_16x16x32_bf16 v[132:135], v[176:179], a[84:87], v[132:135]
    buffer_load_dword v43, v49, s[8:11], s32 offen offset:128 sc1
    v_mfma_f32_16x16x32_bf16 v[136:139], v[180:183], a[80:83], v[136:139]
    ds_read_b128 v[156:159], v3 offset:27648
    v_mfma_f32_16x16x32_bf16 v[140:143], v[180:183], a[84:87], v[140:143]
    s_waitcnt lgkmcnt(4)
    v_mfma_f32_16x16x32_bf16 v[128:131], v[184:187], a[88:91], v[128:131]
    ds_read_b128 v[160:163], v3 offset:28672
    v_mfma_f32_16x16x32_bf16 v[132:135], v[184:187], a[92:95], v[132:135]
    v_mfma_f32_16x16x32_bf16 v[136:139], v[188:191], a[88:91], v[136:139]
    ds_read_b128 v[164:167], v3 offset:29696
    v_mfma_f32_16x16x32_bf16 v[140:143], v[188:191], a[92:95], v[140:143]
    buffer_load_dword v46, v50, s[8:11], s31 offen offset:0 sc1
    s_waitcnt lgkmcnt(4)
    v_mfma_f32_16x16x32_bf16 v[128:131], v[144:147], a[96:99], v[128:131]
    ds_read_b128 v[168:171], v3 offset:30720
    v_mfma_f32_16x16x32_bf16 v[132:135], v[144:147], a[100:103], v[132:135]
    v_mfma_f32_16x16x32_bf16 v[136:139], v[148:151], a[96:99], v[136:139]
    ds_read_b128 v[172:175], v3 offset:31744
    v_mfma_f32_16x16x32_bf16 v[140:143], v[148:151], a[100:103], v[140:143]
    s_waitcnt lgkmcnt(4)
    v_mfma_f32_16x16x32_bf16 v[128:131], v[152:155], a[104:107], v[128:131]
    ds_read_b128 v[176:179], v3 offset:32768
    v_mfma_f32_16x16x32_bf16 v[132:135], v[152:155], a[108:111], v[132:135]
    buffer_load_dword v47, v50, s[8:11], s31 offen offset:128 sc1
    v_mfma_f32_16x16x32_bf16 v[136:139], v[156:159], a[104:107], v[136:139]
    ds_read_b128 v[180:183], v3 offset:33792
    v_mfma_f32_16x16x32_bf16 v[140:143], v[156:159], a[108:111], v[140:143]
    s_waitcnt vmcnt(8)
    s_mov_b64 exec, 1
    v_mov_b32 v247, 1
    buffer_atomic_add v247, v246, s[8:11], s51 offen offset:0
    s_mov_b64 exec, -1
    s_waitcnt lgkmcnt(4)
    v_mfma_f32_16x16x32_bf16 v[128:131], v[160:163], a[112:115], v[128:131]
    ds_read_b128 v[184:187], v3 offset:34816
    v_mfma_f32_16x16x32_bf16 v[132:135], v[160:163], a[116:119], v[132:135]
    v_mfma_f32_16x16x32_bf16 v[136:139], v[164:167], a[112:115], v[136:139]
    ds_read_b128 v[188:191], v3 offset:35840
    v_mfma_f32_16x16x32_bf16 v[140:143], v[164:167], a[116:119], v[140:143]
    s_barrier
    s_waitcnt lgkmcnt(4)
    v_mfma_f32_16x16x32_bf16 v[128:131], v[168:171], a[120:123], v[128:131]
    ds_read_b128 v[144:147], v4 offset:0
    v_mfma_f32_16x16x32_bf16 v[132:135], v[168:171], a[124:127], v[132:135]
    v_mfma_f32_16x16x32_bf16 v[136:139], v[172:175], a[120:123], v[136:139]
    ds_read_b128 v[148:151], v4 offset:1024
    v_mfma_f32_16x16x32_bf16 v[140:143], v[172:175], a[124:127], v[140:143]
    s_waitcnt lgkmcnt(4)
    v_mfma_f32_16x16x32_bf16 v[128:131], v[176:179], a[128:131], v[128:131]
    ds_read_b128 v[152:155], v4 offset:2048
    v_mfma_f32_16x16x32_bf16 v[132:135], v[176:179], a[132:135], v[132:135]
    v_mfma_f32_16x16x32_bf16 v[136:139], v[180:183], a[128:131], v[136:139]
    ds_read_b128 v[156:159], v4 offset:3072
    v_mfma_f32_16x16x32_bf16 v[140:143], v[180:183], a[132:135], v[140:143]
    s_waitcnt lgkmcnt(4)
    v_mfma_f32_16x16x32_bf16 v[128:131], v[184:187], a[136:139], v[128:131]
    ds_read_b128 v[160:163], v4 offset:4096
    v_mfma_f32_16x16x32_bf16 v[132:135], v[184:187], a[140:143], v[132:135]
    v_mfma_f32_16x16x32_bf16 v[136:139], v[188:191], a[136:139], v[136:139]
    ds_read_b128 v[164:167], v4 offset:5120
    v_mfma_f32_16x16x32_bf16 v[140:143], v[188:191], a[140:143], v[140:143]
    s_waitcnt lgkmcnt(4)
    v_mfma_f32_16x16x32_bf16 v[128:131], v[144:147], a[144:147], v[128:131]
    ds_read_b128 v[168:171], v4 offset:6144
    v_mfma_f32_16x16x32_bf16 v[132:135], v[144:147], a[148:151], v[132:135]
    v_mfma_f32_16x16x32_bf16 v[136:139], v[148:151], a[144:147], v[136:139]
    ds_read_b128 v[172:175], v4 offset:7168
    v_mfma_f32_16x16x32_bf16 v[140:143], v[148:151], a[148:151], v[140:143]
    s_waitcnt lgkmcnt(4)
    v_mfma_f32_16x16x32_bf16 v[128:131], v[152:155], a[152:155], v[128:131]
    ds_read_b128 v[176:179], v4 offset:8192
    v_mfma_f32_16x16x32_bf16 v[132:135], v[152:155], a[156:159], v[132:135]
    v_mfma_f32_16x16x32_bf16 v[136:139], v[156:159], a[152:155], v[136:139]
    ds_read_b128 v[180:183], v4 offset:9216
    v_mfma_f32_16x16x32_bf16 v[140:143], v[156:159], a[156:159], v[140:143]
    s_waitcnt lgkmcnt(4)
    v_mfma_f32_16x16x32_bf16 v[128:131], v[160:163], a[160:163], v[128:131]
    ds_read_b128 v[184:187], v4 offset:10240
    v_mfma_f32_16x16x32_bf16 v[132:135], v[160:163], a[164:167], v[132:135]
    v_mfma_f32_16x16x32_bf16 v[136:139], v[164:167], a[160:163], v[136:139]
    ds_read_b128 v[188:191], v4 offset:11264
    v_mfma_f32_16x16x32_bf16 v[140:143], v[164:167], a[164:167], v[140:143]
    s_waitcnt lgkmcnt(4)
    v_mfma_f32_16x16x32_bf16 v[128:131], v[168:171], a[168:171], v[128:131]
    ds_read_b128 v[144:147], v4 offset:12288
    v_mfma_f32_16x16x32_bf16 v[132:135], v[168:171], a[172:175], v[132:135]
    s_waitcnt vmcnt(1)
    v_lshlrev_b32 v200, 16, v56
    v_and_b32 v201, s43, v56
    v_lshlrev_b32 v202, 16, v57
    v_and_b32 v203, s43, v57
    v_mfma_f32_16x16x32_bf16 v[136:139], v[172:175], a[168:171], v[136:139]
    ds_read_b128 v[148:151], v4 offset:13312
    v_mfma_f32_16x16x32_bf16 v[140:143], v[172:175], a[172:175], v[140:143]
    v_lshlrev_b32 v204, 16, v58
    v_and_b32 v205, s43, v58
    v_lshlrev_b32 v206, 16, v59
    v_and_b32 v207, s43, v59
    buffer_load_dword v248, v246, s[8:11], s51 offen offset:0 sc1
    s_waitcnt lgkmcnt(4)
    v_mfma_f32_16x16x32_bf16 v[128:131], v[176:179], a[176:179], v[128:131]
    ds_read_b128 v[152:155], v4 offset:14336
    v_mfma_f32_16x16x32_bf16 v[132:135], v[176:179], a[180:183], v[132:135]
    v_lshlrev_b32 v208, 16, v60
    v_and_b32 v209, s43, v60
    v_lshlrev_b32 v210, 16, v61
    v_and_b32 v211, s43, v61
    v_mfma_f32_16x16x32_bf16 v[136:139], v[180:183], a[176:179], v[136:139]
    ds_read_b128 v[156:159], v4 offset:15360
    v_mfma_f32_16x16x32_bf16 v[140:143], v[180:183], a[180:183], v[140:143]
    v_lshlrev_b32 v212, 16, v62
    v_and_b32 v213, s43, v62
    v_lshlrev_b32 v214, 16, v63
    v_and_b32 v215, s43, v63
    s_waitcnt lgkmcnt(4)
    v_mfma_f32_16x16x32_bf16 v[128:131], v[184:187], a[184:187], v[128:131]
    ds_read_b128 v[160:163], v4 offset:16384
    v_mfma_f32_16x16x32_bf16 v[132:135], v[184:187], a[188:191], v[132:135]
    v_lshlrev_b32 v216, 16, v64
    v_and_b32 v217, s43, v64
    v_lshlrev_b32 v218, 16, v65
    v_and_b32 v219, s43, v65
    v_mfma_f32_16x16x32_bf16 v[136:139], v[188:191], a[184:187], v[136:139]
    ds_read_b128 v[164:167], v4 offset:17408
    v_mfma_f32_16x16x32_bf16 v[140:143], v[188:191], a[188:191], v[140:143]
    v_lshlrev_b32 v220, 16, v66
    v_and_b32 v221, s43, v66
    v_lshlrev_b32 v222, 16, v67
    v_and_b32 v223, s43, v67
    s_waitcnt lgkmcnt(4)
    v_mfma_f32_16x16x32_bf16 v[128:131], v[144:147], a[192:195], v[128:131]
    ds_read_b128 v[168:171], v4 offset:18432
    v_mfma_f32_16x16x32_bf16 v[132:135], v[144:147], a[196:199], v[132:135]
    v_mfma_f32_16x16x32_bf16 v[136:139], v[148:151], a[192:195], v[136:139]
    ds_read_b128 v[172:175], v4 offset:19456
    v_mfma_f32_16x16x32_bf16 v[140:143], v[148:151], a[196:199], v[140:143]
    s_waitcnt lgkmcnt(4)
    v_mfma_f32_16x16x32_bf16 v[128:131], v[152:155], a[200:203], v[128:131]
    ds_read_b128 v[176:179], v4 offset:20480
    v_mfma_f32_16x16x32_bf16 v[132:135], v[152:155], a[204:207], v[132:135]
    v_mfma_f32_16x16x32_bf16 v[136:139], v[156:159], a[200:203], v[136:139]
    ds_read_b128 v[180:183], v4 offset:21504
    v_mfma_f32_16x16x32_bf16 v[140:143], v[156:159], a[204:207], v[140:143]
    s_waitcnt lgkmcnt(4)
    v_mfma_f32_16x16x32_bf16 v[128:131], v[160:163], a[208:211], v[128:131]
    ds_read_b128 v[184:187], v4 offset:22528
    v_mfma_f32_16x16x32_bf16 v[132:135], v[160:163], a[212:215], v[132:135]
    v_mfma_f32_16x16x32_bf16 v[136:139], v[164:167], a[208:211], v[136:139]
    ds_read_b128 v[188:191], v4 offset:23552
    v_mfma_f32_16x16x32_bf16 v[140:143], v[164:167], a[212:215], v[140:143]
    s_waitcnt lgkmcnt(4)
    v_mfma_f32_16x16x32_bf16 v[128:131], v[168:171], a[216:219], v[128:131]
    ds_read_b128 v[144:147], v4 offset:24576
    v_mfma_f32_16x16x32_bf16 v[132:135], v[168:171], a[220:223], v[132:135]
    v_mfma_f32_16x16x32_bf16 v[136:139], v[172:175], a[216:219], v[136:139]
    ds_read_b128 v[148:151], v4 offset:25600
    v_mfma_f32_16x16x32_bf16 v[140:143], v[172:175], a[220:223], v[140:143]
    s_waitcnt lgkmcnt(4)
    v_mfma_f32_16x16x32_bf16 v[128:131], v[176:179], a[224:227], v[128:131]
    ds_read_b128 v[152:155], v4 offset:26624
    v_mfma_f32_16x16x32_bf16 v[132:135], v[176:179], a[228:231], v[132:135]
    v_mfma_f32_16x16x32_bf16 v[136:139], v[180:183], a[224:227], v[136:139]
    ds_read_b128 v[156:159], v4 offset:27648
    v_mfma_f32_16x16x32_bf16 v[140:143], v[180:183], a[228:231], v[140:143]
    s_waitcnt lgkmcnt(4)
    v_mfma_f32_16x16x32_bf16 v[128:131], v[184:187], a[232:235], v[128:131]
    ds_read_b128 v[160:163], v4 offset:28672
    v_mfma_f32_16x16x32_bf16 v[132:135], v[184:187], a[236:239], v[132:135]
    v_mfma_f32_16x16x32_bf16 v[136:139], v[188:191], a[232:235], v[136:139]
    ds_read_b128 v[164:167], v4 offset:29696
    v_mfma_f32_16x16x32_bf16 v[140:143], v[188:191], a[236:239], v[140:143]
    s_waitcnt vmcnt(0)
    v_readfirstlane_b32 s64, v248
    s_nop 0
    s_cmp_ge_u32 s64, 4
    s_cbranch_scc0 k3_kernel_slowF
k3_kernel_backF:
    buffer_load_dwordx4 v[72:75], v3, s[8:11], s44 offen offset:0 sc1
    buffer_load_dwordx4 v[76:79], v3, s[8:11], s44 offen offset:1024 sc1
    buffer_load_dwordx4 v[80:83], v3, s[8:11], s44 offen offset:2048 sc1
    buffer_load_dwordx4 v[84:87], v3, s[8:11], s44 offen offset:3072 sc1
    buffer_load_dwordx4 v[88:91], v3, s[8:11], s45 offen offset:0 sc1
    buffer_load_dwordx4 v[92:95], v3, s[8:11], s45 offen offset:1024 sc1
    s_mov_b64 exec, 0xffff
    buffer_load_dwordx4 v[96:99], v3, s[8:11], s47 offen offset:0 sc1
    buffer_load_dwordx4 v[100:103], v3, s[8:11], s47 offen offset:256 sc1
    buffer_load_dwordx4 v[104:107], v3, s[8:11], s47 offen offset:512 sc1
    buffer_load_dwordx4 v[108:111], v3, s[8:11], s47 offen offset:768 sc1
    s_mov_b64 exec, -1
    s_waitcnt lgkmcnt(4)
    v_mfma_f32_16x16x32_bf16 v[128:131], v[144:147], a[240:243], v[128:131]
    ds_read_b128 v[168:171], v4 offset:30720
    v_mfma_f32_16x16x32_bf16 v[132:135], v[144:147], a[244:247], v[132:135]
    v_mfma_f32_16x16x32_bf16 v[136:139], v[148:151], a[240:243], v[136:139]
    ds_read_b128 v[172:175], v4 offset:31744
    v_mfma_f32_16x16x32_bf16 v[140:143], v[148:151], a[244:247], v[140:143]
    s_waitcnt lgkmcnt(4)
    v_mfma_f32_16x16x32_bf16 v[128:131], v[152:155], a[248:251], v[128:131]
    ds_read_b128 v[176:179], v4 offset:32768
    v_mfma_f32_16x16x32_bf16 v[132:135], v[152:155], a[252:255], v[132:135]
    v_mfma_f32_16x16x32_bf16 v[136:139], v[156:159], a[248:251], v[136:139]
    ds_read_b128 v[180:183], v4 offset:33792
    v_mfma_f32_16x16x32_bf16 v[140:143], v[156:159], a[252:255], v[140:143]
    s_waitcnt lgkmcnt(4)
    v_mfma_f32_16x16x32_bf16 v[128:131], v[160:163], v[8:11], v[128:131]
    ds_read_b128 v[184:187], v4 offset:34816
    v_mfma_f32_16x16x32_bf16 v[132:135], v[160:163], v[12:15], v[132:135]
    v_mfma_f32_16x16x32_bf16 v[136:139], v[164:167], v[8:11], v[136:139]
    ds_read_b128 v[188:191], v4 offset:35840
    v_mfma_f32_16x16x32_bf16 v[140:143], v[164:167], v[12:15], v[140:143]
    s_waitcnt lgkmcnt(4)
    v_mfma_f32_16x16x32_bf16 v[128:131], v[168:171], v[16:19], v[128:131]
    v_mfma_f32_16x16x32_bf16 v[132:135], v[168:171], v[20:23], v[132:135]
    v_mfma_f32_16x16x32_bf16 v[136:139], v[172:175], v[16:19], v[136:139]
    v_mfma_f32_16x16x32_bf16 v[140:143], v[172:175], v[20:23], v[140:143]
    s_waitcnt lgkmcnt(2)
    v_mfma_f32_16x16x32_bf16 v[128:131], v[176:179], v[24:27], v[128:131]
    v_mfma_f32_16x16x32_bf16 v[132:135], v[176:179], v[28:31], v[132:135]
    v_mfma_f32_16x16x32_bf16 v[136:139], v[180:183], v[24:27], v[136:139]
    v_mfma_f32_16x16x32_bf16 v[140:143], v[180:183], v[28:31], v[140:143]
    s_waitcnt lgkmcnt(0)
    v_mfma_f32_16x16x32_bf16 v[128:131], v[184:187], v[32:35], v[128:131]
    v_mfma_f32_16x16x32_bf16 v[132:135], v[184:187], v[36:39], v[132:135]
    v_mfma_f32_16x16x32_bf16 v[136:139], v[188:191], v[32:35], v[136:139]
    v_mfma_f32_16x16x32_bf16 v[140:143], v[188:191], v[36:39], v[140:143]
    s_waitcnt vmcnt(9)
    v_lshlrev_b32 v224, 16, v72
    v_and_b32 v225, s43, v72
    v_lshlrev_b32 v226, 16, v73
    v_and_b32 v227, s43, v73
    v_lshlrev_b32 v228, 16, v74
    v_and_b32 v229, s43, v74
    v_lshlrev_b32 v230, 16, v75
    v_and_b32 v231, s43, v75
    v_pk_add_f32 v[128:129], v[128:129], v[224:225]
    v_pk_add_f32 v[130:131], v[130:131], v[226:227]
    v_pk_add_f32 v[132:133], v[132:133], v[228:229]
    v_pk_add_f32 v[134:135], v[134:135], v[230:231]
    s_waitcnt vmcnt(8)
    v_lshlrev_b32 v224, 16, v76
    v_and_b32 v225, s43, v76
    v_lshlrev_b32 v226, 16, v77
    v_and_b32 v227, s43, v77
    v_lshlrev_b32 v228, 16, v78
    v_and_b32 v229, s43, v78
    v_lshlrev_b32 v230, 16, v79
    v_and_b32 v231, s43, v79
    v_pk_add_f32 v[136:137], v[136:137], v[224:225]
    v_pk_add_f32 v[138:139], v[138:139], v[226:227]
    v_pk_add_f32 v[140:141], v[140:141], v[228:229]
    v_pk_add_f32 v[142:143], v[142:143], v[230:231]
    s_waitcnt vmcnt(7)
    v_lshlrev_b32 v224, 16, v80
    v_and_b32 v225, s43, v80
    v_lshlrev_b32 v226, 16, v81
    v_and_b32 v227, s43, v81
    v_lshlrev_b32 v228, 16, v82
    v_and_b32 v229, s43, v82
    v_lshlrev_b32 v230, 16, v83
    v_and_b32 v231, s43, v83
    v_pk_add_f32 v[128:129], v[128:129], v[224:225]
    v_pk_add_f32 v[130:131], v[130:131], v[226:227]
    v_pk_add_f32 v[132:133], v[132:133], v[228:229]
    v_pk_add_f32 v[134:135], v[134:135], v[230:231]
    s_waitcnt vmcnt(6)
    v_lshlrev_b32 v224, 16, v84
    v_and_b32 v225, s43, v84
    v_lshlrev_b32 v226, 16, v85
    v_and_b32 v227, s43, v85
    v_lshlrev_b32 v228, 16, v86
    v_and_b32 v229, s43, v86
    v_lshlrev_b32 v230, 16, v87
    v_and_b32 v231, s43, v87
    v_pk_add_f32 v[136:137], v[136:137], v[224:225]
    v_pk_add_f32 v[138:139], v[138:139], v[226:227]
    v_pk_add_f32 v[140:141], v[140:141], v[228:229]
    v_pk_add_f32 v[142:143], v[142:143], v[230:231]
    s_waitcnt vmcnt(5)
    v_lshlrev_b32 v224, 16, v88
    v_and_b32 v225, s43, v88
    v_lshlrev_b32 v226, 16, v89
    v_and_b32 v227, s43, v89
    v_lshlrev_b32 v228, 16, v90
    v_and_b32 v229, s43, v90
    v_lshlrev_b32 v230, 16, v91
    v_and_b32 v231, s43, v91
    v_pk_add_f32 v[128:129], v[128:129], v[224:225]
    v_pk_add_f32 v[130:131], v[130:131], v[226:227]
    v_pk_add_f32 v[132:133], v[132:133], v[228:229]
    v_pk_add_f32 v[134:135], v[134:135], v[230:231]
    s_waitcnt vmcnt(4)
    v_lshlrev_b32 v224, 16, v92
    v_and_b32 v225, s43, v92
    v_lshlrev_b32 v226, 16, v93
    v_and_b32 v227, s43, v93
    v_lshlrev_b32 v228, 16, v94
    v_and_b32 v229, s43, v94
    v_lshlrev_b32 v230, 16, v95
    v_and_b32 v231, s43, v95
    v_pk_add_f32 v[136:137], v[136:137], v[224:225]
    v_pk_add_f32 v[138:139], v[138:139], v[226:227]
    v_pk_add_f32 v[140:141], v[140:141], v[228:229]
    v_pk_add_f32 v[142:143], v[142:143], v[230:231]
    v_mul_f32 v128, v42, v128
    v_mul_f32 v129, v42, v129
    v_mul_f32 v130, v42, v130
    v_mul_f32 v131, v42, v131
    v_mul_f32 v132, v43, v132
    v_mul_f32 v133, v43, v133
    v_mul_f32 v134, v43, v134
    v_mul_f32 v135, v43, v135
    v_mul_f32 v136, v42, v136
    v_mul_f32 v137, v42, v137
    v_mul_f32 v138, v42, v138
    v_mul_f32 v139, v42, v139
    v_mul_f32 v140, v43, v140
    v_mul_f32 v141, v43, v141
    v_mul_f32 v142, v43, v142
    v_mul_f32 v143, v43, v143
    v_cvt_pk_bf16_f32 v144, v128, v129
    v_cvt_pk_bf16_f32 v145, v130, v131
    v_cvt_pk_bf16_f32 v146, v136, v137
    v_cvt_pk_bf16_f32 v147, v138, v139
    v_cvt_pk_bf16_f32 v148, v132, v133
    v_cvt_pk_bf16_f32 v149, v134, v135
    v_cvt_pk_bf16_f32 v150, v140, v141
    v_cvt_pk_bf16_f32 v151, v142, v143
    v_permlane16_swap_b32 v144, v146
    v_permlane16_swap_b32 v145, v147
    v_permlane16_swap_b32 v148, v150
    v_permlane16_swap_b32 v149, v151
    v_lshlrev_b32 v224, 16, v144
    v_and_b32 v225, s43, v144
    v_lshlrev_b32 v226, 16, v145
    v_and_b32 v227, s43, v145
    v_lshlrev_b32 v228, 16, v146
    v_and_b32 v229, s43, v146
    v_lshlrev_b32 v230, 16, v147
    v_and_b32 v231, s43, v147
    v_pk_add_f32 v[224:225], v[224:225], v[200:201]
    v_pk_add_f32 v[226:227], v[226:227], v[202:203]
    v_pk_add_f32 v[228:229], v[228:229], v[204:205]
    v_pk_add_f32 v[230:231], v[230:231], v[206:207]
    v_cvt_pk_bf16_f32 v144, v224, v225
    v_cvt_pk_bf16_f32 v145, v226, v227
    v_cvt_pk_bf16_f32 v146, v228, v229
    v_cvt_pk_bf16_f32 v147, v230, v231
    buffer_store_dwordx4 v[144:147], v41, s[16:19], s42 offen sc1
    v_lshlrev_b32 v224, 16, v148
    v_and_b32 v225, s43, v148
    v_lshlrev_b32 v226, 16, v149
    v_and_b32 v227, s43, v149
    v_lshlrev_b32 v228, 16, v150
    v_and_b32 v229, s43, v150
    v_lshlrev_b32 v230, 16, v151
    v_and_b32 v231, s43, v151
    v_pk_add_f32 v[224:225], v[224:225], v[208:209]
    v_pk_add_f32 v[226:227], v[226:227], v[210:211]
    v_pk_add_f32 v[228:229], v[228:229], v[212:213]
    v_pk_add_f32 v[230:231], v[230:231], v[214:215]
    v_cvt_pk_bf16_f32 v148, v224, v225
    v_cvt_pk_bf16_f32 v149, v226, v227
    v_cvt_pk_bf16_f32 v150, v228, v229
    v_cvt_pk_bf16_f32 v151, v230, v231
    buffer_store_dwordx4 v[148:151], v41, s[16:19], s36 offen sc1
    s_mov_b64 exec, 0xffff
    s_waitcnt vmcnt(2)
    v_lshlrev_b32 v152, 16, v96
    v_and_b32 v153, s43, v96
    v_lshlrev_b32 v154, 16, v97
    v_and_b32 v155, s43, v97
    v_lshlrev_b32 v156, 16, v98
    v_and_b32 v157, s43, v98
    v_lshlrev_b32 v158, 16, v99
    v_and_b32 v159, s43, v99
    v_lshlrev_b32 v224, 16, v100
    v_and_b32 v225, s43, v100
    v_lshlrev_b32 v226, 16, v101
    v_and_b32 v227, s43, v101
    v_lshlrev_b32 v228, 16, v102
    v_and_b32 v229, s43, v102
    v_lshlrev_b32 v230, 16, v103
    v_and_b32 v231, s43, v103
    v_pk_add_f32 v[152:153], v[152:153], v[224:225]
    v_pk_add_f32 v[154:155], v[154:155], v[226:227]
    v_pk_add_f32 v[156:157], v[156:157], v[228:229]
    v_pk_add_f32 v[158:159], v[158:159], v[230:231]
    v_lshlrev_b32 v224, 16, v104
    v_and_b32 v225, s43, v104
    v_lshlrev_b32 v226, 16, v105
    v_and_b32 v227, s43, v105
    v_lshlrev_b32 v228, 16, v106
    v_and_b32 v229, s43, v106
    v_lshlrev_b32 v230, 16, v107
    v_and_b32 v231, s43, v107
    v_pk_add_f32 v[152:153], v[152:153], v[224:225]
    v_pk_add_f32 v[154:155], v[154:155], v[226:227]
    v_pk_add_f32 v[156:157], v[156:157], v[228:229]
    v_pk_add_f32 v[158:159], v[158:159], v[230:231]
    v_lshlrev_b32 v224, 16, v108
    v_and_b32 v225, s43, v108
    v_lshlrev_b32 v226, 16, v109
    v_and_b32 v227, s43, v109
    v_lshlrev_b32 v228, 16, v110
    v_and_b32 v229, s43, v110
    v_lshlrev_b32 v230, 16, v111
    v_and_b32 v231, s43, v111
    v_pk_add_f32 v[152:153], v[152:153], v[224:225]
    v_pk_add_f32 v[154:155], v[154:155], v[226:227]
    v_pk_add_f32 v[156:157], v[156:157], v[228:229]
    v_pk_add_f32 v[158:159], v[158:159], v[230:231]
    v_mul_f32 v152, v46, v152
    v_mul_f32 v153, v46, v153
    v_mul_f32 v154, v46, v154
    v_mul_f32 v155, v46, v155
    v_mul_f32 v156, v47, v156
    v_mul_f32 v157, v47, v157
    v_mul_f32 v158, v47, v158
    v_mul_f32 v159, v47, v159
    v_cvt_pk_bf16_f32 v96, v152, v153
    v_cvt_pk_bf16_f32 v97, v154, v155
    v_cvt_pk_bf16_f32 v98, v156, v157
    v_cvt_pk_bf16_f32 v99, v158, v159
    v_lshlrev_b32 v152, 16, v96
    v_and_b32 v153, s43, v96
    v_lshlrev_b32 v154, 16, v97
    v_and_b32 v155, s43, v97
    v_lshlrev_b32 v156, 16, v98
    v_and_b32 v157, s43, v98
    v_lshlrev_b32 v158, 16, v99
    v_and_b32 v159, s43, v99
    v_pk_add_f32 v[152:153], v[152:153], v[216:217]
    v_pk_add_f32 v[154:155], v[154:155], v[218:219]
    v_pk_add_f32 v[156:157], v[156:157], v[220:221]
    v_pk_add_f32 v[158:159], v[158:159], v[222:223]
    v_cvt_pk_bf16_f32 v96, v152, v153
    v_cvt_pk_bf16_f32 v97, v154, v155
    v_cvt_pk_bf16_f32 v98, v156, v157
    v_cvt_pk_bf16_f32 v99, v158, v159
    buffer_store_dwordx2 v[96:97], v45, s[16:19], s34 offen
    buffer_store_dwordx2 v[98:99], v45, s[16:19], s33 offen
    s_mov_b64 exec, -1
k3_kernel_end:
    s_endpgm
k3_kernel_slowM:
    s_mov_b32 s65, 0
k3_kernel_spinM:
    buffer_load_dword v248, v246, s[8:11], s32 offen offset:0 sc1
    s_add_u32 s65, s65, 1
    s_waitcnt vmcnt(0)
    s_cmp_ge_u32 s65, 0x80000
    s_cbranch_scc1 k3_kernel_backM
    v_readfirstlane_b32 s64, v248
    s_nop 0
    s_cmp_ge_u32 s64, 32
    s_cbranch_scc0 k3_kernel_spinM
    s_branch k3_kernel_backM
k3_kernel_slowW:
    s_mov_b32 s65, 0
k3_kernel_spinW:
    buffer_load_dword v248, v251, s[8:11], s66 offen offset:0 sc1
    s_add_u32 s65, s65, 1
    s_waitcnt vmcnt(0)
    s_cmp_ge_u32 s65, 0x80000
    s_cbranch_scc1 k3_kernel_backW
    v_cmp_ne_u32 vcc, 18, v248
    s_nop 0
    s_cmp_eq_u64 vcc, 0
    s_cbranch_scc0 k3_kernel_spinW
    s_branch k3_kernel_backW
k3_kernel_slowA:
    s_mov_b32 s65, 0
k3_kernel_spinA:
    buffer_load_dword v248, v246, s[8:11], s62 offen offset:0 sc1
    s_add_u32 s65, s65, 1
    s_waitcnt vmcnt(0)
    s_cmp_ge_u32 s65, 0x80000
    s_cbranch_scc1 k3_kernel_backA
    v_readfirstlane_b32 s64, v248
    s_nop 0
    s_bitcmp1_b32 s64, 3
    s_cbranch_scc0 k3_kernel_spinA
    s_branch k3_kernel_backA
k3_kernel_slowB:
    s_mov_b32 s65, 0
k3_kernel_spinB:
    buffer_load_dword v248, v246, s[8:11], s62 offen offset:128 sc1
    s_add_u32 s65, s65, 1
    s_waitcnt vmcnt(0)
    s_cmp_ge_u32 s65, 0x80000
    s_cbranch_scc1 k3_kernel_backB
    v_readfirstlane_b32 s64, v248
    s_nop 0
    s_bitcmp1_b32 s64, 7
    s_cbranch_scc0 k3_kernel_spinB
    s_branch k3_kernel_backB
k3_kernel_slowC:
    s_mov_b32 s65, 0
k3_kernel_spinC:
    buffer_load_dword v248, v246, s[8:11], s62 offen offset:256 sc1
    s_add_u32 s65, s65, 1
    s_waitcnt vmcnt(0)
    s_cmp_ge_u32 s65, 0x80000
    s_cbranch_scc1 k3_kernel_backC
    v_readfirstlane_b32 s64, v248
    s_nop 0
    s_bitcmp1_b32 s64, 11
    s_cbranch_scc0 k3_kernel_spinC
    s_branch k3_kernel_backC
k3_kernel_slowD:
    s_mov_b32 s65, 0
k3_kernel_spinD:
    buffer_load_dword v248, v246, s[8:11], s62 offen offset:384 sc1
    s_add_u32 s65, s65, 1
    s_waitcnt vmcnt(0)
    s_cmp_ge_u32 s65, 0x80000
    s_cbranch_scc1 k3_kernel_backD
    v_readfirstlane_b32 s64, v248
    s_nop 0
    s_bitcmp1_b32 s64, 15
    s_cbranch_scc0 k3_kernel_spinD
    s_branch k3_kernel_backD
k3_kernel_slowR:
    s_mov_b32 s65, 0
k3_kernel_spinR:
    buffer_load_dword v248, v246, s[8:11], s81 offen offset:0 sc1
    s_add_u32 s65, s65, 1
    s_waitcnt vmcnt(0)
    s_cmp_ge_u32 s65, 0x80000
    s_cbranch_scc1 k3_kernel_backR
    v_readfirstlane_b32 s64, v248
    s_nop 0
    s_cmp_ge_u32 s64, 32
    s_cbranch_scc0 k3_kernel_spinR
    s_branch k3_kernel_backR
k3_kernel_slowF:
    s_mov_b32 s65, 0
k3_kernel_spinF:
    buffer_load_dword v248, v246, s[8:11], s51 offen offset:0 sc1
    s_add_u32 s65, s65, 1
    s_waitcnt vmcnt(0)
    s_cmp_ge_u32 s65, 0x80000
    s_cbranch_scc1 k3_kernel_backF
    v_readfirstlane_b32 s64, v248
    s_nop 0
    s_cmp_ge_u32 s64, 4
    s_cbranch_scc0 k3_kernel_spinF
    s_branch k3_kernel_backF

L_text_end:
    s_endpgm
.section .rodata,"a"
.p2align 6
.amdhsa_kernel k1_kernel
  .amdhsa_next_free_vgpr 208
  .amdhsa_next_free_sgpr 96
  .amdhsa_accum_offset 208
  .amdhsa_group_segment_fixed_size 0
  .amdhsa_kernarg_size 112
  .amdhsa_user_sgpr_count 2
  .amdhsa_user_sgpr_kernarg_segment_ptr 1
  .amdhsa_system_sgpr_workgroup_id_x 1
  .amdhsa_float_denorm_mode_32 3
.end_amdhsa_kernel
.p2align 6
.amdhsa_kernel k2_kernel
  .amdhsa_next_free_vgpr 256
  .amdhsa_next_free_sgpr 96
  .amdhsa_accum_offset 256
  .amdhsa_group_segment_fixed_size 0
  .amdhsa_kernarg_size 112
  .amdhsa_user_sgpr_count 2
  .amdhsa_user_sgpr_kernarg_segment_ptr 1
  .amdhsa_system_sgpr_workgroup_id_x 1
  .amdhsa_float_denorm_mode_32 3
.end_amdhsa_kernel
.p2align 6
.amdhsa_kernel k3_kernel
  .amdhsa_next_free_vgpr 512
  .amdhsa_next_free_sgpr 102
  .amdhsa_accum_offset 256
  .amdhsa_group_segment_fixed_size 0
  .amdhsa_kernarg_size 112
  .amdhsa_user_sgpr_count 2
  .amdhsa_user_sgpr_kernarg_segment_ptr 1
  .amdhsa_system_sgpr_workgroup_id_x 1
  .amdhsa_float_denorm_mode_32 3
.end_amdhsa_kernel
```
